```python
import torch

def _softmax(x, axis=-1):
    return torch.softmax(x, dim=axis)
def _gelu(x):
    return torch.nn.functional.gelu(x, approximate="tanh")
def _silu(x):
    return torch.nn.functional.silu(x)
def _sigmoid(x):
    return torch.sigmoid(x)
def _layernorm(x, axis=-1, eps=1e-5):
    m = x.mean(dim=axis, keepdim=True)
    v = x.var(dim=axis, keepdim=True, unbiased=False)
    return (x - m) / torch.sqrt(v + eps)
def _scatter_add(tgt, idx, src, axis=0):
    return tgt.clone().index_add_(axis, idx, src)
def _segment_sum(src, seg, n):
    out = torch.zeros((n,) + src.shape[1:], dtype=src.dtype)
    return out.index_add_(0, seg, src)
def _pad(x, pw):
    flat = tuple(v for pair in reversed(pw) for v in pair)
    return torch.nn.functional.pad(x, flat)

kernel_name = 'standalone__gqa_softmax__prompt'

def setup_inputs():

    _w = (lambda a: (lambda t: t.to(torch.bfloat16) if t.is_floating_point() else t)(torch.as_tensor(a)))
    B, Hq, Hkv, Sq, Sk, D = 1, 32, 32, 2048, 2048, 192
    return {
        "q": _w((lambda *s: torch.randn(*s, dtype=torch.bfloat16) * 0.8)(B, Hq, Sq, D)),
        "k": _w((lambda *s: torch.randn(*s, dtype=torch.bfloat16) * 0.8)(B, Hkv, Sk, D)),
        "v": _w((lambda *s: torch.randn(*s, dtype=torch.bfloat16) * 0.05)(B, Hkv, Sk, D)),
    }

def reference(q, k, v):
    B, Hq, Sq, D = q.shape
    Hkv = k.shape[1]
    rep = Hq // Hkv
    k = (lambda x, n, axis: torch.repeat_interleave(x, n, dim=axis))(k, rep, axis=1)
    v = (lambda x, n, axis: torch.repeat_interleave(x, n, dim=axis))(v, rep, axis=1)
    scale = D ** -0.5
    scores = torch.einsum("bhqd,bhkd->bhqk", q, k) * scale
    p = _softmax(scores, axis=-1)
    return torch.einsum("bhqk,bhkd->bhqd", p, v)
```

```asm
; @launch grid=(256,1,1) block=(256,1,1) lds=147456
.amdgcn_target "amdgcn-amd-amdhsa--gfx950"
.text
.globl standalone__gqa_softmax__prompt_kernel
.p2align 8
.type standalone__gqa_softmax__prompt_kernel,@function
standalone__gqa_softmax__prompt_kernel:
s_cmp_ge_u32 s2, 256
s_cbranch_scc1 L_end
s_load_dwordx4 s[4:7], s[0:1], 0
s_load_dwordx4 s[40:43], s[0:1], 16
s_getpc_b64 s[84:85]
L_pc:
s_lshr_b32 s86, s2, 3
s_and_b32 s86, s86, 7
s_lshl_b32 s86, s86, 13
v_and_b32 v2, 63, v0
v_lshlrev_b32 v2, 7, v2
v_add_u32 v2, s86, v2
v_min_u32 v3, L_text_end-L_pc-4, v2
global_load_dword v247, v3, s[84:85]
v_lshrrev_b32 v251, 6, v0
v_and_b32 v248, 63, v0
v_readfirstlane_b32 s28, v251
v_lshrrev_b32 v250, 4, v248
s_and_b32 s29, s2, 7
s_lshr_b32 s32, s2, 3
s_lshr_b32 s33, s32, 3
s_lshl_b32 s29, s29, 2
s_add_u32 s29, s29, s33
s_and_b32 s32, s32, 7
s_mul_i32 s33, s29, 786432
s_mul_i32 s34, s32, 98304
s_add_u32 s34, s34, s33
s_mul_i32 s24, s28, 6144
v_lshrrev_b32 v251, 3, v248
v_mul_u32_u24 v251, 384, v251
v_and_b32 v252, 7, v248
v_add_u32 v251, s24, v251
v_add_u32 v253, 0, v250
v_xor_b32 v253, v253, v252
v_lshlrev_b32 v253, 4, v253
v_add_u32 v253, v253, v251
v_add_u32 v244, 0, v253
v_add_u32 v253, 4, v250
v_xor_b32 v253, v253, v252
v_lshlrev_b32 v253, 4, v253
v_add_u32 v253, v253, v251
v_add_u32 v245, 3072, v253
v_lshlrev_b32 v253, 1, v250
v_xor_b32 v253, v253, v252
v_lshlrev_b32 v253, 4, v253
v_add_u32 v246, v253, v251
s_waitcnt lgkmcnt(0)
s_add_u32 s8, s4, s34
s_addc_u32 s9, s5, 0
s_and_b32 s9, s9, 0xffff
s_mov_b32 s10, 98304
s_mov_b32 s11, 0x20000
s_add_u32 s12, s6, s33
s_addc_u32 s13, s7, 0
s_and_b32 s13, s13, 0xffff
s_mov_b32 s14, 786432
s_mov_b32 s15, 0x20000
s_mul_i32 s91, s28, 18432
s_add_u32 s90, s91, 0
s_add_u32 m0, s24, 24576
s_nop 0
buffer_load_dwordx4 v244, s[8:11], s90 offen lds
s_add_u32 m0, s24, 25600
s_nop 0
buffer_load_dwordx4 v245, s[8:11], s90 offen lds
s_add_u32 m0, s24, 26496
s_nop 0
buffer_load_dwordx4 v244, s[8:11], s90 offen offset:128 lds
s_add_u32 m0, s24, 27520
s_nop 0
buffer_load_dwordx4 v245, s[8:11], s90 offen offset:128 lds
s_add_u32 m0, s24, 28416
s_nop 0
buffer_load_dwordx4 v244, s[8:11], s90 offen offset:256 lds
s_add_u32 m0, s24, 29440
s_nop 0
buffer_load_dwordx4 v245, s[8:11], s90 offen offset:256 lds
s_mov_b32 s90, 0
s_add_u32 m0, s24, 0
s_nop 0
buffer_load_dwordx4 v244, s[12:15], s90 offen lds
s_add_u32 m0, s24, 1024
s_nop 0
buffer_load_dwordx4 v245, s[12:15], s90 offen lds
s_add_u32 m0, s24, 1920
s_nop 0
buffer_load_dwordx4 v244, s[12:15], s90 offen offset:128 lds
s_add_u32 m0, s24, 2944
s_nop 0
buffer_load_dwordx4 v245, s[12:15], s90 offen offset:128 lds
s_add_u32 m0, s24, 3840
s_nop 0
buffer_load_dwordx4 v244, s[12:15], s90 offen offset:256 lds
s_add_u32 m0, s24, 4864
s_nop 0
buffer_load_dwordx4 v245, s[12:15], s90 offen offset:256 lds
s_add_u32 s16, s40, s33
s_addc_u32 s17, s41, 0
s_sub_u32 s16, s16, 24576
s_subb_u32 s17, s17, 0
s_and_b32 s17, s17, 0xffff
s_mov_b32 s18, 811008
s_mov_b32 s19, 0x20000
s_add_u32 s20, s42, s34
s_addc_u32 s21, s43, 0
s_and_b32 s21, s21, 0xffff
s_mov_b32 s22, 98304
s_mov_b32 s23, 0x20000
v_and_b32 v249, 15, v248
v_lshrrev_b32 v251, 1, v249
v_add_u32 v252, 0, v250
v_xor_b32 v252, v252, v251
v_lshlrev_b32 v252, 4, v252
v_lshl_add_u32 v232, v249, 7, v252
v_add_u32 v234, 49152, v232
v_add_u32 v252, 4, v250
v_xor_b32 v252, v252, v251
v_lshlrev_b32 v252, 4, v252
v_lshl_add_u32 v233, v249, 7, v252
v_add_u32 v235, 49152, v233
v_lshrrev_b32 v251, 2, v249
v_lshl_add_u32 v251, v250, 2, v251
v_lshrrev_b32 v252, 1, v251
v_and_b32 v252, 3, v252
v_and_b32 v254, 3, v249
v_xor_b32 v253, 0, v252
v_lshlrev_b32 v253, 5, v253
v_lshl_add_u32 v253, v251, 7, v253
v_lshl_add_u32 v253, v254, 3, v253
v_add_u32 v236, 73728, v253
v_add_u32 v240, 122880, v253
v_xor_b32 v253, 1, v252
v_lshlrev_b32 v253, 5, v253
v_lshl_add_u32 v253, v251, 7, v253
v_lshl_add_u32 v253, v254, 3, v253
v_add_u32 v237, 73728, v253
v_add_u32 v241, 122880, v253
v_xor_b32 v253, 2, v252
v_lshlrev_b32 v253, 5, v253
v_lshl_add_u32 v253, v251, 7, v253
v_lshl_add_u32 v253, v254, 3, v253
v_add_u32 v238, 73728, v253
v_add_u32 v242, 122880, v253
v_xor_b32 v253, 3, v252
v_lshlrev_b32 v253, 5, v253
v_lshl_add_u32 v253, v251, 7, v253
v_lshl_add_u32 v253, v254, 3, v253
v_add_u32 v239, 73728, v253
v_add_u32 v243, 122880, v253
s_mov_b32 s35, 0x3dd53b95
s_mov_b32 s94, 0x3dd53b95
s_mov_b32 s95, 0x3dd53b95
s_mov_b32 s27, 0x45800000
v_mov_b32 v10, 0
v_mov_b32 v11, 0
v_mov_b32 v12, 0
v_mov_b32 v13, 0
s_nop 1
v_mfma_f32_32x32x16_bf16 a[0:15], v[10:13], v[10:13], 0
v_mfma_f32_32x32x16_bf16 a[16:31], v[10:13], v[10:13], 0
v_mfma_f32_32x32x16_bf16 a[32:47], v[10:13], v[10:13], 0
v_mfma_f32_32x32x16_bf16 a[48:63], v[10:13], v[10:13], 0
v_mfma_f32_32x32x16_bf16 a[64:79], v[10:13], v[10:13], 0
v_mfma_f32_32x32x16_bf16 a[80:95], v[10:13], v[10:13], 0
v_mfma_f32_32x32x16_bf16 a[96:111], v[10:13], v[10:13], 0
v_mfma_f32_32x32x16_bf16 a[112:127], v[10:13], v[10:13], 0
v_mfma_f32_32x32x16_bf16 a[128:143], v[10:13], v[10:13], 0
v_mfma_f32_32x32x16_bf16 a[144:159], v[10:13], v[10:13], 0
v_mfma_f32_32x32x16_bf16 a[160:175], v[10:13], v[10:13], 0
v_mfma_f32_32x32x16_bf16 a[176:191], v[10:13], v[10:13], 0
s_add_u32 s90, s91, 6144
s_add_u32 m0, s24, 49152
s_nop 0
buffer_load_dwordx4 v244, s[8:11], s90 offen lds
s_add_u32 m0, s24, 50176
s_nop 0
buffer_load_dwordx4 v245, s[8:11], s90 offen lds
s_add_u32 m0, s24, 51072
s_nop 0
buffer_load_dwordx4 v244, s[8:11], s90 offen offset:128 lds
s_add_u32 m0, s24, 52096
s_nop 0
buffer_load_dwordx4 v245, s[8:11], s90 offen offset:128 lds
s_add_u32 m0, s24, 52992
s_nop 0
buffer_load_dwordx4 v244, s[8:11], s90 offen offset:256 lds
s_add_u32 m0, s24, 54016
s_nop 0
buffer_load_dwordx4 v245, s[8:11], s90 offen offset:256 lds
v_mov_b32 v228, 0
v_mov_b32 v229, 0
v_mov_b32 v230, 0
v_mov_b32 v231, 0
s_waitcnt vmcnt(6) lgkmcnt(0)
s_barrier
s_add_u32 s90, s91, 12288
s_add_u32 m0, s24, 98304
s_nop 0
buffer_load_dwordx4 v244, s[8:11], s90 offen lds
s_add_u32 m0, s24, 99328
s_nop 0
buffer_load_dwordx4 v245, s[8:11], s90 offen lds
s_add_u32 m0, s24, 100224
s_nop 0
buffer_load_dwordx4 v244, s[8:11], s90 offen offset:128 lds
s_add_u32 m0, s24, 101248
s_nop 0
buffer_load_dwordx4 v245, s[8:11], s90 offen offset:128 lds
s_add_u32 m0, s24, 102144
s_nop 0
buffer_load_dwordx4 v244, s[8:11], s90 offen offset:256 lds
s_add_u32 m0, s24, 103168
s_nop 0
buffer_load_dwordx4 v245, s[8:11], s90 offen offset:256 lds
s_waitcnt vmcnt(18)
v_add_u32 v248, s24, v232
v_add_u32 v248, 24576, v248
v_add_u32 v249, s24, v233
v_add_u32 v249, 24576, v249
ds_read_b128 v[96:99], v248 offset:0
ds_read_b128 v[100:103], v249 offset:0
ds_read_b128 v[104:107], v248 offset:2048
ds_read_b128 v[108:111], v249 offset:2048
ds_read_b128 v[112:115], v248 offset:4096
ds_read_b128 v[116:119], v249 offset:4096
ds_read_b128 v[144:147], v232 offset:0
ds_read_b128 v[148:151], v233 offset:0
ds_read_b128 v[152:155], v232 offset:2048
ds_read_b128 v[156:159], v233 offset:2048
ds_read_b128 v[160:163], v232 offset:4096
ds_read_b128 v[164:167], v233 offset:4096
ds_read_b128 v[168:171], v232 offset:6144
ds_read_b128 v[172:175], v233 offset:6144
s_waitcnt lgkmcnt(13)
v_lshlrev_b32 v120, 16, v96
v_and_b32 v121, 0xffff0000, v96
v_lshlrev_b32 v122, 16, v97
v_and_b32 v123, 0xffff0000, v97
v_lshlrev_b32 v124, 16, v98
v_and_b32 v125, 0xffff0000, v98
v_lshlrev_b32 v126, 16, v99
v_and_b32 v127, 0xffff0000, v99
v_pk_mul_f32 v[120:121], v[120:121], s[94:95]
v_pk_mul_f32 v[122:123], v[122:123], s[94:95]
v_pk_mul_f32 v[124:125], v[124:125], s[94:95]
v_pk_mul_f32 v[126:127], v[126:127], s[94:95]
v_cvt_pk_bf16_f32 v96, v120, v121
v_cvt_pk_bf16_f32 v97, v122, v123
v_cvt_pk_bf16_f32 v98, v124, v125
v_cvt_pk_bf16_f32 v99, v126, v127
v_accvgpr_write_b32 a192, v96
v_accvgpr_write_b32 a193, v97
v_accvgpr_write_b32 a194, v98
v_accvgpr_write_b32 a195, v99
ds_read_b128 v[176:179], v232 offset:8192
ds_read_b128 v[180:183], v233 offset:8192
s_waitcnt lgkmcnt(14)
v_lshlrev_b32 v120, 16, v100
v_and_b32 v121, 0xffff0000, v100
v_lshlrev_b32 v122, 16, v101
v_and_b32 v123, 0xffff0000, v101
v_lshlrev_b32 v124, 16, v102
v_and_b32 v125, 0xffff0000, v102
v_lshlrev_b32 v126, 16, v103
v_and_b32 v127, 0xffff0000, v103
v_pk_mul_f32 v[120:121], v[120:121], s[94:95]
v_pk_mul_f32 v[122:123], v[122:123], s[94:95]
v_pk_mul_f32 v[124:125], v[124:125], s[94:95]
v_pk_mul_f32 v[126:127], v[126:127], s[94:95]
v_cvt_pk_bf16_f32 v100, v120, v121
v_cvt_pk_bf16_f32 v101, v122, v123
v_cvt_pk_bf16_f32 v102, v124, v125
v_cvt_pk_bf16_f32 v103, v126, v127
v_accvgpr_write_b32 a196, v100
v_accvgpr_write_b32 a197, v101
v_accvgpr_write_b32 a198, v102
v_accvgpr_write_b32 a199, v103
s_waitcnt lgkmcnt(13)
v_lshlrev_b32 v120, 16, v104
v_and_b32 v121, 0xffff0000, v104
v_lshlrev_b32 v122, 16, v105
v_and_b32 v123, 0xffff0000, v105
v_lshlrev_b32 v124, 16, v106
v_and_b32 v125, 0xffff0000, v106
v_lshlrev_b32 v126, 16, v107
v_and_b32 v127, 0xffff0000, v107
v_pk_mul_f32 v[120:121], v[120:121], s[94:95]
v_pk_mul_f32 v[122:123], v[122:123], s[94:95]
v_pk_mul_f32 v[124:125], v[124:125], s[94:95]
v_pk_mul_f32 v[126:127], v[126:127], s[94:95]
v_cvt_pk_bf16_f32 v104, v120, v121
v_cvt_pk_bf16_f32 v105, v122, v123
v_cvt_pk_bf16_f32 v106, v124, v125
v_cvt_pk_bf16_f32 v107, v126, v127
v_accvgpr_write_b32 a200, v104
v_accvgpr_write_b32 a201, v105
v_accvgpr_write_b32 a202, v106
v_accvgpr_write_b32 a203, v107
s_waitcnt lgkmcnt(12)
v_lshlrev_b32 v120, 16, v108
v_and_b32 v121, 0xffff0000, v108
v_lshlrev_b32 v122, 16, v109
v_and_b32 v123, 0xffff0000, v109
v_lshlrev_b32 v124, 16, v110
v_and_b32 v125, 0xffff0000, v110
v_lshlrev_b32 v126, 16, v111
v_and_b32 v127, 0xffff0000, v111
v_pk_mul_f32 v[120:121], v[120:121], s[94:95]
v_pk_mul_f32 v[122:123], v[122:123], s[94:95]
v_pk_mul_f32 v[124:125], v[124:125], s[94:95]
v_pk_mul_f32 v[126:127], v[126:127], s[94:95]
v_cvt_pk_bf16_f32 v108, v120, v121
v_cvt_pk_bf16_f32 v109, v122, v123
v_cvt_pk_bf16_f32 v110, v124, v125
v_cvt_pk_bf16_f32 v111, v126, v127
v_accvgpr_write_b32 a204, v108
v_accvgpr_write_b32 a205, v109
v_accvgpr_write_b32 a206, v110
v_accvgpr_write_b32 a207, v111
s_waitcnt lgkmcnt(11)
v_lshlrev_b32 v120, 16, v112
v_and_b32 v121, 0xffff0000, v112
v_lshlrev_b32 v122, 16, v113
v_and_b32 v123, 0xffff0000, v113
v_lshlrev_b32 v124, 16, v114
v_and_b32 v125, 0xffff0000, v114
v_lshlrev_b32 v126, 16, v115
v_and_b32 v127, 0xffff0000, v115
v_pk_mul_f32 v[120:121], v[120:121], s[94:95]
v_pk_mul_f32 v[122:123], v[122:123], s[94:95]
v_pk_mul_f32 v[124:125], v[124:125], s[94:95]
v_pk_mul_f32 v[126:127], v[126:127], s[94:95]
v_cvt_pk_bf16_f32 v112, v120, v121
v_cvt_pk_bf16_f32 v113, v122, v123
v_cvt_pk_bf16_f32 v114, v124, v125
v_cvt_pk_bf16_f32 v115, v126, v127
v_accvgpr_write_b32 a208, v112
v_accvgpr_write_b32 a209, v113
v_accvgpr_write_b32 a210, v114
v_accvgpr_write_b32 a211, v115
s_waitcnt lgkmcnt(10)
v_lshlrev_b32 v120, 16, v116
v_and_b32 v121, 0xffff0000, v116
v_lshlrev_b32 v122, 16, v117
v_and_b32 v123, 0xffff0000, v117
v_lshlrev_b32 v124, 16, v118
v_and_b32 v125, 0xffff0000, v118
v_lshlrev_b32 v126, 16, v119
v_and_b32 v127, 0xffff0000, v119
v_pk_mul_f32 v[120:121], v[120:121], s[94:95]
v_pk_mul_f32 v[122:123], v[122:123], s[94:95]
v_pk_mul_f32 v[124:125], v[124:125], s[94:95]
v_pk_mul_f32 v[126:127], v[126:127], s[94:95]
v_cvt_pk_bf16_f32 v116, v120, v121
v_cvt_pk_bf16_f32 v117, v122, v123
v_cvt_pk_bf16_f32 v118, v124, v125
v_cvt_pk_bf16_f32 v119, v126, v127
v_accvgpr_write_b32 a212, v116
v_accvgpr_write_b32 a213, v117
v_accvgpr_write_b32 a214, v118
v_accvgpr_write_b32 a215, v119
s_waitcnt lgkmcnt(0)
s_nop 1
v_mfma_f32_16x16x32_bf16 v[0:3], v[144:147], a[192:195], 0
v_mfma_f32_16x16x32_bf16 v[0:3], v[148:151], a[196:199], v[0:3]
ds_read_b128 v[144:147], v232 offset:10240
ds_read_b128 v[148:151], v233 offset:10240
v_mfma_f32_16x16x32_bf16 v[0:3], v[152:155], a[200:203], v[0:3]
v_mfma_f32_16x16x32_bf16 v[0:3], v[156:159], a[204:207], v[0:3]
ds_read_b128 v[152:155], v232 offset:12288
ds_read_b128 v[156:159], v233 offset:12288
v_mfma_f32_16x16x32_bf16 v[0:3], v[160:163], a[208:211], v[0:3]
v_mfma_f32_16x16x32_bf16 v[0:3], v[164:167], a[212:215], v[0:3]
ds_read_b128 v[160:163], v232 offset:14336
ds_read_b128 v[164:167], v233 offset:14336
v_mfma_f32_16x16x32_bf16 v[16:19], v[168:171], a[192:195], 0
v_mfma_f32_16x16x32_bf16 v[16:19], v[172:175], a[196:199], v[16:19]
ds_read_b128 v[168:171], v232 offset:16384
ds_read_b128 v[172:175], v233 offset:16384
v_mfma_f32_16x16x32_bf16 v[16:19], v[176:179], a[200:203], v[16:19]
v_mfma_f32_16x16x32_bf16 v[16:19], v[180:183], a[204:207], v[16:19]
ds_read_b128 v[176:179], v232 offset:18432
s_waitcnt lgkmcnt(6)
v_mfma_f32_16x16x32_bf16 v[16:19], v[144:147], a[208:211], v[16:19]
ds_read_b128 v[180:183], v233 offset:18432
v_mfma_f32_16x16x32_bf16 v[16:19], v[148:151], a[212:215], v[16:19]
ds_read_b128 v[144:147], v232 offset:20480
ds_read_b128 v[148:151], v233 offset:20480
v_mfma_f32_16x16x32_bf16 v[32:35], v[152:155], a[192:195], 0
s_waitcnt lgkmcnt(6)
v_mfma_f32_16x16x32_bf16 v[32:35], v[156:159], a[196:199], v[32:35]
ds_read_b128 v[152:155], v232 offset:22528
ds_read_b128 v[156:159], v233 offset:22528
v_mfma_f32_16x16x32_bf16 v[32:35], v[160:163], a[200:203], v[32:35]
v_mfma_f32_16x16x32_bf16 v[32:35], v[164:167], a[204:207], v[32:35]
s_waitcnt lgkmcnt(5)
v_mfma_f32_16x16x32_bf16 v[32:35], v[168:171], a[208:211], v[32:35]
v_mfma_f32_16x16x32_bf16 v[32:35], v[172:175], a[212:215], v[32:35]
v_mfma_f32_16x16x32_bf16 v[48:51], v[176:179], a[192:195], 0
s_waitcnt lgkmcnt(2)
v_mfma_f32_16x16x32_bf16 v[48:51], v[180:183], a[196:199], v[48:51]
v_mfma_f32_16x16x32_bf16 v[48:51], v[144:147], a[200:203], v[48:51]
v_mfma_f32_16x16x32_bf16 v[48:51], v[148:151], a[204:207], v[48:51]
s_waitcnt lgkmcnt(0)
v_mfma_f32_16x16x32_bf16 v[48:51], v[152:155], a[208:211], v[48:51]
v_mfma_f32_16x16x32_bf16 v[48:51], v[156:159], a[212:215], v[48:51]
s_nop 7
v_max3_f32 v250, v0, v1, v2
v_max3_f32 v251, v32, v33, v34
v_max3_f32 v250, v250, v3, v16
v_max3_f32 v251, v251, v35, v48
v_max3_f32 v250, v250, v17, v18
v_max3_f32 v251, v251, v49, v50
v_max3_f32 v250, v250, v19, v51
v_max_f32 v250, v250, v251
v_mov_b32 v251, v250
s_nop 1
v_permlane16_swap_b32 v250, v251
v_max_f32 v250, v250, v251
v_mov_b32 v251, v250
s_nop 1
v_permlane32_swap_b32 v250, v251
v_max_f32 v250, v250, v251
v_sub_f32 v128, 0, v250
v_sub_f32 v129, 0, v250
v_sub_f32 v130, 0, v250
v_sub_f32 v131, 0, v250
v_sub_f32 v0, v0, v250
v_sub_f32 v1, v1, v250
v_sub_f32 v2, v2, v250
v_sub_f32 v3, v3, v250
v_sub_f32 v16, v16, v250
v_sub_f32 v17, v17, v250
v_sub_f32 v18, v18, v250
v_sub_f32 v19, v19, v250
v_sub_f32 v32, v32, v250
v_sub_f32 v33, v33, v250
v_sub_f32 v34, v34, v250
v_sub_f32 v35, v35, v250
v_sub_f32 v48, v48, v250
v_sub_f32 v49, v49, v250
v_sub_f32 v50, v50, v250
v_sub_f32 v51, v51, v250
s_add_u32 s90, s91, 18432
s_add_u32 m0, s24, 122880
s_nop 0
buffer_load_dwordx4 v244, s[8:11], s90 offen lds
s_add_u32 m0, s24, 123904
s_nop 0
buffer_load_dwordx4 v245, s[8:11], s90 offen lds
s_add_u32 m0, s24, 124800
s_nop 0
buffer_load_dwordx4 v244, s[8:11], s90 offen offset:128 lds
s_add_u32 m0, s24, 125824
s_nop 0
buffer_load_dwordx4 v245, s[8:11], s90 offen offset:128 lds
s_add_u32 m0, s24, 126720
s_nop 0
buffer_load_dwordx4 v244, s[8:11], s90 offen offset:256 lds
s_add_u32 m0, s24, 127744
s_nop 0
buffer_load_dwordx4 v245, s[8:11], s90 offen offset:256 lds
s_waitcnt vmcnt(12)
v_add_u32 v248, s24, v232
v_add_u32 v248, 49152, v248
v_add_u32 v249, s24, v233
v_add_u32 v249, 49152, v249
ds_read_b128 v[96:99], v248 offset:0
ds_read_b128 v[100:103], v249 offset:0
ds_read_b128 v[104:107], v248 offset:2048
ds_read_b128 v[108:111], v249 offset:2048
ds_read_b128 v[112:115], v248 offset:4096
ds_read_b128 v[116:119], v249 offset:4096
ds_read_b128 v[144:147], v232 offset:0
ds_read_b128 v[148:151], v233 offset:0
ds_read_b128 v[152:155], v232 offset:2048
ds_read_b128 v[156:159], v233 offset:2048
ds_read_b128 v[160:163], v232 offset:4096
ds_read_b128 v[164:167], v233 offset:4096
ds_read_b128 v[168:171], v232 offset:6144
ds_read_b128 v[172:175], v233 offset:6144
s_waitcnt lgkmcnt(13)
v_lshlrev_b32 v120, 16, v96
v_and_b32 v121, 0xffff0000, v96
v_lshlrev_b32 v122, 16, v97
v_and_b32 v123, 0xffff0000, v97
v_lshlrev_b32 v124, 16, v98
v_and_b32 v125, 0xffff0000, v98
v_lshlrev_b32 v126, 16, v99
v_and_b32 v127, 0xffff0000, v99
v_pk_mul_f32 v[120:121], v[120:121], s[94:95]
v_pk_mul_f32 v[122:123], v[122:123], s[94:95]
v_pk_mul_f32 v[124:125], v[124:125], s[94:95]
v_pk_mul_f32 v[126:127], v[126:127], s[94:95]
v_cvt_pk_bf16_f32 v96, v120, v121
v_cvt_pk_bf16_f32 v97, v122, v123
v_cvt_pk_bf16_f32 v98, v124, v125
v_cvt_pk_bf16_f32 v99, v126, v127
v_accvgpr_write_b32 a216, v96
v_accvgpr_write_b32 a217, v97
v_accvgpr_write_b32 a218, v98
v_accvgpr_write_b32 a219, v99
ds_read_b128 v[176:179], v232 offset:8192
ds_read_b128 v[180:183], v233 offset:8192
s_waitcnt lgkmcnt(14)
v_lshlrev_b32 v120, 16, v100
v_and_b32 v121, 0xffff0000, v100
v_lshlrev_b32 v122, 16, v101
v_and_b32 v123, 0xffff0000, v101
v_lshlrev_b32 v124, 16, v102
v_and_b32 v125, 0xffff0000, v102
v_lshlrev_b32 v126, 16, v103
v_and_b32 v127, 0xffff0000, v103
v_pk_mul_f32 v[120:121], v[120:121], s[94:95]
v_pk_mul_f32 v[122:123], v[122:123], s[94:95]
v_pk_mul_f32 v[124:125], v[124:125], s[94:95]
v_pk_mul_f32 v[126:127], v[126:127], s[94:95]
v_cvt_pk_bf16_f32 v100, v120, v121
v_cvt_pk_bf16_f32 v101, v122, v123
v_cvt_pk_bf16_f32 v102, v124, v125
v_cvt_pk_bf16_f32 v103, v126, v127
v_accvgpr_write_b32 a220, v100
v_accvgpr_write_b32 a221, v101
v_accvgpr_write_b32 a222, v102
v_accvgpr_write_b32 a223, v103
s_waitcnt lgkmcnt(13)
v_lshlrev_b32 v120, 16, v104
v_and_b32 v121, 0xffff0000, v104
v_lshlrev_b32 v122, 16, v105
v_and_b32 v123, 0xffff0000, v105
v_lshlrev_b32 v124, 16, v106
v_and_b32 v125, 0xffff0000, v106
v_lshlrev_b32 v126, 16, v107
v_and_b32 v127, 0xffff0000, v107
v_pk_mul_f32 v[120:121], v[120:121], s[94:95]
v_pk_mul_f32 v[122:123], v[122:123], s[94:95]
v_pk_mul_f32 v[124:125], v[124:125], s[94:95]
v_pk_mul_f32 v[126:127], v[126:127], s[94:95]
v_cvt_pk_bf16_f32 v104, v120, v121
v_cvt_pk_bf16_f32 v105, v122, v123
v_cvt_pk_bf16_f32 v106, v124, v125
v_cvt_pk_bf16_f32 v107, v126, v127
v_accvgpr_write_b32 a224, v104
v_accvgpr_write_b32 a225, v105
v_accvgpr_write_b32 a226, v106
v_accvgpr_write_b32 a227, v107
s_waitcnt lgkmcnt(12)
v_lshlrev_b32 v120, 16, v108
v_and_b32 v121, 0xffff0000, v108
v_lshlrev_b32 v122, 16, v109
v_and_b32 v123, 0xffff0000, v109
v_lshlrev_b32 v124, 16, v110
v_and_b32 v125, 0xffff0000, v110
v_lshlrev_b32 v126, 16, v111
v_and_b32 v127, 0xffff0000, v111
v_pk_mul_f32 v[120:121], v[120:121], s[94:95]
v_pk_mul_f32 v[122:123], v[122:123], s[94:95]
v_pk_mul_f32 v[124:125], v[124:125], s[94:95]
v_pk_mul_f32 v[126:127], v[126:127], s[94:95]
v_cvt_pk_bf16_f32 v108, v120, v121
v_cvt_pk_bf16_f32 v109, v122, v123
v_cvt_pk_bf16_f32 v110, v124, v125
v_cvt_pk_bf16_f32 v111, v126, v127
v_accvgpr_write_b32 a228, v108
v_accvgpr_write_b32 a229, v109
v_accvgpr_write_b32 a230, v110
v_accvgpr_write_b32 a231, v111
s_waitcnt lgkmcnt(11)
v_lshlrev_b32 v120, 16, v112
v_and_b32 v121, 0xffff0000, v112
v_lshlrev_b32 v122, 16, v113
v_and_b32 v123, 0xffff0000, v113
v_lshlrev_b32 v124, 16, v114
v_and_b32 v125, 0xffff0000, v114
v_lshlrev_b32 v126, 16, v115
v_and_b32 v127, 0xffff0000, v115
v_pk_mul_f32 v[120:121], v[120:121], s[94:95]
v_pk_mul_f32 v[122:123], v[122:123], s[94:95]
v_pk_mul_f32 v[124:125], v[124:125], s[94:95]
v_pk_mul_f32 v[126:127], v[126:127], s[94:95]
v_cvt_pk_bf16_f32 v112, v120, v121
v_cvt_pk_bf16_f32 v113, v122, v123
v_cvt_pk_bf16_f32 v114, v124, v125
v_cvt_pk_bf16_f32 v115, v126, v127
v_accvgpr_write_b32 a232, v112
v_accvgpr_write_b32 a233, v113
v_accvgpr_write_b32 a234, v114
v_accvgpr_write_b32 a235, v115
s_waitcnt lgkmcnt(10)
v_lshlrev_b32 v120, 16, v116
v_and_b32 v121, 0xffff0000, v116
v_lshlrev_b32 v122, 16, v117
v_and_b32 v123, 0xffff0000, v117
v_lshlrev_b32 v124, 16, v118
v_and_b32 v125, 0xffff0000, v118
v_lshlrev_b32 v126, 16, v119
v_and_b32 v127, 0xffff0000, v119
v_pk_mul_f32 v[120:121], v[120:121], s[94:95]
v_pk_mul_f32 v[122:123], v[122:123], s[94:95]
v_pk_mul_f32 v[124:125], v[124:125], s[94:95]
v_pk_mul_f32 v[126:127], v[126:127], s[94:95]
v_cvt_pk_bf16_f32 v116, v120, v121
v_cvt_pk_bf16_f32 v117, v122, v123
v_cvt_pk_bf16_f32 v118, v124, v125
v_cvt_pk_bf16_f32 v119, v126, v127
v_accvgpr_write_b32 a236, v116
v_accvgpr_write_b32 a237, v117
v_accvgpr_write_b32 a238, v118
v_accvgpr_write_b32 a239, v119
s_waitcnt lgkmcnt(0)
s_nop 1
v_mfma_f32_16x16x32_bf16 v[4:7], v[144:147], a[216:219], 0
v_exp_f32 v216, v0
v_mfma_f32_16x16x32_bf16 v[4:7], v[148:151], a[220:223], v[4:7]
ds_read_b128 v[144:147], v232 offset:10240
ds_read_b128 v[148:151], v233 offset:10240
v_mfma_f32_16x16x32_bf16 v[4:7], v[152:155], a[224:227], v[4:7]
v_exp_f32 v217, v1
v_mfma_f32_16x16x32_bf16 v[4:7], v[156:159], a[228:231], v[4:7]
ds_read_b128 v[152:155], v232 offset:12288
ds_read_b128 v[156:159], v233 offset:12288
v_mfma_f32_16x16x32_bf16 v[4:7], v[160:163], a[232:235], v[4:7]
v_exp_f32 v218, v2
v_mfma_f32_16x16x32_bf16 v[4:7], v[164:167], a[236:239], v[4:7]
ds_read_b128 v[160:163], v232 offset:14336
ds_read_b128 v[164:167], v233 offset:14336
v_mfma_f32_16x16x32_bf16 v[20:23], v[168:171], a[216:219], 0
v_exp_f32 v219, v3
v_mfma_f32_16x16x32_bf16 v[20:23], v[172:175], a[220:223], v[20:23]
ds_read_b128 v[168:171], v232 offset:16384
ds_read_b128 v[172:175], v233 offset:16384
v_mfma_f32_16x16x32_bf16 v[20:23], v[176:179], a[224:227], v[20:23]
v_exp_f32 v220, v16
v_mfma_f32_16x16x32_bf16 v[20:23], v[180:183], a[228:231], v[20:23]
ds_read_b128 v[176:179], v232 offset:18432
s_waitcnt lgkmcnt(6)
v_mfma_f32_16x16x32_bf16 v[20:23], v[144:147], a[232:235], v[20:23]
ds_read_b128 v[180:183], v233 offset:18432
v_cvt_pk_bf16_f32 v64, v216, v217
v_mfma_f32_16x16x32_bf16 v[20:23], v[148:151], a[236:239], v[20:23]
ds_read_b128 v[144:147], v232 offset:20480
ds_read_b128 v[148:151], v233 offset:20480
v_mfma_f32_16x16x32_bf16 v[36:39], v[152:155], a[216:219], 0
v_cvt_pk_bf16_f32 v65, v218, v219
s_waitcnt lgkmcnt(6)
v_mfma_f32_16x16x32_bf16 v[36:39], v[156:159], a[220:223], v[36:39]
ds_read_b128 v[152:155], v232 offset:22528
ds_read_b128 v[156:159], v233 offset:22528
v_mfma_f32_16x16x32_bf16 v[36:39], v[160:163], a[224:227], v[36:39]
v_exp_f32 v221, v17
v_mfma_f32_16x16x32_bf16 v[36:39], v[164:167], a[228:231], v[36:39]
v_cvt_pk_bf16_f32 v66, v220, v221
s_waitcnt lgkmcnt(5)
v_mfma_f32_16x16x32_bf16 v[36:39], v[168:171], a[232:235], v[36:39]
v_exp_f32 v222, v18
v_mfma_f32_16x16x32_bf16 v[36:39], v[172:175], a[236:239], v[36:39]
v_exp_f32 v223, v19
v_mfma_f32_16x16x32_bf16 v[52:55], v[176:179], a[216:219], 0
v_cvt_pk_bf16_f32 v67, v222, v223
s_waitcnt lgkmcnt(2)
v_mfma_f32_16x16x32_bf16 v[52:55], v[180:183], a[220:223], v[52:55]
v_add_f32 v216, v216, v217
v_add_f32 v220, v220, v221
v_mfma_f32_16x16x32_bf16 v[52:55], v[144:147], a[224:227], v[52:55]
v_add_f32 v218, v218, v219
v_add_f32 v222, v222, v223
v_mfma_f32_16x16x32_bf16 v[52:55], v[148:151], a[228:231], v[52:55]
v_add_f32 v224, v216, v218
s_waitcnt lgkmcnt(0)
v_mfma_f32_16x16x32_bf16 v[52:55], v[152:155], a[232:235], v[52:55]
v_exp_f32 v216, v32
v_mfma_f32_16x16x32_bf16 v[52:55], v[156:159], a[236:239], v[52:55]
v_exp_f32 v217, v33
v_exp_f32 v218, v34
v_exp_f32 v219, v35
v_add_f32 v224, v224, v220
v_add_f32 v224, v224, v222
v_exp_f32 v220, v48
v_exp_f32 v221, v49
v_exp_f32 v222, v50
v_exp_f32 v223, v51
v_cvt_pk_bf16_f32 v80, v216, v217
v_cvt_pk_bf16_f32 v81, v218, v219
v_add_f32 v216, v216, v217
v_add_f32 v218, v218, v219
v_add_f32 v224, v224, v216
v_add_f32 v224, v224, v218
v_cvt_pk_bf16_f32 v82, v220, v221
v_cvt_pk_bf16_f32 v83, v222, v223
v_add_f32 v220, v220, v221
v_add_f32 v222, v222, v223
v_add_f32 v224, v224, v220
v_add_f32 v224, v224, v222
v_max3_f32 v250, v4, v5, v6
v_max3_f32 v251, v36, v37, v38
v_max3_f32 v250, v250, v7, v20
v_max3_f32 v251, v251, v39, v52
v_max3_f32 v250, v250, v21, v22
v_max3_f32 v251, v251, v53, v54
v_max3_f32 v250, v250, v23, v55
v_max_f32 v250, v250, v251
v_mov_b32 v251, v250
s_nop 1
v_permlane16_swap_b32 v250, v251
v_max_f32 v250, v250, v251
v_mov_b32 v251, v250
s_nop 1
v_permlane32_swap_b32 v250, v251
v_max_f32 v250, v250, v251
v_sub_f32 v132, 0, v250
v_sub_f32 v133, 0, v250
v_sub_f32 v134, 0, v250
v_sub_f32 v135, 0, v250
v_sub_f32 v4, v4, v250
v_sub_f32 v5, v5, v250
v_sub_f32 v6, v6, v250
v_sub_f32 v7, v7, v250
v_sub_f32 v20, v20, v250
v_sub_f32 v21, v21, v250
v_sub_f32 v22, v22, v250
v_sub_f32 v23, v23, v250
v_sub_f32 v36, v36, v250
v_sub_f32 v37, v37, v250
v_sub_f32 v38, v38, v250
v_sub_f32 v39, v39, v250
v_sub_f32 v52, v52, v250
v_sub_f32 v53, v53, v250
v_sub_f32 v54, v54, v250
v_sub_f32 v55, v55, v250
s_mov_b32 s90, 24576
s_add_u32 m0, s24, 73728
s_nop 0
buffer_load_dwordx4 v246, s[16:19], s90 offen lds
s_add_u32 m0, s24, 71680
s_nop 0
buffer_load_dwordx4 v246, s[16:19], s90 offen offset:3072 lds
s_add_u32 m0, s24, 75648
s_nop 0
buffer_load_dwordx4 v246, s[16:19], s90 offen offset:128 lds
s_add_u32 m0, s24, 73600
s_nop 0
buffer_load_dwordx4 v246, s[16:19], s90 offen offset:3200 lds
s_add_u32 m0, s24, 77568
s_nop 0
buffer_load_dwordx4 v246, s[16:19], s90 offen offset:256 lds
s_add_u32 m0, s24, 75520
s_nop 0
buffer_load_dwordx4 v246, s[16:19], s90 offen offset:3328 lds
s_waitcnt vmcnt(12)
v_add_u32 v248, s24, v232
v_add_u32 v248, 98304, v248
v_add_u32 v249, s24, v233
v_add_u32 v249, 98304, v249
ds_read_b128 v[96:99], v248 offset:0
ds_read_b128 v[100:103], v249 offset:0
ds_read_b128 v[104:107], v248 offset:2048
ds_read_b128 v[108:111], v249 offset:2048
ds_read_b128 v[112:115], v248 offset:4096
ds_read_b128 v[116:119], v249 offset:4096
ds_read_b128 v[144:147], v232 offset:0
ds_read_b128 v[148:151], v233 offset:0
ds_read_b128 v[152:155], v232 offset:2048
ds_read_b128 v[156:159], v233 offset:2048
ds_read_b128 v[160:163], v232 offset:4096
ds_read_b128 v[164:167], v233 offset:4096
ds_read_b128 v[168:171], v232 offset:6144
ds_read_b128 v[172:175], v233 offset:6144
s_waitcnt lgkmcnt(13)
v_lshlrev_b32 v120, 16, v96
v_and_b32 v121, 0xffff0000, v96
v_lshlrev_b32 v122, 16, v97
v_and_b32 v123, 0xffff0000, v97
v_lshlrev_b32 v124, 16, v98
v_and_b32 v125, 0xffff0000, v98
v_lshlrev_b32 v126, 16, v99
v_and_b32 v127, 0xffff0000, v99
v_pk_mul_f32 v[120:121], v[120:121], s[94:95]
v_pk_mul_f32 v[122:123], v[122:123], s[94:95]
v_pk_mul_f32 v[124:125], v[124:125], s[94:95]
v_pk_mul_f32 v[126:127], v[126:127], s[94:95]
v_cvt_pk_bf16_f32 v96, v120, v121
v_cvt_pk_bf16_f32 v97, v122, v123
v_cvt_pk_bf16_f32 v98, v124, v125
v_cvt_pk_bf16_f32 v99, v126, v127
v_accvgpr_write_b32 a240, v96
v_accvgpr_write_b32 a241, v97
v_accvgpr_write_b32 a242, v98
v_accvgpr_write_b32 a243, v99
ds_read_b128 v[176:179], v232 offset:8192
ds_read_b128 v[180:183], v233 offset:8192
s_waitcnt lgkmcnt(14)
v_lshlrev_b32 v120, 16, v100
v_and_b32 v121, 0xffff0000, v100
v_lshlrev_b32 v122, 16, v101
v_and_b32 v123, 0xffff0000, v101
v_lshlrev_b32 v124, 16, v102
v_and_b32 v125, 0xffff0000, v102
v_lshlrev_b32 v126, 16, v103
v_and_b32 v127, 0xffff0000, v103
v_pk_mul_f32 v[120:121], v[120:121], s[94:95]
v_pk_mul_f32 v[122:123], v[122:123], s[94:95]
v_pk_mul_f32 v[124:125], v[124:125], s[94:95]
v_pk_mul_f32 v[126:127], v[126:127], s[94:95]
v_cvt_pk_bf16_f32 v100, v120, v121
v_cvt_pk_bf16_f32 v101, v122, v123
v_cvt_pk_bf16_f32 v102, v124, v125
v_cvt_pk_bf16_f32 v103, v126, v127
v_accvgpr_write_b32 a244, v100
v_accvgpr_write_b32 a245, v101
v_accvgpr_write_b32 a246, v102
v_accvgpr_write_b32 a247, v103
s_waitcnt lgkmcnt(13)
v_lshlrev_b32 v120, 16, v104
v_and_b32 v121, 0xffff0000, v104
v_lshlrev_b32 v122, 16, v105
v_and_b32 v123, 0xffff0000, v105
v_lshlrev_b32 v124, 16, v106
v_and_b32 v125, 0xffff0000, v106
v_lshlrev_b32 v126, 16, v107
v_and_b32 v127, 0xffff0000, v107
v_pk_mul_f32 v[120:121], v[120:121], s[94:95]
v_pk_mul_f32 v[122:123], v[122:123], s[94:95]
v_pk_mul_f32 v[124:125], v[124:125], s[94:95]
v_pk_mul_f32 v[126:127], v[126:127], s[94:95]
v_cvt_pk_bf16_f32 v104, v120, v121
v_cvt_pk_bf16_f32 v105, v122, v123
v_cvt_pk_bf16_f32 v106, v124, v125
v_cvt_pk_bf16_f32 v107, v126, v127
v_accvgpr_write_b32 a248, v104
v_accvgpr_write_b32 a249, v105
v_accvgpr_write_b32 a250, v106
v_accvgpr_write_b32 a251, v107
s_waitcnt lgkmcnt(12)
v_lshlrev_b32 v120, 16, v108
v_and_b32 v121, 0xffff0000, v108
v_lshlrev_b32 v122, 16, v109
v_and_b32 v123, 0xffff0000, v109
v_lshlrev_b32 v124, 16, v110
v_and_b32 v125, 0xffff0000, v110
v_lshlrev_b32 v126, 16, v111
v_and_b32 v127, 0xffff0000, v111
v_pk_mul_f32 v[120:121], v[120:121], s[94:95]
v_pk_mul_f32 v[122:123], v[122:123], s[94:95]
v_pk_mul_f32 v[124:125], v[124:125], s[94:95]
v_pk_mul_f32 v[126:127], v[126:127], s[94:95]
v_cvt_pk_bf16_f32 v108, v120, v121
v_cvt_pk_bf16_f32 v109, v122, v123
v_cvt_pk_bf16_f32 v110, v124, v125
v_cvt_pk_bf16_f32 v111, v126, v127
v_accvgpr_write_b32 a252, v108
v_accvgpr_write_b32 a253, v109
v_accvgpr_write_b32 a254, v110
v_accvgpr_write_b32 a255, v111
s_waitcnt lgkmcnt(11)
v_lshlrev_b32 v120, 16, v112
v_and_b32 v121, 0xffff0000, v112
v_lshlrev_b32 v122, 16, v113
v_and_b32 v123, 0xffff0000, v113
v_lshlrev_b32 v124, 16, v114
v_and_b32 v125, 0xffff0000, v114
v_lshlrev_b32 v126, 16, v115
v_and_b32 v127, 0xffff0000, v115
v_pk_mul_f32 v[120:121], v[120:121], s[94:95]
v_pk_mul_f32 v[122:123], v[122:123], s[94:95]
v_pk_mul_f32 v[124:125], v[124:125], s[94:95]
v_pk_mul_f32 v[126:127], v[126:127], s[94:95]
v_cvt_pk_bf16_f32 v184, v120, v121
v_cvt_pk_bf16_f32 v185, v122, v123
v_cvt_pk_bf16_f32 v186, v124, v125
v_cvt_pk_bf16_f32 v187, v126, v127
s_waitcnt lgkmcnt(10)
v_lshlrev_b32 v120, 16, v116
v_and_b32 v121, 0xffff0000, v116
v_lshlrev_b32 v122, 16, v117
v_and_b32 v123, 0xffff0000, v117
v_lshlrev_b32 v124, 16, v118
v_and_b32 v125, 0xffff0000, v118
v_lshlrev_b32 v126, 16, v119
v_and_b32 v127, 0xffff0000, v119
v_pk_mul_f32 v[120:121], v[120:121], s[94:95]
v_pk_mul_f32 v[122:123], v[122:123], s[94:95]
v_pk_mul_f32 v[124:125], v[124:125], s[94:95]
v_pk_mul_f32 v[126:127], v[126:127], s[94:95]
v_cvt_pk_bf16_f32 v188, v120, v121
v_cvt_pk_bf16_f32 v189, v122, v123
v_cvt_pk_bf16_f32 v190, v124, v125
v_cvt_pk_bf16_f32 v191, v126, v127
s_waitcnt lgkmcnt(0)
s_nop 1
v_mfma_f32_16x16x32_bf16 v[8:11], v[144:147], a[240:243], 0
v_exp_f32 v216, v4
v_mfma_f32_16x16x32_bf16 v[8:11], v[148:151], a[244:247], v[8:11]
ds_read_b128 v[144:147], v232 offset:10240
ds_read_b128 v[148:151], v233 offset:10240
v_mfma_f32_16x16x32_bf16 v[8:11], v[152:155], a[248:251], v[8:11]
v_exp_f32 v217, v5
v_mfma_f32_16x16x32_bf16 v[8:11], v[156:159], a[252:255], v[8:11]
ds_read_b128 v[152:155], v232 offset:12288
ds_read_b128 v[156:159], v233 offset:12288
v_mfma_f32_16x16x32_bf16 v[8:11], v[160:163], v[184:187], v[8:11]
v_exp_f32 v218, v6
v_mfma_f32_16x16x32_bf16 v[8:11], v[164:167], v[188:191], v[8:11]
ds_read_b128 v[160:163], v232 offset:14336
ds_read_b128 v[164:167], v233 offset:14336
v_mfma_f32_16x16x32_bf16 v[24:27], v[168:171], a[240:243], 0
v_exp_f32 v219, v7
v_mfma_f32_16x16x32_bf16 v[24:27], v[172:175], a[244:247], v[24:27]
ds_read_b128 v[168:171], v232 offset:16384
ds_read_b128 v[172:175], v233 offset:16384
v_mfma_f32_16x16x32_bf16 v[24:27], v[176:179], a[248:251], v[24:27]
v_exp_f32 v220, v20
v_mfma_f32_16x16x32_bf16 v[24:27], v[180:183], a[252:255], v[24:27]
ds_read_b128 v[176:179], v232 offset:18432
s_waitcnt lgkmcnt(6)
v_mfma_f32_16x16x32_bf16 v[24:27], v[144:147], v[184:187], v[24:27]
ds_read_b128 v[180:183], v233 offset:18432
v_cvt_pk_bf16_f32 v68, v216, v217
v_mfma_f32_16x16x32_bf16 v[24:27], v[148:151], v[188:191], v[24:27]
ds_read_b128 v[144:147], v232 offset:20480
ds_read_b128 v[148:151], v233 offset:20480
v_mfma_f32_16x16x32_bf16 v[40:43], v[152:155], a[240:243], 0
v_cvt_pk_bf16_f32 v69, v218, v219
s_waitcnt lgkmcnt(6)
v_mfma_f32_16x16x32_bf16 v[40:43], v[156:159], a[244:247], v[40:43]
ds_read_b128 v[152:155], v232 offset:22528
ds_read_b128 v[156:159], v233 offset:22528
v_mfma_f32_16x16x32_bf16 v[40:43], v[160:163], a[248:251], v[40:43]
v_exp_f32 v221, v21
v_mfma_f32_16x16x32_bf16 v[40:43], v[164:167], a[252:255], v[40:43]
v_cvt_pk_bf16_f32 v70, v220, v221
s_waitcnt lgkmcnt(5)
v_mfma_f32_16x16x32_bf16 v[40:43], v[168:171], v[184:187], v[40:43]
v_exp_f32 v222, v22
v_mfma_f32_16x16x32_bf16 v[40:43], v[172:175], v[188:191], v[40:43]
v_exp_f32 v223, v23
v_mfma_f32_16x16x32_bf16 v[56:59], v[176:179], a[240:243], 0
v_cvt_pk_bf16_f32 v71, v222, v223
s_waitcnt lgkmcnt(2)
v_mfma_f32_16x16x32_bf16 v[56:59], v[180:183], a[244:247], v[56:59]
v_add_f32 v216, v216, v217
v_add_f32 v220, v220, v221
v_mfma_f32_16x16x32_bf16 v[56:59], v[144:147], a[248:251], v[56:59]
v_add_f32 v218, v218, v219
v_add_f32 v222, v222, v223
v_mfma_f32_16x16x32_bf16 v[56:59], v[148:151], a[252:255], v[56:59]
v_add_f32 v225, v216, v218
s_waitcnt lgkmcnt(0)
v_mfma_f32_16x16x32_bf16 v[56:59], v[152:155], v[184:187], v[56:59]
v_exp_f32 v216, v36
v_mfma_f32_16x16x32_bf16 v[56:59], v[156:159], v[188:191], v[56:59]
v_exp_f32 v217, v37
v_exp_f32 v218, v38
v_exp_f32 v219, v39
v_add_f32 v225, v225, v220
v_add_f32 v225, v225, v222
v_exp_f32 v220, v52
v_exp_f32 v221, v53
v_exp_f32 v222, v54
v_exp_f32 v223, v55
v_cvt_pk_bf16_f32 v84, v216, v217
v_cvt_pk_bf16_f32 v85, v218, v219
v_add_f32 v216, v216, v217
v_add_f32 v218, v218, v219
v_add_f32 v225, v225, v216
v_add_f32 v225, v225, v218
v_cvt_pk_bf16_f32 v86, v220, v221
v_cvt_pk_bf16_f32 v87, v222, v223
v_add_f32 v220, v220, v221
v_add_f32 v222, v222, v223
v_add_f32 v225, v225, v220
v_add_f32 v225, v225, v222
v_max3_f32 v250, v8, v9, v10
v_max3_f32 v251, v40, v41, v42
v_max3_f32 v250, v250, v11, v24
v_max3_f32 v251, v251, v43, v56
v_max3_f32 v250, v250, v25, v26
v_max3_f32 v251, v251, v57, v58
v_max3_f32 v250, v250, v27, v59
v_max_f32 v250, v250, v251
v_mov_b32 v251, v250
s_nop 1
v_permlane16_swap_b32 v250, v251
v_max_f32 v250, v250, v251
v_mov_b32 v251, v250
s_nop 1
v_permlane32_swap_b32 v250, v251
v_max_f32 v250, v250, v251
v_sub_f32 v136, 0, v250
v_sub_f32 v137, 0, v250
v_sub_f32 v138, 0, v250
v_sub_f32 v139, 0, v250
v_sub_f32 v8, v8, v250
v_sub_f32 v9, v9, v250
v_sub_f32 v10, v10, v250
v_sub_f32 v11, v11, v250
v_sub_f32 v24, v24, v250
v_sub_f32 v25, v25, v250
v_sub_f32 v26, v26, v250
v_sub_f32 v27, v27, v250
v_sub_f32 v40, v40, v250
v_sub_f32 v41, v41, v250
v_sub_f32 v42, v42, v250
v_sub_f32 v43, v43, v250
v_sub_f32 v56, v56, v250
v_sub_f32 v57, v57, v250
v_sub_f32 v58, v58, v250
v_sub_f32 v59, v59, v250
s_mov_b32 s90, 24576
s_add_u32 m0, s24, 24576
s_nop 0
buffer_load_dwordx4 v244, s[12:15], s90 offen lds
s_add_u32 m0, s24, 25600
s_nop 0
buffer_load_dwordx4 v245, s[12:15], s90 offen lds
s_add_u32 m0, s24, 26496
s_nop 0
buffer_load_dwordx4 v244, s[12:15], s90 offen offset:128 lds
s_add_u32 m0, s24, 27520
s_nop 0
buffer_load_dwordx4 v245, s[12:15], s90 offen offset:128 lds
s_add_u32 m0, s24, 28416
s_nop 0
buffer_load_dwordx4 v244, s[12:15], s90 offen offset:256 lds
s_add_u32 m0, s24, 29440
s_nop 0
buffer_load_dwordx4 v245, s[12:15], s90 offen offset:256 lds
s_waitcnt vmcnt(16)
v_add_u32 v248, s24, v232
v_add_u32 v248, 122880, v248
v_add_u32 v249, s24, v233
v_add_u32 v249, 122880, v249
ds_read_b128 v[96:99], v248 offset:0
ds_read_b128 v[100:103], v249 offset:0
ds_read_b128 v[144:147], v232 offset:0
ds_read_b128 v[148:151], v233 offset:0
ds_read_b128 v[152:155], v232 offset:2048
ds_read_b128 v[156:159], v233 offset:2048
ds_read_b128 v[160:163], v232 offset:4096
ds_read_b128 v[164:167], v233 offset:4096
ds_read_b128 v[168:171], v232 offset:6144
ds_read_b128 v[172:175], v233 offset:6144
ds_read_b128 v[176:179], v232 offset:8192
ds_read_b128 v[180:183], v233 offset:8192
s_waitcnt vmcnt(14)
ds_read_b128 v[104:107], v248 offset:2048
ds_read_b128 v[108:111], v249 offset:2048
s_waitcnt lgkmcnt(13)
v_lshlrev_b32 v120, 16, v96
v_and_b32 v121, 0xffff0000, v96
v_lshlrev_b32 v122, 16, v97
v_and_b32 v123, 0xffff0000, v97
v_lshlrev_b32 v124, 16, v98
v_and_b32 v125, 0xffff0000, v98
v_lshlrev_b32 v126, 16, v99
v_and_b32 v127, 0xffff0000, v99
v_pk_mul_f32 v[120:121], v[120:121], s[94:95]
v_pk_mul_f32 v[122:123], v[122:123], s[94:95]
v_pk_mul_f32 v[124:125], v[124:125], s[94:95]
v_pk_mul_f32 v[126:127], v[126:127], s[94:95]
v_cvt_pk_bf16_f32 v192, v120, v121
v_cvt_pk_bf16_f32 v193, v122, v123
v_cvt_pk_bf16_f32 v194, v124, v125
v_cvt_pk_bf16_f32 v195, v126, v127
s_waitcnt lgkmcnt(12)
v_lshlrev_b32 v120, 16, v100
v_and_b32 v121, 0xffff0000, v100
v_lshlrev_b32 v122, 16, v101
v_and_b32 v123, 0xffff0000, v101
v_lshlrev_b32 v124, 16, v102
v_and_b32 v125, 0xffff0000, v102
v_lshlrev_b32 v126, 16, v103
v_and_b32 v127, 0xffff0000, v103
v_pk_mul_f32 v[120:121], v[120:121], s[94:95]
v_pk_mul_f32 v[122:123], v[122:123], s[94:95]
v_pk_mul_f32 v[124:125], v[124:125], s[94:95]
v_pk_mul_f32 v[126:127], v[126:127], s[94:95]
v_cvt_pk_bf16_f32 v196, v120, v121
v_cvt_pk_bf16_f32 v197, v122, v123
v_cvt_pk_bf16_f32 v198, v124, v125
v_cvt_pk_bf16_f32 v199, v126, v127
s_waitcnt vmcnt(12)
ds_read_b128 v[112:115], v248 offset:4096
ds_read_b128 v[116:119], v249 offset:4096
s_waitcnt lgkmcnt(3)
v_lshlrev_b32 v120, 16, v104
v_and_b32 v121, 0xffff0000, v104
v_lshlrev_b32 v122, 16, v105
v_and_b32 v123, 0xffff0000, v105
v_lshlrev_b32 v124, 16, v106
v_and_b32 v125, 0xffff0000, v106
v_lshlrev_b32 v126, 16, v107
v_and_b32 v127, 0xffff0000, v107
v_pk_mul_f32 v[120:121], v[120:121], s[94:95]
v_pk_mul_f32 v[122:123], v[122:123], s[94:95]
v_pk_mul_f32 v[124:125], v[124:125], s[94:95]
v_pk_mul_f32 v[126:127], v[126:127], s[94:95]
v_cvt_pk_bf16_f32 v200, v120, v121
v_cvt_pk_bf16_f32 v201, v122, v123
v_cvt_pk_bf16_f32 v202, v124, v125
v_cvt_pk_bf16_f32 v203, v126, v127
s_waitcnt lgkmcnt(2)
v_lshlrev_b32 v120, 16, v108
v_and_b32 v121, 0xffff0000, v108
v_lshlrev_b32 v122, 16, v109
v_and_b32 v123, 0xffff0000, v109
v_lshlrev_b32 v124, 16, v110
v_and_b32 v125, 0xffff0000, v110
v_lshlrev_b32 v126, 16, v111
v_and_b32 v127, 0xffff0000, v111
v_pk_mul_f32 v[120:121], v[120:121], s[94:95]
v_pk_mul_f32 v[122:123], v[122:123], s[94:95]
v_pk_mul_f32 v[124:125], v[124:125], s[94:95]
v_pk_mul_f32 v[126:127], v[126:127], s[94:95]
v_cvt_pk_bf16_f32 v204, v120, v121
v_cvt_pk_bf16_f32 v205, v122, v123
v_cvt_pk_bf16_f32 v206, v124, v125
v_cvt_pk_bf16_f32 v207, v126, v127
s_waitcnt lgkmcnt(1)
v_lshlrev_b32 v120, 16, v112
v_and_b32 v121, 0xffff0000, v112
v_lshlrev_b32 v122, 16, v113
v_and_b32 v123, 0xffff0000, v113
v_lshlrev_b32 v124, 16, v114
v_and_b32 v125, 0xffff0000, v114
v_lshlrev_b32 v126, 16, v115
v_and_b32 v127, 0xffff0000, v115
v_pk_mul_f32 v[120:121], v[120:121], s[94:95]
v_pk_mul_f32 v[122:123], v[122:123], s[94:95]
v_pk_mul_f32 v[124:125], v[124:125], s[94:95]
v_pk_mul_f32 v[126:127], v[126:127], s[94:95]
v_cvt_pk_bf16_f32 v208, v120, v121
v_cvt_pk_bf16_f32 v209, v122, v123
v_cvt_pk_bf16_f32 v210, v124, v125
v_cvt_pk_bf16_f32 v211, v126, v127
s_waitcnt lgkmcnt(0)
v_lshlrev_b32 v120, 16, v116
v_and_b32 v121, 0xffff0000, v116
v_lshlrev_b32 v122, 16, v117
v_and_b32 v123, 0xffff0000, v117
v_lshlrev_b32 v124, 16, v118
v_and_b32 v125, 0xffff0000, v118
v_lshlrev_b32 v126, 16, v119
v_and_b32 v127, 0xffff0000, v119
v_pk_mul_f32 v[120:121], v[120:121], s[94:95]
v_pk_mul_f32 v[122:123], v[122:123], s[94:95]
v_pk_mul_f32 v[124:125], v[124:125], s[94:95]
v_pk_mul_f32 v[126:127], v[126:127], s[94:95]
v_cvt_pk_bf16_f32 v212, v120, v121
v_cvt_pk_bf16_f32 v213, v122, v123
v_cvt_pk_bf16_f32 v214, v124, v125
v_cvt_pk_bf16_f32 v215, v126, v127
s_mov_b32 s90, 49152
s_add_u32 m0, s24, 49152
s_nop 0
buffer_load_dwordx4 v244, s[12:15], s90 offen lds
s_add_u32 m0, s24, 50176
s_nop 0
buffer_load_dwordx4 v245, s[12:15], s90 offen lds
s_add_u32 m0, s24, 51072
s_nop 0
buffer_load_dwordx4 v244, s[12:15], s90 offen offset:128 lds
s_add_u32 m0, s24, 52096
s_nop 0
buffer_load_dwordx4 v245, s[12:15], s90 offen offset:128 lds
s_add_u32 m0, s24, 52992
s_nop 0
buffer_load_dwordx4 v244, s[12:15], s90 offen offset:256 lds
s_add_u32 m0, s24, 54016
s_nop 0
buffer_load_dwordx4 v245, s[12:15], s90 offen offset:256 lds
s_nop 0
s_nop 1
v_mfma_f32_16x16x32_bf16 v[12:15], v[144:147], v[192:195], 0
v_exp_f32 v216, v8
v_mfma_f32_16x16x32_bf16 v[12:15], v[148:151], v[196:199], v[12:15]
ds_read_b128 v[144:147], v232 offset:10240
ds_read_b128 v[148:151], v233 offset:10240
v_mfma_f32_16x16x32_bf16 v[12:15], v[152:155], v[200:203], v[12:15]
v_exp_f32 v217, v9
v_mfma_f32_16x16x32_bf16 v[12:15], v[156:159], v[204:207], v[12:15]
ds_read_b128 v[152:155], v232 offset:12288
ds_read_b128 v[156:159], v233 offset:12288
v_mfma_f32_16x16x32_bf16 v[12:15], v[160:163], v[208:211], v[12:15]
v_exp_f32 v218, v10
v_mfma_f32_16x16x32_bf16 v[12:15], v[164:167], v[212:215], v[12:15]
ds_read_b128 v[160:163], v232 offset:14336
ds_read_b128 v[164:167], v233 offset:14336
v_mfma_f32_16x16x32_bf16 v[28:31], v[168:171], v[192:195], 0
v_exp_f32 v219, v11
v_mfma_f32_16x16x32_bf16 v[28:31], v[172:175], v[196:199], v[28:31]
ds_read_b128 v[168:171], v232 offset:16384
ds_read_b128 v[172:175], v233 offset:16384
v_mfma_f32_16x16x32_bf16 v[28:31], v[176:179], v[200:203], v[28:31]
v_exp_f32 v220, v24
v_mfma_f32_16x16x32_bf16 v[28:31], v[180:183], v[204:207], v[28:31]
ds_read_b128 v[176:179], v232 offset:18432
s_waitcnt lgkmcnt(6)
v_mfma_f32_16x16x32_bf16 v[28:31], v[144:147], v[208:211], v[28:31]
ds_read_b128 v[180:183], v233 offset:18432
v_cvt_pk_bf16_f32 v72, v216, v217
v_mfma_f32_16x16x32_bf16 v[28:31], v[148:151], v[212:215], v[28:31]
ds_read_b128 v[144:147], v232 offset:20480
ds_read_b128 v[148:151], v233 offset:20480
v_mfma_f32_16x16x32_bf16 v[44:47], v[152:155], v[192:195], 0
v_cvt_pk_bf16_f32 v73, v218, v219
s_waitcnt lgkmcnt(6)
v_mfma_f32_16x16x32_bf16 v[44:47], v[156:159], v[196:199], v[44:47]
ds_read_b128 v[152:155], v232 offset:22528
ds_read_b128 v[156:159], v233 offset:22528
v_mfma_f32_16x16x32_bf16 v[44:47], v[160:163], v[200:203], v[44:47]
v_exp_f32 v221, v25
v_mfma_f32_16x16x32_bf16 v[44:47], v[164:167], v[204:207], v[44:47]
v_cvt_pk_bf16_f32 v74, v220, v221
s_waitcnt lgkmcnt(5)
v_mfma_f32_16x16x32_bf16 v[44:47], v[168:171], v[208:211], v[44:47]
v_exp_f32 v222, v26
v_mfma_f32_16x16x32_bf16 v[44:47], v[172:175], v[212:215], v[44:47]
v_exp_f32 v223, v27
v_mfma_f32_16x16x32_bf16 v[60:63], v[176:179], v[192:195], 0
v_cvt_pk_bf16_f32 v75, v222, v223
s_waitcnt lgkmcnt(2)
v_mfma_f32_16x16x32_bf16 v[60:63], v[180:183], v[196:199], v[60:63]
v_add_f32 v216, v216, v217
v_add_f32 v220, v220, v221
v_mfma_f32_16x16x32_bf16 v[60:63], v[144:147], v[200:203], v[60:63]
v_add_f32 v218, v218, v219
v_add_f32 v222, v222, v223
v_mfma_f32_16x16x32_bf16 v[60:63], v[148:151], v[204:207], v[60:63]
v_add_f32 v226, v216, v218
s_waitcnt lgkmcnt(0)
v_mfma_f32_16x16x32_bf16 v[60:63], v[152:155], v[208:211], v[60:63]
v_exp_f32 v216, v40
v_mfma_f32_16x16x32_bf16 v[60:63], v[156:159], v[212:215], v[60:63]
v_exp_f32 v217, v41
v_exp_f32 v218, v42
v_exp_f32 v219, v43
v_add_f32 v226, v226, v220
v_add_f32 v226, v226, v222
v_exp_f32 v220, v56
v_exp_f32 v221, v57
v_exp_f32 v222, v58
v_exp_f32 v223, v59
v_cvt_pk_bf16_f32 v88, v216, v217
v_cvt_pk_bf16_f32 v89, v218, v219
v_add_f32 v216, v216, v217
v_add_f32 v218, v218, v219
v_add_f32 v226, v226, v216
v_add_f32 v226, v226, v218
v_cvt_pk_bf16_f32 v90, v220, v221
v_cvt_pk_bf16_f32 v91, v222, v223
v_add_f32 v220, v220, v221
v_add_f32 v222, v222, v223
v_add_f32 v226, v226, v220
v_add_f32 v226, v226, v222
v_max3_f32 v250, v12, v13, v14
v_max3_f32 v251, v44, v45, v46
v_max3_f32 v250, v250, v15, v28
v_max3_f32 v251, v251, v47, v60
v_max3_f32 v250, v250, v29, v30
v_max3_f32 v251, v251, v61, v62
v_max3_f32 v250, v250, v31, v63
v_max_f32 v250, v250, v251
v_mov_b32 v251, v250
s_nop 1
v_permlane16_swap_b32 v250, v251
v_max_f32 v250, v250, v251
v_mov_b32 v251, v250
s_nop 1
v_permlane32_swap_b32 v250, v251
v_max_f32 v250, v250, v251
v_sub_f32 v140, 0, v250
v_sub_f32 v141, 0, v250
v_sub_f32 v142, 0, v250
v_sub_f32 v143, 0, v250
v_sub_f32 v12, v12, v250
v_sub_f32 v13, v13, v250
v_sub_f32 v14, v14, v250
v_sub_f32 v15, v15, v250
v_sub_f32 v28, v28, v250
v_sub_f32 v29, v29, v250
v_sub_f32 v30, v30, v250
v_sub_f32 v31, v31, v250
v_sub_f32 v44, v44, v250
v_sub_f32 v45, v45, v250
v_sub_f32 v46, v46, v250
v_sub_f32 v47, v47, v250
v_sub_f32 v60, v60, v250
v_sub_f32 v61, v61, v250
v_sub_f32 v62, v62, v250
v_sub_f32 v63, v63, v250
s_mov_b32 s90, 49152
s_add_u32 m0, s24, 98304
s_nop 0
buffer_load_dwordx4 v246, s[16:19], s90 offen lds
s_add_u32 m0, s24, 96256
s_nop 0
buffer_load_dwordx4 v246, s[16:19], s90 offen offset:3072 lds
s_add_u32 m0, s24, 100224
s_nop 0
buffer_load_dwordx4 v246, s[16:19], s90 offen offset:128 lds
s_add_u32 m0, s24, 98176
s_nop 0
buffer_load_dwordx4 v246, s[16:19], s90 offen offset:3200 lds
s_add_u32 m0, s24, 102144
s_nop 0
buffer_load_dwordx4 v246, s[16:19], s90 offen offset:256 lds
s_add_u32 m0, s24, 100096
s_nop 0
buffer_load_dwordx4 v246, s[16:19], s90 offen offset:3328 lds
s_mov_b32 s25, 73728
s_waitcnt vmcnt(12) lgkmcnt(0)
s_barrier
ds_read_b128 v[144:147], v232 offset:24576
ds_read_b128 v[148:151], v233 offset:24576
ds_read_b128 v[152:155], v232 offset:26624
ds_read_b128 v[156:159], v233 offset:26624
ds_read_b128 v[176:179], v232 offset:28672
ds_read_b128 v[180:183], v233 offset:28672
v_exp_f32 v216, v12
v_exp_f32 v217, v13
v_exp_f32 v218, v14
v_exp_f32 v219, v15
v_exp_f32 v220, v28
v_exp_f32 v221, v29
v_exp_f32 v222, v30
v_exp_f32 v223, v31
v_cvt_pk_bf16_f32 v76, v216, v217
v_cvt_pk_bf16_f32 v77, v218, v219
v_add_f32 v216, v216, v217
v_add_f32 v218, v218, v219
v_add_f32 v227, v216, v218
v_exp_f32 v216, v44
v_exp_f32 v217, v45
v_exp_f32 v218, v46
v_exp_f32 v219, v47
v_cvt_pk_bf16_f32 v78, v220, v221
v_cvt_pk_bf16_f32 v79, v222, v223
v_add_f32 v220, v220, v221
v_add_f32 v222, v222, v223
v_add_f32 v227, v227, v220
v_add_f32 v227, v227, v222
v_exp_f32 v220, v60
v_exp_f32 v221, v61
v_exp_f32 v222, v62
v_exp_f32 v223, v63
v_cvt_pk_bf16_f32 v92, v216, v217
v_cvt_pk_bf16_f32 v93, v218, v219
v_add_f32 v216, v216, v217
v_add_f32 v218, v218, v219
v_add_f32 v227, v227, v216
v_add_f32 v227, v227, v218
v_cvt_pk_bf16_f32 v94, v220, v221
v_cvt_pk_bf16_f32 v95, v222, v223
v_add_f32 v220, v220, v221
v_add_f32 v222, v222, v223
v_add_f32 v227, v227, v220
v_add_f32 v227, v227, v222
s_waitcnt lgkmcnt(2)
s_mov_b32 s26, 5
.p2align 6
L_loop:
v_mfma_f32_16x16x32_bf16 v[0:3], v[144:147], a[192:195], v[128:131]
v_add_f32 v228, v228, v224
v_add_f32 v229, v229, v225
v_mfma_f32_16x16x32_bf16 v[0:3], v[148:151], a[196:199], v[0:3]
v_add_f32 v230, v230, v226
v_add_f32 v231, v231, v227
v_mfma_f32_16x16x32_bf16 v[0:3], v[152:155], a[200:203], v[0:3]
v_mfma_f32_16x16x32_bf16 v[0:3], v[156:159], a[204:207], v[0:3]
s_add_u32 m0, s24, 0
s_waitcnt lgkmcnt(0)
v_mfma_f32_16x16x32_bf16 v[0:3], v[176:179], a[208:211], v[0:3]
buffer_load_dwordx4 v244, s[12:15], s25 offen lds
v_mfma_f32_16x16x32_bf16 v[0:3], v[180:183], a[212:215], v[0:3]
v_mfma_f32_16x16x32_bf16 v[4:7], v[180:183], a[236:239], v[132:135]
v_mfma_f32_16x16x32_bf16 v[4:7], v[176:179], a[232:235], v[4:7]
ds_read_b128 v[160:163], v232 offset:30720
v_mfma_f32_16x16x32_bf16 v[4:7], v[156:159], a[228:231], v[4:7]
ds_read_b128 v[164:167], v233 offset:30720
v_mfma_f32_16x16x32_bf16 v[4:7], v[152:155], a[224:227], v[4:7]
ds_read_b128 v[168:171], v232 offset:32768
v_mfma_f32_16x16x32_bf16 v[4:7], v[148:151], a[220:223], v[4:7]
v_exp_f32 v216, v0
v_mfma_f32_16x16x32_bf16 v[4:7], v[144:147], a[216:219], v[4:7]
ds_read_b128 v[172:175], v233 offset:32768
v_mfma_f32_16x16x32_bf16 v[8:11], v[144:147], a[240:243], v[136:139]
v_exp_f32 v217, v1
v_mfma_f32_16x16x32_bf16 v[8:11], v[148:151], a[244:247], v[8:11]
v_cvt_pk_bf16_f32 v96, v216, v217
v_add_f32 v216, v216, v217
v_mfma_f32_16x16x32_bf16 v[8:11], v[152:155], a[248:251], v[8:11]
v_exp_f32 v218, v2
v_mfma_f32_16x16x32_bf16 v[8:11], v[156:159], a[252:255], v[8:11]
v_exp_f32 v219, v3
v_mfma_f32_16x16x32_bf16 v[8:11], v[176:179], v[184:187], v[8:11]
v_cvt_pk_bf16_f32 v97, v218, v219
v_add_f32 v218, v218, v219
v_mfma_f32_16x16x32_bf16 v[8:11], v[180:183], v[188:191], v[8:11]
s_add_u32 m0, s24, 122880
v_add_f32 v224, v216, v218
v_mfma_f32_16x16x32_bf16 v[12:15], v[180:183], v[212:215], v[140:143]
ds_read_b128 v[180:183], v232 offset:34816
v_mfma_f32_16x16x32_bf16 v[12:15], v[176:179], v[208:211], v[12:15]
ds_read_b128 v[176:179], v233 offset:34816
v_mfma_f32_16x16x32_bf16 v[12:15], v[156:159], v[204:207], v[12:15]
buffer_load_dwordx4 v246, s[16:19], s25 offen lds
v_mfma_f32_16x16x32_bf16 v[12:15], v[152:155], v[200:203], v[12:15]
v_exp_f32 v220, v4
v_mfma_f32_16x16x32_bf16 v[12:15], v[148:151], v[196:199], v[12:15]
v_exp_f32 v221, v5
v_mfma_f32_16x16x32_bf16 v[12:15], v[144:147], v[192:195], v[12:15]
v_cvt_pk_bf16_f32 v100, v220, v221
s_waitcnt lgkmcnt(2)
v_mfma_f32_16x16x32_bf16 v[16:19], v[160:163], a[192:195], v[128:131]
v_add_f32 v220, v220, v221
v_mfma_f32_16x16x32_bf16 v[16:19], v[164:167], a[196:199], v[16:19]
v_exp_f32 v222, v6
v_mfma_f32_16x16x32_bf16 v[16:19], v[168:171], a[200:203], v[16:19]
v_exp_f32 v223, v7
v_mfma_f32_16x16x32_bf16 v[16:19], v[172:175], a[204:207], v[16:19]
v_cvt_pk_bf16_f32 v101, v222, v223
s_waitcnt lgkmcnt(0)
v_mfma_f32_16x16x32_bf16 v[16:19], v[180:183], a[208:211], v[16:19]
v_add_f32 v222, v222, v223
v_mfma_f32_16x16x32_bf16 v[16:19], v[176:179], a[212:215], v[16:19]
v_add_f32 v225, v220, v222
v_mfma_f32_16x16x32_bf16 v[20:23], v[176:179], a[236:239], v[132:135]
v_exp_f32 v216, v8
v_mfma_f32_16x16x32_bf16 v[20:23], v[180:183], a[232:235], v[20:23]
ds_read_b128 v[144:147], v232 offset:36864
s_add_u32 m0, s24, 1024
v_mfma_f32_16x16x32_bf16 v[20:23], v[172:175], a[228:231], v[20:23]
buffer_load_dwordx4 v245, s[12:15], s25 offen lds
v_mfma_f32_16x16x32_bf16 v[20:23], v[168:171], a[224:227], v[20:23]
ds_read_b128 v[148:151], v233 offset:36864
v_mfma_f32_16x16x32_bf16 v[20:23], v[164:167], a[220:223], v[20:23]
ds_read_b128 v[152:155], v232 offset:38912
v_mfma_f32_16x16x32_bf16 v[20:23], v[160:163], a[216:219], v[20:23]
v_exp_f32 v217, v9
v_mfma_f32_16x16x32_bf16 v[24:27], v[160:163], a[240:243], v[136:139]
ds_read_b128 v[156:159], v233 offset:38912
v_cvt_pk_bf16_f32 v104, v216, v217
v_mfma_f32_16x16x32_bf16 v[24:27], v[164:167], a[244:247], v[24:27]
v_add_f32 v216, v216, v217
v_mfma_f32_16x16x32_bf16 v[24:27], v[168:171], a[248:251], v[24:27]
v_exp_f32 v218, v10
v_mfma_f32_16x16x32_bf16 v[24:27], v[172:175], a[252:255], v[24:27]
v_exp_f32 v219, v11
v_mfma_f32_16x16x32_bf16 v[24:27], v[180:183], v[184:187], v[24:27]
v_cvt_pk_bf16_f32 v105, v218, v219
v_add_f32 v218, v218, v219
v_mfma_f32_16x16x32_bf16 v[24:27], v[176:179], v[188:191], v[24:27]
v_add_f32 v226, v216, v218
v_mfma_f32_16x16x32_bf16 v[28:31], v[176:179], v[212:215], v[140:143]
ds_read_b128 v[176:179], v232 offset:40960
v_mfma_f32_16x16x32_bf16 v[28:31], v[180:183], v[208:211], v[28:31]
ds_read_b128 v[180:183], v233 offset:40960
v_mfma_f32_16x16x32_bf16 v[28:31], v[172:175], v[204:207], v[28:31]
v_exp_f32 v220, v12
v_mfma_f32_16x16x32_bf16 v[28:31], v[168:171], v[200:203], v[28:31]
s_add_u32 m0, s24, 120832
v_mfma_f32_16x16x32_bf16 v[28:31], v[164:167], v[196:199], v[28:31]
v_exp_f32 v221, v13
v_mfma_f32_16x16x32_bf16 v[28:31], v[160:163], v[192:195], v[28:31]
v_cvt_pk_bf16_f32 v108, v220, v221
s_waitcnt lgkmcnt(2)
v_mfma_f32_16x16x32_bf16 v[32:35], v[144:147], a[192:195], v[128:131]
buffer_load_dwordx4 v246, s[16:19], s25 offen offset:3072 lds
v_mfma_f32_16x16x32_bf16 v[32:35], v[148:151], a[196:199], v[32:35]
v_exp_f32 v222, v14
v_mfma_f32_16x16x32_bf16 v[32:35], v[152:155], a[200:203], v[32:35]
v_add_f32 v220, v220, v221
v_mfma_f32_16x16x32_bf16 v[32:35], v[156:159], a[204:207], v[32:35]
s_waitcnt lgkmcnt(0)
v_mfma_f32_16x16x32_bf16 v[32:35], v[176:179], a[208:211], v[32:35]
v_exp_f32 v223, v15
v_mfma_f32_16x16x32_bf16 v[32:35], v[180:183], a[212:215], v[32:35]
v_cvt_pk_bf16_f32 v109, v222, v223
v_add_f32 v222, v222, v223
v_mfma_f32_16x16x32_bf16 v[36:39], v[180:183], a[236:239], v[132:135]
v_exp_f32 v216, v16
v_mfma_f32_16x16x32_bf16 v[36:39], v[176:179], a[232:235], v[36:39]
ds_read_b128 v[160:163], v232 offset:43008
v_add_f32 v227, v220, v222
v_mfma_f32_16x16x32_bf16 v[36:39], v[156:159], a[228:231], v[36:39]
ds_read_b128 v[164:167], v233 offset:43008
v_mfma_f32_16x16x32_bf16 v[36:39], v[152:155], a[224:227], v[36:39]
v_exp_f32 v217, v17
v_mfma_f32_16x16x32_bf16 v[36:39], v[148:151], a[220:223], v[36:39]
ds_read_b128 v[168:171], v232 offset:45056
v_cvt_pk_bf16_f32 v98, v216, v217
v_mfma_f32_16x16x32_bf16 v[36:39], v[144:147], a[216:219], v[36:39]
ds_read_b128 v[172:175], v233 offset:45056
s_add_u32 m0, s24, 1920
v_mfma_f32_16x16x32_bf16 v[40:43], v[144:147], a[240:243], v[136:139]
v_exp_f32 v218, v18
v_mfma_f32_16x16x32_bf16 v[40:43], v[148:151], a[244:247], v[40:43]
buffer_load_dwordx4 v244, s[12:15], s25 offen offset:128 lds
v_mfma_f32_16x16x32_bf16 v[40:43], v[152:155], a[248:251], v[40:43]
v_add_f32 v216, v216, v217
v_mfma_f32_16x16x32_bf16 v[40:43], v[156:159], a[252:255], v[40:43]
v_exp_f32 v219, v19
v_mfma_f32_16x16x32_bf16 v[40:43], v[176:179], v[184:187], v[40:43]
v_cvt_pk_bf16_f32 v99, v218, v219
v_add_f32 v218, v218, v219
v_mfma_f32_16x16x32_bf16 v[40:43], v[180:183], v[188:191], v[40:43]
v_exp_f32 v220, v20
v_mfma_f32_16x16x32_bf16 v[44:47], v[180:183], v[212:215], v[140:143]
ds_read_b128 v[180:183], v232 offset:47104
v_add_f32 v224, v224, v216
v_mfma_f32_16x16x32_bf16 v[44:47], v[176:179], v[208:211], v[44:47]
ds_read_b128 v[176:179], v233 offset:47104
v_add_f32 v224, v224, v218
v_mfma_f32_16x16x32_bf16 v[44:47], v[156:159], v[204:207], v[44:47]
v_exp_f32 v221, v21
v_mfma_f32_16x16x32_bf16 v[44:47], v[152:155], v[200:203], v[44:47]
v_cvt_pk_bf16_f32 v102, v220, v221
v_add_f32 v220, v220, v221
v_mfma_f32_16x16x32_bf16 v[44:47], v[148:151], v[196:199], v[44:47]
v_add_f32 v225, v225, v220
v_mfma_f32_16x16x32_bf16 v[44:47], v[144:147], v[192:195], v[44:47]
ds_read_b64_tr_b16 v[144:145], v236 offset:0
s_waitcnt lgkmcnt(3)
v_mfma_f32_16x16x32_bf16 v[48:51], v[160:163], a[192:195], v[128:131]
v_exp_f32 v222, v22
v_mfma_f32_16x16x32_bf16 v[48:51], v[164:167], a[196:199], v[48:51]
ds_read_b64_tr_b16 v[146:147], v236 offset:6144
s_add_u32 m0, s24, 124800
v_mfma_f32_16x16x32_bf16 v[48:51], v[168:171], a[200:203], v[48:51]
v_exp_f32 v223, v23
v_mfma_f32_16x16x32_bf16 v[48:51], v[172:175], a[204:207], v[48:51]
v_cvt_pk_bf16_f32 v103, v222, v223
s_waitcnt lgkmcnt(2)
v_mfma_f32_16x16x32_bf16 v[48:51], v[180:183], a[208:211], v[48:51]
v_exp_f32 v216, v24
v_mfma_f32_16x16x32_bf16 v[48:51], v[176:179], a[212:215], v[48:51]
buffer_load_dwordx4 v246, s[16:19], s25 offen offset:128 lds
v_mfma_f32_16x16x32_bf16 v[52:55], v[176:179], a[236:239], v[132:135]
ds_read_b64_tr_b16 v[148:149], v236 offset:12288
v_add_f32 v222, v222, v223
v_mfma_f32_16x16x32_bf16 v[52:55], v[180:183], a[232:235], v[52:55]
v_exp_f32 v217, v25
v_mfma_f32_16x16x32_bf16 v[52:55], v[172:175], a[228:231], v[52:55]
ds_read_b64_tr_b16 v[150:151], v236 offset:18432
v_add_f32 v225, v225, v222
v_mfma_f32_16x16x32_bf16 v[52:55], v[168:171], a[224:227], v[52:55]
ds_read_b64_tr_b16 v[152:153], v237 offset:0
v_cvt_pk_bf16_f32 v106, v216, v217
v_mfma_f32_16x16x32_bf16 v[52:55], v[164:167], a[220:223], v[52:55]
v_exp_f32 v218, v26
v_mfma_f32_16x16x32_bf16 v[52:55], v[160:163], a[216:219], v[52:55]
ds_read_b64_tr_b16 v[154:155], v237 offset:6144
v_add_f32 v216, v216, v217
v_mfma_f32_16x16x32_bf16 v[56:59], v[160:163], a[240:243], v[136:139]
ds_read_b64_tr_b16 v[156:157], v237 offset:12288
v_add_f32 v226, v226, v216
v_mfma_f32_16x16x32_bf16 v[56:59], v[164:167], a[244:247], v[56:59]
v_exp_f32 v219, v27
v_mfma_f32_16x16x32_bf16 v[56:59], v[168:171], a[248:251], v[56:59]
ds_read_b64_tr_b16 v[158:159], v237 offset:18432
v_cvt_pk_bf16_f32 v107, v218, v219
v_mfma_f32_16x16x32_bf16 v[56:59], v[172:175], a[252:255], v[56:59]
v_exp_f32 v220, v28
v_mfma_f32_16x16x32_bf16 v[56:59], v[180:183], v[184:187], v[56:59]
s_add_u32 m0, s24, 2944
v_add_f32 v218, v218, v219
v_mfma_f32_16x16x32_bf16 v[56:59], v[176:179], v[188:191], v[56:59]
buffer_load_dwordx4 v245, s[12:15], s25 offen offset:128 lds
v_mfma_f32_16x16x32_bf16 v[60:63], v[176:179], v[212:215], v[140:143]
v_exp_f32 v221, v29
v_mfma_f32_16x16x32_bf16 v[60:63], v[180:183], v[208:211], v[60:63]
ds_read_b64_tr_b16 v[176:177], v238 offset:0
v_add_f32 v226, v226, v218
v_mfma_f32_16x16x32_bf16 v[60:63], v[172:175], v[204:207], v[60:63]
ds_read_b64_tr_b16 v[178:179], v238 offset:6144
v_cvt_pk_bf16_f32 v110, v220, v221
v_mfma_f32_16x16x32_bf16 v[60:63], v[168:171], v[200:203], v[60:63]
v_exp_f32 v222, v30
v_mfma_f32_16x16x32_bf16 v[60:63], v[164:167], v[196:199], v[60:63]
ds_read_b64_tr_b16 v[180:181], v238 offset:12288
v_add_f32 v220, v220, v221
v_mfma_f32_16x16x32_bf16 v[60:63], v[160:163], v[192:195], v[60:63]
ds_read_b64_tr_b16 v[182:183], v238 offset:18432
s_waitcnt lgkmcnt(4)
v_mfma_f32_16x16x32_bf16 a[0:3], v[144:147], v[64:67], a[0:3]
v_exp_f32 v223, v31
v_mfma_f32_16x16x32_bf16 a[0:3], v[148:151], v[80:83], a[0:3]
ds_read_b64_tr_b16 v[160:161], v239 offset:0
v_cvt_pk_bf16_f32 v111, v222, v223
v_mfma_f32_16x16x32_bf16 a[4:7], v[148:151], v[84:87], a[4:7]
v_exp_f32 v216, v32
v_mfma_f32_16x16x32_bf16 a[4:7], v[144:147], v[68:71], a[4:7]
ds_read_b64_tr_b16 v[162:163], v239 offset:6144
v_add_f32 v222, v222, v223
v_mfma_f32_16x16x32_bf16 a[8:11], v[144:147], v[72:75], a[8:11]
ds_read_b64_tr_b16 v[164:165], v239 offset:12288
v_add_f32 v227, v227, v220
v_mfma_f32_16x16x32_bf16 a[8:11], v[148:151], v[88:91], a[8:11]
v_exp_f32 v217, v33
v_mfma_f32_16x16x32_bf16 a[12:15], v[148:151], v[92:95], a[12:15]
ds_read_b64_tr_b16 v[166:167], v239 offset:18432
s_add_u32 m0, s24, 122752
v_mfma_f32_16x16x32_bf16 a[12:15], v[144:147], v[76:79], a[12:15]
buffer_load_dwordx4 v246, s[16:19], s25 offen offset:3200 lds
v_mfma_f32_16x16x32_bf16 a[16:19], v[152:155], v[64:67], a[16:19]
v_exp_f32 v218, v34
v_mfma_f32_16x16x32_bf16 a[16:19], v[156:159], v[80:83], a[16:19]
v_add_f32 v227, v227, v222
v_cvt_pk_bf16_f32 v112, v216, v217
v_mfma_f32_16x16x32_bf16 a[20:23], v[156:159], v[84:87], a[20:23]
ds_read_b64_tr_b16 v[168:169], v236 offset:2048
v_add_f32 v216, v216, v217
v_mfma_f32_16x16x32_bf16 a[20:23], v[152:155], v[68:71], a[20:23]
v_exp_f32 v219, v35
v_mfma_f32_16x16x32_bf16 a[24:27], v[152:155], v[72:75], a[24:27]
v_cvt_pk_bf16_f32 v113, v218, v219
v_add_f32 v218, v218, v219
v_mfma_f32_16x16x32_bf16 a[24:27], v[156:159], v[88:91], a[24:27]
v_exp_f32 v220, v36
v_mfma_f32_16x16x32_bf16 a[28:31], v[156:159], v[92:95], a[28:31]
ds_read_b64_tr_b16 v[170:171], v236 offset:8192
v_add_f32 v224, v224, v216
v_mfma_f32_16x16x32_bf16 a[28:31], v[152:155], v[76:79], a[28:31]
v_add_f32 v224, v224, v218
s_waitcnt lgkmcnt(2)
v_mfma_f32_16x16x32_bf16 a[32:35], v[176:179], v[64:67], a[32:35]
v_exp_f32 v221, v37
v_mfma_f32_16x16x32_bf16 a[32:35], v[180:183], v[80:83], a[32:35]
ds_read_b64_tr_b16 v[172:173], v236 offset:14336
v_cvt_pk_bf16_f32 v116, v220, v221
v_mfma_f32_16x16x32_bf16 a[36:39], v[180:183], v[84:87], a[36:39]
ds_read_b64_tr_b16 v[174:175], v236 offset:20480
v_add_f32 v220, v220, v221
v_mfma_f32_16x16x32_bf16 a[36:39], v[176:179], v[68:71], a[36:39]
v_exp_f32 v222, v38
v_mfma_f32_16x16x32_bf16 a[40:43], v[176:179], v[72:75], a[40:43]
ds_read_b64_tr_b16 v[144:145], v237 offset:2048
s_add_u32 m0, s24, 3840
v_mfma_f32_16x16x32_bf16 a[40:43], v[180:183], v[88:91], a[40:43]
ds_read_b64_tr_b16 v[146:147], v237 offset:8192
v_add_f32 v225, v225, v220
v_mfma_f32_16x16x32_bf16 a[44:47], v[180:183], v[92:95], a[44:47]
v_exp_f32 v223, v39
v_mfma_f32_16x16x32_bf16 a[44:47], v[176:179], v[76:79], a[44:47]
ds_read_b64_tr_b16 v[148:149], v237 offset:14336
v_cvt_pk_bf16_f32 v117, v222, v223
v_mfma_f32_16x16x32_bf16 a[48:51], v[160:163], v[64:67], a[48:51]
ds_read_b64_tr_b16 v[150:151], v237 offset:20480
v_add_f32 v222, v222, v223
v_mfma_f32_16x16x32_bf16 a[48:51], v[164:167], v[80:83], a[48:51]
buffer_load_dwordx4 v244, s[12:15], s25 offen offset:256 lds
v_mfma_f32_16x16x32_bf16 a[52:55], v[164:167], v[84:87], a[52:55]
v_exp_f32 v216, v40
v_mfma_f32_16x16x32_bf16 a[52:55], v[160:163], v[68:71], a[52:55]
v_exp_f32 v217, v41
v_mfma_f32_16x16x32_bf16 a[56:59], v[160:163], v[72:75], a[56:59]
ds_read_b64_tr_b16 v[176:177], v238 offset:2048
v_add_f32 v225, v225, v222
v_mfma_f32_16x16x32_bf16 a[56:59], v[164:167], v[88:91], a[56:59]
ds_read_b64_tr_b16 v[178:179], v238 offset:8192
v_cvt_pk_bf16_f32 v120, v216, v217
v_mfma_f32_16x16x32_bf16 a[60:63], v[164:167], v[92:95], a[60:63]
v_exp_f32 v218, v42
v_mfma_f32_16x16x32_bf16 a[60:63], v[160:163], v[76:79], a[60:63]
ds_read_b64_tr_b16 v[180:181], v238 offset:14336
s_waitcnt lgkmcnt(3)
v_mfma_f32_16x16x32_bf16 a[64:67], v[168:171], v[64:67], a[64:67]
ds_read_b64_tr_b16 v[182:183], v238 offset:20480
v_add_f32 v216, v216, v217
v_mfma_f32_16x16x32_bf16 a[64:67], v[172:175], v[80:83], a[64:67]
v_exp_f32 v219, v43
v_mfma_f32_16x16x32_bf16 a[68:71], v[172:175], v[84:87], a[68:71]
ds_read_b64_tr_b16 v[160:161], v239 offset:2048
s_add_u32 m0, s24, 126720
v_mfma_f32_16x16x32_bf16 a[68:71], v[168:171], v[68:71], a[68:71]
v_exp_f32 v220, v44
v_mfma_f32_16x16x32_bf16 a[72:75], v[168:171], v[72:75], a[72:75]
buffer_load_dwordx4 v246, s[16:19], s25 offen offset:256 lds
v_mfma_f32_16x16x32_bf16 a[72:75], v[172:175], v[88:91], a[72:75]
ds_read_b64_tr_b16 v[162:163], v239 offset:8192
v_cvt_pk_bf16_f32 v121, v218, v219
v_mfma_f32_16x16x32_bf16 a[76:79], v[172:175], v[92:95], a[76:79]
v_exp_f32 v221, v45
v_mfma_f32_16x16x32_bf16 a[76:79], v[168:171], v[76:79], a[76:79]
ds_read_b64_tr_b16 v[164:165], v239 offset:14336
v_add_f32 v218, v218, v219
v_mfma_f32_16x16x32_bf16 a[80:83], v[144:147], v[64:67], a[80:83]
ds_read_b64_tr_b16 v[166:167], v239 offset:20480
v_add_f32 v226, v226, v216
v_mfma_f32_16x16x32_bf16 a[80:83], v[148:151], v[80:83], a[80:83]
v_exp_f32 v222, v46
v_mfma_f32_16x16x32_bf16 a[84:87], v[148:151], v[84:87], a[84:87]
v_add_f32 v226, v226, v218
v_cvt_pk_bf16_f32 v124, v220, v221
v_mfma_f32_16x16x32_bf16 a[84:87], v[144:147], v[68:71], a[84:87]
ds_read_b64_tr_b16 v[152:153], v236 offset:4096
v_add_f32 v220, v220, v221
v_mfma_f32_16x16x32_bf16 a[88:91], v[144:147], v[72:75], a[88:91]
v_exp_f32 v223, v47
v_mfma_f32_16x16x32_bf16 a[88:91], v[148:151], v[88:91], a[88:91]
v_cvt_pk_bf16_f32 v125, v222, v223
v_add_f32 v222, v222, v223
v_mfma_f32_16x16x32_bf16 a[92:95], v[148:151], v[92:95], a[92:95]
v_exp_f32 v216, v48
v_mfma_f32_16x16x32_bf16 a[92:95], v[144:147], v[76:79], a[92:95]
s_add_u32 m0, s24, 4864
s_waitcnt lgkmcnt(1)
v_mfma_f32_16x16x32_bf16 a[96:99], v[176:179], v[64:67], a[96:99]
buffer_load_dwordx4 v245, s[12:15], s25 offen offset:256 lds
v_mfma_f32_16x16x32_bf16 a[96:99], v[180:183], v[80:83], a[96:99]
v_exp_f32 v217, v49
v_mfma_f32_16x16x32_bf16 a[100:103], v[180:183], v[84:87], a[100:103]
ds_read_b64_tr_b16 v[154:155], v236 offset:10240
v_add_f32 v227, v227, v220
v_mfma_f32_16x16x32_bf16 a[100:103], v[176:179], v[68:71], a[100:103]
ds_read_b64_tr_b16 v[156:157], v236 offset:16384
v_add_f32 v227, v227, v222
v_mfma_f32_16x16x32_bf16 a[104:107], v[176:179], v[72:75], a[104:107]
v_exp_f32 v218, v50
v_mfma_f32_16x16x32_bf16 a[104:107], v[180:183], v[88:91], a[104:107]
ds_read_b64_tr_b16 v[158:159], v236 offset:22528
v_cvt_pk_bf16_f32 v114, v216, v217
v_mfma_f32_16x16x32_bf16 a[108:111], v[180:183], v[92:95], a[108:111]
ds_read_b64_tr_b16 v[144:145], v237 offset:4096
v_add_f32 v216, v216, v217
v_mfma_f32_16x16x32_bf16 a[108:111], v[176:179], v[76:79], a[108:111]
ds_read_b64_tr_b16 v[146:147], v237 offset:10240
v_add_f32 v224, v224, v216
v_mfma_f32_16x16x32_bf16 a[112:115], v[160:163], v[64:67], a[112:115]
ds_read_b64_tr_b16 v[148:149], v237 offset:16384
ds_read_b64_tr_b16 v[150:151], v237 offset:22528
v_mfma_f32_16x16x32_bf16 a[112:115], v[164:167], v[80:83], a[112:115]
v_exp_f32 v219, v51
v_mfma_f32_16x16x32_bf16 a[116:119], v[164:167], v[84:87], a[116:119]
v_exp_f32 v220, v52
v_mfma_f32_16x16x32_bf16 a[116:119], v[160:163], v[68:71], a[116:119]
v_cvt_pk_bf16_f32 v115, v218, v219
v_add_f32 v218, v218, v219
v_mfma_f32_16x16x32_bf16 a[120:123], v[160:163], v[72:75], a[120:123]
v_exp_f32 v221, v53
v_mfma_f32_16x16x32_bf16 a[120:123], v[164:167], v[88:91], a[120:123]
s_add_u32 m0, s24, 124672
v_add_f32 v224, v224, v218
v_mfma_f32_16x16x32_bf16 a[124:127], v[164:167], v[92:95], a[124:127]
buffer_load_dwordx4 v246, s[16:19], s25 offen offset:3328 lds
v_mfma_f32_16x16x32_bf16 a[124:127], v[160:163], v[76:79], a[124:127]
ds_read_b64_tr_b16 v[176:177], v238 offset:4096
s_waitcnt lgkmcnt(1)
v_mfma_f32_16x16x32_bf16 a[128:131], v[152:155], v[64:67], a[128:131]
v_exp_f32 v222, v54
v_mfma_f32_16x16x32_bf16 a[128:131], v[156:159], v[80:83], a[128:131]
ds_read_b64_tr_b16 v[178:179], v238 offset:10240
v_cvt_pk_bf16_f32 v118, v220, v221
v_mfma_f32_16x16x32_bf16 a[132:135], v[156:159], v[84:87], a[132:135]
v_exp_f32 v223, v55
v_mfma_f32_16x16x32_bf16 a[132:135], v[152:155], v[68:71], a[132:135]
ds_read_b64_tr_b16 v[180:181], v238 offset:16384
v_add_f32 v220, v220, v221
v_mfma_f32_16x16x32_bf16 a[136:139], v[152:155], v[72:75], a[136:139]
v_exp_f32 v216, v56
v_mfma_f32_16x16x32_bf16 a[136:139], v[156:159], v[88:91], a[136:139]
ds_read_b64_tr_b16 v[182:183], v238 offset:22528
v_cvt_pk_bf16_f32 v119, v222, v223
v_mfma_f32_16x16x32_bf16 a[140:143], v[156:159], v[92:95], a[140:143]
ds_read_b64_tr_b16 v[168:169], v239 offset:4096
v_add_f32 v222, v222, v223
v_mfma_f32_16x16x32_bf16 a[140:143], v[152:155], v[76:79], a[140:143]
ds_read_b64_tr_b16 v[170:171], v239 offset:10240
v_add_f32 v225, v225, v220
v_mfma_f32_16x16x32_bf16 a[144:147], v[144:147], v[64:67], a[144:147]
ds_read_b64_tr_b16 v[172:173], v239 offset:16384
ds_read_b64_tr_b16 v[174:175], v239 offset:22528
v_mfma_f32_16x16x32_bf16 a[144:147], v[148:151], v[80:83], a[144:147]
v_exp_f32 v217, v57
v_mfma_f32_16x16x32_bf16 a[148:151], v[148:151], v[84:87], a[148:151]
v_exp_f32 v218, v58
v_mfma_f32_16x16x32_bf16 a[148:151], v[144:147], v[68:71], a[148:151]
v_add_f32 v225, v225, v222
v_cvt_pk_bf16_f32 v122, v216, v217
v_mfma_f32_16x16x32_bf16 a[152:155], v[144:147], v[72:75], a[152:155]
s_add_u32 s25, s25, 24576
v_add_f32 v216, v216, v217
v_mfma_f32_16x16x32_bf16 a[152:155], v[148:151], v[88:91], a[152:155]
v_exp_f32 v219, v59
v_mfma_f32_16x16x32_bf16 a[156:159], v[148:151], v[92:95], a[156:159]
v_cvt_pk_bf16_f32 v123, v218, v219
v_add_f32 v218, v218, v219
v_mfma_f32_16x16x32_bf16 a[156:159], v[144:147], v[76:79], a[156:159]
s_waitcnt vmcnt(12) lgkmcnt(0)
s_barrier
v_mfma_f32_16x16x32_bf16 a[160:163], v[176:179], v[64:67], a[160:163]
v_exp_f32 v220, v60
v_mfma_f32_16x16x32_bf16 a[160:163], v[180:183], v[80:83], a[160:163]
ds_read_b128 v[144:147], v234 offset:0
v_add_f32 v226, v226, v216
v_mfma_f32_16x16x32_bf16 a[164:167], v[180:183], v[84:87], a[164:167]
v_exp_f32 v221, v61
v_mfma_f32_16x16x32_bf16 a[164:167], v[176:179], v[68:71], a[164:167]
ds_read_b128 v[148:151], v235 offset:0
v_cvt_pk_bf16_f32 v126, v220, v221
v_mfma_f32_16x16x32_bf16 a[168:171], v[176:179], v[72:75], a[168:171]
ds_read_b128 v[152:155], v234 offset:2048
v_add_f32 v220, v220, v221
v_mfma_f32_16x16x32_bf16 a[168:171], v[180:183], v[88:91], a[168:171]
v_exp_f32 v222, v62
v_mfma_f32_16x16x32_bf16 a[172:175], v[180:183], v[92:95], a[172:175]
ds_read_b128 v[156:159], v235 offset:2048
v_add_f32 v226, v226, v218
v_mfma_f32_16x16x32_bf16 a[172:175], v[176:179], v[76:79], a[172:175]
v_exp_f32 v223, v63
v_mfma_f32_16x16x32_bf16 a[176:179], v[168:171], v[64:67], a[176:179]
v_cvt_pk_bf16_f32 v127, v222, v223
v_add_f32 v222, v222, v223
v_mfma_f32_16x16x32_bf16 a[176:179], v[172:175], v[80:83], a[176:179]
ds_read_b128 v[176:179], v234 offset:4096
v_add_f32 v227, v227, v220
v_mfma_f32_16x16x32_bf16 a[180:183], v[172:175], v[84:87], a[180:183]
ds_read_b128 v[180:183], v235 offset:4096
v_add_f32 v227, v227, v222
v_mfma_f32_16x16x32_bf16 a[180:183], v[168:171], v[68:71], a[180:183]
v_max3_f32 v247, v224, v225, v226
v_mfma_f32_16x16x32_bf16 a[184:187], v[168:171], v[72:75], a[184:187]
v_max_f32 v247, v247, v227
v_mfma_f32_16x16x32_bf16 a[184:187], v[172:175], v[88:91], a[184:187]
v_cmp_lt_f32 vcc, s27, v247
v_mfma_f32_16x16x32_bf16 a[188:191], v[172:175], v[92:95], a[188:191]
s_waitcnt lgkmcnt(2)
v_mfma_f32_16x16x32_bf16 a[188:191], v[168:171], v[76:79], a[188:191]
s_cbranch_vccnz L_stub_0
L_back_0:
v_mfma_f32_16x16x32_bf16 v[0:3], v[144:147], a[192:195], v[128:131]
v_add_f32 v228, v228, v224
v_add_f32 v229, v229, v225
v_mfma_f32_16x16x32_bf16 v[0:3], v[148:151], a[196:199], v[0:3]
v_add_f32 v230, v230, v226
v_add_f32 v231, v231, v227
v_mfma_f32_16x16x32_bf16 v[0:3], v[152:155], a[200:203], v[0:3]
v_mfma_f32_16x16x32_bf16 v[0:3], v[156:159], a[204:207], v[0:3]
s_add_u32 m0, s24, 24576
s_waitcnt lgkmcnt(0)
v_mfma_f32_16x16x32_bf16 v[0:3], v[176:179], a[208:211], v[0:3]
buffer_load_dwordx4 v244, s[12:15], s25 offen lds
v_mfma_f32_16x16x32_bf16 v[0:3], v[180:183], a[212:215], v[0:3]
v_mfma_f32_16x16x32_bf16 v[4:7], v[180:183], a[236:239], v[132:135]
v_mfma_f32_16x16x32_bf16 v[4:7], v[176:179], a[232:235], v[4:7]
ds_read_b128 v[160:163], v234 offset:6144
v_mfma_f32_16x16x32_bf16 v[4:7], v[156:159], a[228:231], v[4:7]
ds_read_b128 v[164:167], v235 offset:6144
v_mfma_f32_16x16x32_bf16 v[4:7], v[152:155], a[224:227], v[4:7]
ds_read_b128 v[168:171], v234 offset:8192
v_mfma_f32_16x16x32_bf16 v[4:7], v[148:151], a[220:223], v[4:7]
v_exp_f32 v216, v0
v_mfma_f32_16x16x32_bf16 v[4:7], v[144:147], a[216:219], v[4:7]
ds_read_b128 v[172:175], v235 offset:8192
v_mfma_f32_16x16x32_bf16 v[8:11], v[144:147], a[240:243], v[136:139]
v_exp_f32 v217, v1
v_mfma_f32_16x16x32_bf16 v[8:11], v[148:151], a[244:247], v[8:11]
v_cvt_pk_bf16_f32 v64, v216, v217
v_add_f32 v216, v216, v217
v_mfma_f32_16x16x32_bf16 v[8:11], v[152:155], a[248:251], v[8:11]
v_exp_f32 v218, v2
v_mfma_f32_16x16x32_bf16 v[8:11], v[156:159], a[252:255], v[8:11]
v_exp_f32 v219, v3
v_mfma_f32_16x16x32_bf16 v[8:11], v[176:179], v[184:187], v[8:11]
v_cvt_pk_bf16_f32 v65, v218, v219
v_add_f32 v218, v218, v219
v_mfma_f32_16x16x32_bf16 v[8:11], v[180:183], v[188:191], v[8:11]
s_add_u32 m0, s24, 73728
v_add_f32 v224, v216, v218
v_mfma_f32_16x16x32_bf16 v[12:15], v[180:183], v[212:215], v[140:143]
ds_read_b128 v[180:183], v234 offset:10240
v_mfma_f32_16x16x32_bf16 v[12:15], v[176:179], v[208:211], v[12:15]
ds_read_b128 v[176:179], v235 offset:10240
v_mfma_f32_16x16x32_bf16 v[12:15], v[156:159], v[204:207], v[12:15]
buffer_load_dwordx4 v246, s[16:19], s25 offen lds
v_mfma_f32_16x16x32_bf16 v[12:15], v[152:155], v[200:203], v[12:15]
v_exp_f32 v220, v4
v_mfma_f32_16x16x32_bf16 v[12:15], v[148:151], v[196:199], v[12:15]
v_exp_f32 v221, v5
v_mfma_f32_16x16x32_bf16 v[12:15], v[144:147], v[192:195], v[12:15]
v_cvt_pk_bf16_f32 v68, v220, v221
s_waitcnt lgkmcnt(2)
v_mfma_f32_16x16x32_bf16 v[16:19], v[160:163], a[192:195], v[128:131]
v_add_f32 v220, v220, v221
v_mfma_f32_16x16x32_bf16 v[16:19], v[164:167], a[196:199], v[16:19]
v_exp_f32 v222, v6
v_mfma_f32_16x16x32_bf16 v[16:19], v[168:171], a[200:203], v[16:19]
v_exp_f32 v223, v7
v_mfma_f32_16x16x32_bf16 v[16:19], v[172:175], a[204:207], v[16:19]
v_cvt_pk_bf16_f32 v69, v222, v223
s_waitcnt lgkmcnt(0)
v_mfma_f32_16x16x32_bf16 v[16:19], v[180:183], a[208:211], v[16:19]
v_add_f32 v222, v222, v223
v_mfma_f32_16x16x32_bf16 v[16:19], v[176:179], a[212:215], v[16:19]
v_add_f32 v225, v220, v222
v_mfma_f32_16x16x32_bf16 v[20:23], v[176:179], a[236:239], v[132:135]
v_exp_f32 v216, v8
v_mfma_f32_16x16x32_bf16 v[20:23], v[180:183], a[232:235], v[20:23]
ds_read_b128 v[144:147], v234 offset:12288
s_add_u32 m0, s24, 25600
v_mfma_f32_16x16x32_bf16 v[20:23], v[172:175], a[228:231], v[20:23]
buffer_load_dwordx4 v245, s[12:15], s25 offen lds
v_mfma_f32_16x16x32_bf16 v[20:23], v[168:171], a[224:227], v[20:23]
ds_read_b128 v[148:151], v235 offset:12288
v_mfma_f32_16x16x32_bf16 v[20:23], v[164:167], a[220:223], v[20:23]
ds_read_b128 v[152:155], v234 offset:14336
v_mfma_f32_16x16x32_bf16 v[20:23], v[160:163], a[216:219], v[20:23]
v_exp_f32 v217, v9
v_mfma_f32_16x16x32_bf16 v[24:27], v[160:163], a[240:243], v[136:139]
ds_read_b128 v[156:159], v235 offset:14336
v_cvt_pk_bf16_f32 v72, v216, v217
v_mfma_f32_16x16x32_bf16 v[24:27], v[164:167], a[244:247], v[24:27]
v_add_f32 v216, v216, v217
v_mfma_f32_16x16x32_bf16 v[24:27], v[168:171], a[248:251], v[24:27]
v_exp_f32 v218, v10
v_mfma_f32_16x16x32_bf16 v[24:27], v[172:175], a[252:255], v[24:27]
v_exp_f32 v219, v11
v_mfma_f32_16x16x32_bf16 v[24:27], v[180:183], v[184:187], v[24:27]
v_cvt_pk_bf16_f32 v73, v218, v219
v_add_f32 v218, v218, v219
v_mfma_f32_16x16x32_bf16 v[24:27], v[176:179], v[188:191], v[24:27]
v_add_f32 v226, v216, v218
v_mfma_f32_16x16x32_bf16 v[28:31], v[176:179], v[212:215], v[140:143]
ds_read_b128 v[176:179], v234 offset:16384
v_mfma_f32_16x16x32_bf16 v[28:31], v[180:183], v[208:211], v[28:31]
ds_read_b128 v[180:183], v235 offset:16384
v_mfma_f32_16x16x32_bf16 v[28:31], v[172:175], v[204:207], v[28:31]
v_exp_f32 v220, v12
v_mfma_f32_16x16x32_bf16 v[28:31], v[168:171], v[200:203], v[28:31]
s_add_u32 m0, s24, 71680
v_mfma_f32_16x16x32_bf16 v[28:31], v[164:167], v[196:199], v[28:31]
v_exp_f32 v221, v13
v_mfma_f32_16x16x32_bf16 v[28:31], v[160:163], v[192:195], v[28:31]
v_cvt_pk_bf16_f32 v76, v220, v221
s_waitcnt lgkmcnt(2)
v_mfma_f32_16x16x32_bf16 v[32:35], v[144:147], a[192:195], v[128:131]
buffer_load_dwordx4 v246, s[16:19], s25 offen offset:3072 lds
v_mfma_f32_16x16x32_bf16 v[32:35], v[148:151], a[196:199], v[32:35]
v_exp_f32 v222, v14
v_mfma_f32_16x16x32_bf16 v[32:35], v[152:155], a[200:203], v[32:35]
v_add_f32 v220, v220, v221
v_mfma_f32_16x16x32_bf16 v[32:35], v[156:159], a[204:207], v[32:35]
s_waitcnt lgkmcnt(0)
v_mfma_f32_16x16x32_bf16 v[32:35], v[176:179], a[208:211], v[32:35]
v_exp_f32 v223, v15
v_mfma_f32_16x16x32_bf16 v[32:35], v[180:183], a[212:215], v[32:35]
v_cvt_pk_bf16_f32 v77, v222, v223
v_add_f32 v222, v222, v223
v_mfma_f32_16x16x32_bf16 v[36:39], v[180:183], a[236:239], v[132:135]
v_exp_f32 v216, v16
v_mfma_f32_16x16x32_bf16 v[36:39], v[176:179], a[232:235], v[36:39]
ds_read_b128 v[160:163], v234 offset:18432
v_add_f32 v227, v220, v222
v_mfma_f32_16x16x32_bf16 v[36:39], v[156:159], a[228:231], v[36:39]
ds_read_b128 v[164:167], v235 offset:18432
v_mfma_f32_16x16x32_bf16 v[36:39], v[152:155], a[224:227], v[36:39]
v_exp_f32 v217, v17
v_mfma_f32_16x16x32_bf16 v[36:39], v[148:151], a[220:223], v[36:39]
ds_read_b128 v[168:171], v234 offset:20480
v_cvt_pk_bf16_f32 v66, v216, v217
v_mfma_f32_16x16x32_bf16 v[36:39], v[144:147], a[216:219], v[36:39]
ds_read_b128 v[172:175], v235 offset:20480
s_add_u32 m0, s24, 26496
v_mfma_f32_16x16x32_bf16 v[40:43], v[144:147], a[240:243], v[136:139]
v_exp_f32 v218, v18
v_mfma_f32_16x16x32_bf16 v[40:43], v[148:151], a[244:247], v[40:43]
buffer_load_dwordx4 v244, s[12:15], s25 offen offset:128 lds
v_mfma_f32_16x16x32_bf16 v[40:43], v[152:155], a[248:251], v[40:43]
v_add_f32 v216, v216, v217
v_mfma_f32_16x16x32_bf16 v[40:43], v[156:159], a[252:255], v[40:43]
v_exp_f32 v219, v19
v_mfma_f32_16x16x32_bf16 v[40:43], v[176:179], v[184:187], v[40:43]
v_cvt_pk_bf16_f32 v67, v218, v219
v_add_f32 v218, v218, v219
v_mfma_f32_16x16x32_bf16 v[40:43], v[180:183], v[188:191], v[40:43]
v_exp_f32 v220, v20
v_mfma_f32_16x16x32_bf16 v[44:47], v[180:183], v[212:215], v[140:143]
ds_read_b128 v[180:183], v234 offset:22528
v_add_f32 v224, v224, v216
v_mfma_f32_16x16x32_bf16 v[44:47], v[176:179], v[208:211], v[44:47]
ds_read_b128 v[176:179], v235 offset:22528
v_add_f32 v224, v224, v218
v_mfma_f32_16x16x32_bf16 v[44:47], v[156:159], v[204:207], v[44:47]
v_exp_f32 v221, v21
v_mfma_f32_16x16x32_bf16 v[44:47], v[152:155], v[200:203], v[44:47]
v_cvt_pk_bf16_f32 v70, v220, v221
v_add_f32 v220, v220, v221
v_mfma_f32_16x16x32_bf16 v[44:47], v[148:151], v[196:199], v[44:47]
v_add_f32 v225, v225, v220
v_mfma_f32_16x16x32_bf16 v[44:47], v[144:147], v[192:195], v[44:47]
ds_read_b64_tr_b16 v[144:145], v236 offset:24576
s_waitcnt lgkmcnt(3)
v_mfma_f32_16x16x32_bf16 v[48:51], v[160:163], a[192:195], v[128:131]
v_exp_f32 v222, v22
v_mfma_f32_16x16x32_bf16 v[48:51], v[164:167], a[196:199], v[48:51]
ds_read_b64_tr_b16 v[146:147], v236 offset:30720
s_add_u32 m0, s24, 75648
v_mfma_f32_16x16x32_bf16 v[48:51], v[168:171], a[200:203], v[48:51]
v_exp_f32 v223, v23
v_mfma_f32_16x16x32_bf16 v[48:51], v[172:175], a[204:207], v[48:51]
v_cvt_pk_bf16_f32 v71, v222, v223
s_waitcnt lgkmcnt(2)
v_mfma_f32_16x16x32_bf16 v[48:51], v[180:183], a[208:211], v[48:51]
v_exp_f32 v216, v24
v_mfma_f32_16x16x32_bf16 v[48:51], v[176:179], a[212:215], v[48:51]
buffer_load_dwordx4 v246, s[16:19], s25 offen offset:128 lds
v_mfma_f32_16x16x32_bf16 v[52:55], v[176:179], a[236:239], v[132:135]
ds_read_b64_tr_b16 v[148:149], v236 offset:36864
v_add_f32 v222, v222, v223
v_mfma_f32_16x16x32_bf16 v[52:55], v[180:183], a[232:235], v[52:55]
v_exp_f32 v217, v25
v_mfma_f32_16x16x32_bf16 v[52:55], v[172:175], a[228:231], v[52:55]
ds_read_b64_tr_b16 v[150:151], v236 offset:43008
v_add_f32 v225, v225, v222
v_mfma_f32_16x16x32_bf16 v[52:55], v[168:171], a[224:227], v[52:55]
ds_read_b64_tr_b16 v[152:153], v237 offset:24576
v_cvt_pk_bf16_f32 v74, v216, v217
v_mfma_f32_16x16x32_bf16 v[52:55], v[164:167], a[220:223], v[52:55]
v_exp_f32 v218, v26
v_mfma_f32_16x16x32_bf16 v[52:55], v[160:163], a[216:219], v[52:55]
ds_read_b64_tr_b16 v[154:155], v237 offset:30720
v_add_f32 v216, v216, v217
v_mfma_f32_16x16x32_bf16 v[56:59], v[160:163], a[240:243], v[136:139]
ds_read_b64_tr_b16 v[156:157], v237 offset:36864
v_add_f32 v226, v226, v216
v_mfma_f32_16x16x32_bf16 v[56:59], v[164:167], a[244:247], v[56:59]
v_exp_f32 v219, v27
v_mfma_f32_16x16x32_bf16 v[56:59], v[168:171], a[248:251], v[56:59]
ds_read_b64_tr_b16 v[158:159], v237 offset:43008
v_cvt_pk_bf16_f32 v75, v218, v219
v_mfma_f32_16x16x32_bf16 v[56:59], v[172:175], a[252:255], v[56:59]
v_exp_f32 v220, v28
v_mfma_f32_16x16x32_bf16 v[56:59], v[180:183], v[184:187], v[56:59]
s_add_u32 m0, s24, 27520
v_add_f32 v218, v218, v219
v_mfma_f32_16x16x32_bf16 v[56:59], v[176:179], v[188:191], v[56:59]
buffer_load_dwordx4 v245, s[12:15], s25 offen offset:128 lds
v_mfma_f32_16x16x32_bf16 v[60:63], v[176:179], v[212:215], v[140:143]
v_exp_f32 v221, v29
v_mfma_f32_16x16x32_bf16 v[60:63], v[180:183], v[208:211], v[60:63]
ds_read_b64_tr_b16 v[176:177], v238 offset:24576
v_add_f32 v226, v226, v218
v_mfma_f32_16x16x32_bf16 v[60:63], v[172:175], v[204:207], v[60:63]
ds_read_b64_tr_b16 v[178:179], v238 offset:30720
v_cvt_pk_bf16_f32 v78, v220, v221
v_mfma_f32_16x16x32_bf16 v[60:63], v[168:171], v[200:203], v[60:63]
v_exp_f32 v222, v30
v_mfma_f32_16x16x32_bf16 v[60:63], v[164:167], v[196:199], v[60:63]
ds_read_b64_tr_b16 v[180:181], v238 offset:36864
v_add_f32 v220, v220, v221
v_mfma_f32_16x16x32_bf16 v[60:63], v[160:163], v[192:195], v[60:63]
ds_read_b64_tr_b16 v[182:183], v238 offset:43008
s_waitcnt lgkmcnt(4)
v_mfma_f32_16x16x32_bf16 a[0:3], v[144:147], v[96:99], a[0:3]
v_exp_f32 v223, v31
v_mfma_f32_16x16x32_bf16 a[0:3], v[148:151], v[112:115], a[0:3]
ds_read_b64_tr_b16 v[160:161], v239 offset:24576
v_cvt_pk_bf16_f32 v79, v222, v223
v_mfma_f32_16x16x32_bf16 a[4:7], v[148:151], v[116:119], a[4:7]
v_exp_f32 v216, v32
v_mfma_f32_16x16x32_bf16 a[4:7], v[144:147], v[100:103], a[4:7]
ds_read_b64_tr_b16 v[162:163], v239 offset:30720
v_add_f32 v222, v222, v223
v_mfma_f32_16x16x32_bf16 a[8:11], v[144:147], v[104:107], a[8:11]
ds_read_b64_tr_b16 v[164:165], v239 offset:36864
v_add_f32 v227, v227, v220
v_mfma_f32_16x16x32_bf16 a[8:11], v[148:151], v[120:123], a[8:11]
v_exp_f32 v217, v33
v_mfma_f32_16x16x32_bf16 a[12:15], v[148:151], v[124:127], a[12:15]
ds_read_b64_tr_b16 v[166:167], v239 offset:43008
s_add_u32 m0, s24, 73600
v_mfma_f32_16x16x32_bf16 a[12:15], v[144:147], v[108:111], a[12:15]
buffer_load_dwordx4 v246, s[16:19], s25 offen offset:3200 lds
v_mfma_f32_16x16x32_bf16 a[16:19], v[152:155], v[96:99], a[16:19]
v_exp_f32 v218, v34
v_mfma_f32_16x16x32_bf16 a[16:19], v[156:159], v[112:115], a[16:19]
v_add_f32 v227, v227, v222
v_cvt_pk_bf16_f32 v80, v216, v217
v_mfma_f32_16x16x32_bf16 a[20:23], v[156:159], v[116:119], a[20:23]
ds_read_b64_tr_b16 v[168:169], v236 offset:26624
v_add_f32 v216, v216, v217
v_mfma_f32_16x16x32_bf16 a[20:23], v[152:155], v[100:103], a[20:23]
v_exp_f32 v219, v35
v_mfma_f32_16x16x32_bf16 a[24:27], v[152:155], v[104:107], a[24:27]
v_cvt_pk_bf16_f32 v81, v218, v219
v_add_f32 v218, v218, v219
v_mfma_f32_16x16x32_bf16 a[24:27], v[156:159], v[120:123], a[24:27]
v_exp_f32 v220, v36
v_mfma_f32_16x16x32_bf16 a[28:31], v[156:159], v[124:127], a[28:31]
ds_read_b64_tr_b16 v[170:171], v236 offset:32768
v_add_f32 v224, v224, v216
v_mfma_f32_16x16x32_bf16 a[28:31], v[152:155], v[108:111], a[28:31]
v_add_f32 v224, v224, v218
s_waitcnt lgkmcnt(2)
v_mfma_f32_16x16x32_bf16 a[32:35], v[176:179], v[96:99], a[32:35]
v_exp_f32 v221, v37
v_mfma_f32_16x16x32_bf16 a[32:35], v[180:183], v[112:115], a[32:35]
ds_read_b64_tr_b16 v[172:173], v236 offset:38912
v_cvt_pk_bf16_f32 v84, v220, v221
v_mfma_f32_16x16x32_bf16 a[36:39], v[180:183], v[116:119], a[36:39]
ds_read_b64_tr_b16 v[174:175], v236 offset:45056
v_add_f32 v220, v220, v221
v_mfma_f32_16x16x32_bf16 a[36:39], v[176:179], v[100:103], a[36:39]
v_exp_f32 v222, v38
v_mfma_f32_16x16x32_bf16 a[40:43], v[176:179], v[104:107], a[40:43]
ds_read_b64_tr_b16 v[144:145], v237 offset:26624
s_add_u32 m0, s24, 28416
v_mfma_f32_16x16x32_bf16 a[40:43], v[180:183], v[120:123], a[40:43]
ds_read_b64_tr_b16 v[146:147], v237 offset:32768
v_add_f32 v225, v225, v220
v_mfma_f32_16x16x32_bf16 a[44:47], v[180:183], v[124:127], a[44:47]
v_exp_f32 v223, v39
v_mfma_f32_16x16x32_bf16 a[44:47], v[176:179], v[108:111], a[44:47]
ds_read_b64_tr_b16 v[148:149], v237 offset:38912
v_cvt_pk_bf16_f32 v85, v222, v223
v_mfma_f32_16x16x32_bf16 a[48:51], v[160:163], v[96:99], a[48:51]
ds_read_b64_tr_b16 v[150:151], v237 offset:45056
v_add_f32 v222, v222, v223
v_mfma_f32_16x16x32_bf16 a[48:51], v[164:167], v[112:115], a[48:51]
buffer_load_dwordx4 v244, s[12:15], s25 offen offset:256 lds
v_mfma_f32_16x16x32_bf16 a[52:55], v[164:167], v[116:119], a[52:55]
v_exp_f32 v216, v40
v_mfma_f32_16x16x32_bf16 a[52:55], v[160:163], v[100:103], a[52:55]
v_exp_f32 v217, v41
v_mfma_f32_16x16x32_bf16 a[56:59], v[160:163], v[104:107], a[56:59]
ds_read_b64_tr_b16 v[176:177], v238 offset:26624
v_add_f32 v225, v225, v222
v_mfma_f32_16x16x32_bf16 a[56:59], v[164:167], v[120:123], a[56:59]
ds_read_b64_tr_b16 v[178:179], v238 offset:32768
v_cvt_pk_bf16_f32 v88, v216, v217
v_mfma_f32_16x16x32_bf16 a[60:63], v[164:167], v[124:127], a[60:63]
v_exp_f32 v218, v42
v_mfma_f32_16x16x32_bf16 a[60:63], v[160:163], v[108:111], a[60:63]
ds_read_b64_tr_b16 v[180:181], v238 offset:38912
s_waitcnt lgkmcnt(3)
v_mfma_f32_16x16x32_bf16 a[64:67], v[168:171], v[96:99], a[64:67]
ds_read_b64_tr_b16 v[182:183], v238 offset:45056
v_add_f32 v216, v216, v217
v_mfma_f32_16x16x32_bf16 a[64:67], v[172:175], v[112:115], a[64:67]
v_exp_f32 v219, v43
v_mfma_f32_16x16x32_bf16 a[68:71], v[172:175], v[116:119], a[68:71]
ds_read_b64_tr_b16 v[160:161], v239 offset:26624
s_add_u32 m0, s24, 77568
v_mfma_f32_16x16x32_bf16 a[68:71], v[168:171], v[100:103], a[68:71]
v_exp_f32 v220, v44
v_mfma_f32_16x16x32_bf16 a[72:75], v[168:171], v[104:107], a[72:75]
buffer_load_dwordx4 v246, s[16:19], s25 offen offset:256 lds
v_mfma_f32_16x16x32_bf16 a[72:75], v[172:175], v[120:123], a[72:75]
ds_read_b64_tr_b16 v[162:163], v239 offset:32768
v_cvt_pk_bf16_f32 v89, v218, v219
v_mfma_f32_16x16x32_bf16 a[76:79], v[172:175], v[124:127], a[76:79]
v_exp_f32 v221, v45
v_mfma_f32_16x16x32_bf16 a[76:79], v[168:171], v[108:111], a[76:79]
ds_read_b64_tr_b16 v[164:165], v239 offset:38912
v_add_f32 v218, v218, v219
v_mfma_f32_16x16x32_bf16 a[80:83], v[144:147], v[96:99], a[80:83]
ds_read_b64_tr_b16 v[166:167], v239 offset:45056
v_add_f32 v226, v226, v216
v_mfma_f32_16x16x32_bf16 a[80:83], v[148:151], v[112:115], a[80:83]
v_exp_f32 v222, v46
v_mfma_f32_16x16x32_bf16 a[84:87], v[148:151], v[116:119], a[84:87]
v_add_f32 v226, v226, v218
v_cvt_pk_bf16_f32 v92, v220, v221
v_mfma_f32_16x16x32_bf16 a[84:87], v[144:147], v[100:103], a[84:87]
ds_read_b64_tr_b16 v[152:153], v236 offset:28672
v_add_f32 v220, v220, v221
v_mfma_f32_16x16x32_bf16 a[88:91], v[144:147], v[104:107], a[88:91]
v_exp_f32 v223, v47
v_mfma_f32_16x16x32_bf16 a[88:91], v[148:151], v[120:123], a[88:91]
v_cvt_pk_bf16_f32 v93, v222, v223
v_add_f32 v222, v222, v223
v_mfma_f32_16x16x32_bf16 a[92:95], v[148:151], v[124:127], a[92:95]
v_exp_f32 v216, v48
v_mfma_f32_16x16x32_bf16 a[92:95], v[144:147], v[108:111], a[92:95]
s_add_u32 m0, s24, 29440
s_waitcnt lgkmcnt(1)
v_mfma_f32_16x16x32_bf16 a[96:99], v[176:179], v[96:99], a[96:99]
buffer_load_dwordx4 v245, s[12:15], s25 offen offset:256 lds
v_mfma_f32_16x16x32_bf16 a[96:99], v[180:183], v[112:115], a[96:99]
v_exp_f32 v217, v49
v_mfma_f32_16x16x32_bf16 a[100:103], v[180:183], v[116:119], a[100:103]
ds_read_b64_tr_b16 v[154:155], v236 offset:34816
v_add_f32 v227, v227, v220
v_mfma_f32_16x16x32_bf16 a[100:103], v[176:179], v[100:103], a[100:103]
ds_read_b64_tr_b16 v[156:157], v236 offset:40960
v_add_f32 v227, v227, v222
v_mfma_f32_16x16x32_bf16 a[104:107], v[176:179], v[104:107], a[104:107]
v_exp_f32 v218, v50
v_mfma_f32_16x16x32_bf16 a[104:107], v[180:183], v[120:123], a[104:107]
ds_read_b64_tr_b16 v[158:159], v236 offset:47104
v_cvt_pk_bf16_f32 v82, v216, v217
v_mfma_f32_16x16x32_bf16 a[108:111], v[180:183], v[124:127], a[108:111]
ds_read_b64_tr_b16 v[144:145], v237 offset:28672
v_add_f32 v216, v216, v217
v_mfma_f32_16x16x32_bf16 a[108:111], v[176:179], v[108:111], a[108:111]
ds_read_b64_tr_b16 v[146:147], v237 offset:34816
v_add_f32 v224, v224, v216
v_mfma_f32_16x16x32_bf16 a[112:115], v[160:163], v[96:99], a[112:115]
ds_read_b64_tr_b16 v[148:149], v237 offset:40960
ds_read_b64_tr_b16 v[150:151], v237 offset:47104
v_mfma_f32_16x16x32_bf16 a[112:115], v[164:167], v[112:115], a[112:115]
v_exp_f32 v219, v51
v_mfma_f32_16x16x32_bf16 a[116:119], v[164:167], v[116:119], a[116:119]
v_exp_f32 v220, v52
v_mfma_f32_16x16x32_bf16 a[116:119], v[160:163], v[100:103], a[116:119]
v_cvt_pk_bf16_f32 v83, v218, v219
v_add_f32 v218, v218, v219
v_mfma_f32_16x16x32_bf16 a[120:123], v[160:163], v[104:107], a[120:123]
v_exp_f32 v221, v53
v_mfma_f32_16x16x32_bf16 a[120:123], v[164:167], v[120:123], a[120:123]
s_add_u32 m0, s24, 75520
v_add_f32 v224, v224, v218
v_mfma_f32_16x16x32_bf16 a[124:127], v[164:167], v[124:127], a[124:127]
buffer_load_dwordx4 v246, s[16:19], s25 offen offset:3328 lds
v_mfma_f32_16x16x32_bf16 a[124:127], v[160:163], v[108:111], a[124:127]
ds_read_b64_tr_b16 v[176:177], v238 offset:28672
s_waitcnt lgkmcnt(1)
v_mfma_f32_16x16x32_bf16 a[128:131], v[152:155], v[96:99], a[128:131]
v_exp_f32 v222, v54
v_mfma_f32_16x16x32_bf16 a[128:131], v[156:159], v[112:115], a[128:131]
ds_read_b64_tr_b16 v[178:179], v238 offset:34816
v_cvt_pk_bf16_f32 v86, v220, v221
v_mfma_f32_16x16x32_bf16 a[132:135], v[156:159], v[116:119], a[132:135]
v_exp_f32 v223, v55
v_mfma_f32_16x16x32_bf16 a[132:135], v[152:155], v[100:103], a[132:135]
ds_read_b64_tr_b16 v[180:181], v238 offset:40960
v_add_f32 v220, v220, v221
v_mfma_f32_16x16x32_bf16 a[136:139], v[152:155], v[104:107], a[136:139]
v_exp_f32 v216, v56
v_mfma_f32_16x16x32_bf16 a[136:139], v[156:159], v[120:123], a[136:139]
ds_read_b64_tr_b16 v[182:183], v238 offset:47104
v_cvt_pk_bf16_f32 v87, v222, v223
v_mfma_f32_16x16x32_bf16 a[140:143], v[156:159], v[124:127], a[140:143]
ds_read_b64_tr_b16 v[168:169], v239 offset:28672
v_add_f32 v222, v222, v223
v_mfma_f32_16x16x32_bf16 a[140:143], v[152:155], v[108:111], a[140:143]
ds_read_b64_tr_b16 v[170:171], v239 offset:34816
v_add_f32 v225, v225, v220
v_mfma_f32_16x16x32_bf16 a[144:147], v[144:147], v[96:99], a[144:147]
ds_read_b64_tr_b16 v[172:173], v239 offset:40960
ds_read_b64_tr_b16 v[174:175], v239 offset:47104
v_mfma_f32_16x16x32_bf16 a[144:147], v[148:151], v[112:115], a[144:147]
v_exp_f32 v217, v57
v_mfma_f32_16x16x32_bf16 a[148:151], v[148:151], v[116:119], a[148:151]
v_exp_f32 v218, v58
v_mfma_f32_16x16x32_bf16 a[148:151], v[144:147], v[100:103], a[148:151]
v_add_f32 v225, v225, v222
v_cvt_pk_bf16_f32 v90, v216, v217
v_mfma_f32_16x16x32_bf16 a[152:155], v[144:147], v[104:107], a[152:155]
s_add_u32 s25, s25, 24576
v_add_f32 v216, v216, v217
v_mfma_f32_16x16x32_bf16 a[152:155], v[148:151], v[120:123], a[152:155]
v_exp_f32 v219, v59
v_mfma_f32_16x16x32_bf16 a[156:159], v[148:151], v[124:127], a[156:159]
v_cvt_pk_bf16_f32 v91, v218, v219
v_add_f32 v218, v218, v219
v_mfma_f32_16x16x32_bf16 a[156:159], v[144:147], v[108:111], a[156:159]
s_waitcnt vmcnt(12) lgkmcnt(0)
s_barrier
v_mfma_f32_16x16x32_bf16 a[160:163], v[176:179], v[96:99], a[160:163]
v_exp_f32 v220, v60
v_mfma_f32_16x16x32_bf16 a[160:163], v[180:183], v[112:115], a[160:163]
ds_read_b128 v[144:147], v232 offset:0
v_add_f32 v226, v226, v216
v_mfma_f32_16x16x32_bf16 a[164:167], v[180:183], v[116:119], a[164:167]
v_exp_f32 v221, v61
v_mfma_f32_16x16x32_bf16 a[164:167], v[176:179], v[100:103], a[164:167]
ds_read_b128 v[148:151], v233 offset:0
v_cvt_pk_bf16_f32 v94, v220, v221
v_mfma_f32_16x16x32_bf16 a[168:171], v[176:179], v[104:107], a[168:171]
ds_read_b128 v[152:155], v232 offset:2048
v_add_f32 v220, v220, v221
v_mfma_f32_16x16x32_bf16 a[168:171], v[180:183], v[120:123], a[168:171]
v_exp_f32 v222, v62
v_mfma_f32_16x16x32_bf16 a[172:175], v[180:183], v[124:127], a[172:175]
ds_read_b128 v[156:159], v233 offset:2048
v_add_f32 v226, v226, v218
v_mfma_f32_16x16x32_bf16 a[172:175], v[176:179], v[108:111], a[172:175]
v_exp_f32 v223, v63
v_mfma_f32_16x16x32_bf16 a[176:179], v[168:171], v[96:99], a[176:179]
v_cvt_pk_bf16_f32 v95, v222, v223
v_add_f32 v222, v222, v223
v_mfma_f32_16x16x32_bf16 a[176:179], v[172:175], v[112:115], a[176:179]
ds_read_b128 v[176:179], v232 offset:4096
v_add_f32 v227, v227, v220
v_mfma_f32_16x16x32_bf16 a[180:183], v[172:175], v[116:119], a[180:183]
ds_read_b128 v[180:183], v233 offset:4096
v_add_f32 v227, v227, v222
v_mfma_f32_16x16x32_bf16 a[180:183], v[168:171], v[100:103], a[180:183]
v_max3_f32 v247, v224, v225, v226
v_mfma_f32_16x16x32_bf16 a[184:187], v[168:171], v[104:107], a[184:187]
v_max_f32 v247, v247, v227
v_mfma_f32_16x16x32_bf16 a[184:187], v[172:175], v[120:123], a[184:187]
v_cmp_lt_f32 vcc, s27, v247
v_mfma_f32_16x16x32_bf16 a[188:191], v[172:175], v[124:127], a[188:191]
s_waitcnt lgkmcnt(2)
v_mfma_f32_16x16x32_bf16 a[188:191], v[168:171], v[108:111], a[188:191]
s_cbranch_vccnz L_stub_1
L_back_1:
v_mfma_f32_16x16x32_bf16 v[0:3], v[144:147], a[192:195], v[128:131]
v_add_f32 v228, v228, v224
v_add_f32 v229, v229, v225
v_mfma_f32_16x16x32_bf16 v[0:3], v[148:151], a[196:199], v[0:3]
v_add_f32 v230, v230, v226
v_add_f32 v231, v231, v227
v_mfma_f32_16x16x32_bf16 v[0:3], v[152:155], a[200:203], v[0:3]
v_mfma_f32_16x16x32_bf16 v[0:3], v[156:159], a[204:207], v[0:3]
s_add_u32 m0, s24, 49152
s_waitcnt lgkmcnt(0)
v_mfma_f32_16x16x32_bf16 v[0:3], v[176:179], a[208:211], v[0:3]
buffer_load_dwordx4 v244, s[12:15], s25 offen lds
v_mfma_f32_16x16x32_bf16 v[0:3], v[180:183], a[212:215], v[0:3]
v_mfma_f32_16x16x32_bf16 v[4:7], v[180:183], a[236:239], v[132:135]
v_mfma_f32_16x16x32_bf16 v[4:7], v[176:179], a[232:235], v[4:7]
ds_read_b128 v[160:163], v232 offset:6144
v_mfma_f32_16x16x32_bf16 v[4:7], v[156:159], a[228:231], v[4:7]
ds_read_b128 v[164:167], v233 offset:6144
v_mfma_f32_16x16x32_bf16 v[4:7], v[152:155], a[224:227], v[4:7]
ds_read_b128 v[168:171], v232 offset:8192
v_mfma_f32_16x16x32_bf16 v[4:7], v[148:151], a[220:223], v[4:7]
v_exp_f32 v216, v0
v_mfma_f32_16x16x32_bf16 v[4:7], v[144:147], a[216:219], v[4:7]
ds_read_b128 v[172:175], v233 offset:8192
v_mfma_f32_16x16x32_bf16 v[8:11], v[144:147], a[240:243], v[136:139]
v_exp_f32 v217, v1
v_mfma_f32_16x16x32_bf16 v[8:11], v[148:151], a[244:247], v[8:11]
v_cvt_pk_bf16_f32 v96, v216, v217
v_add_f32 v216, v216, v217
v_mfma_f32_16x16x32_bf16 v[8:11], v[152:155], a[248:251], v[8:11]
v_exp_f32 v218, v2
v_mfma_f32_16x16x32_bf16 v[8:11], v[156:159], a[252:255], v[8:11]
v_exp_f32 v219, v3
v_mfma_f32_16x16x32_bf16 v[8:11], v[176:179], v[184:187], v[8:11]
v_cvt_pk_bf16_f32 v97, v218, v219
v_add_f32 v218, v218, v219
v_mfma_f32_16x16x32_bf16 v[8:11], v[180:183], v[188:191], v[8:11]
s_add_u32 m0, s24, 98304
v_add_f32 v224, v216, v218
v_mfma_f32_16x16x32_bf16 v[12:15], v[180:183], v[212:215], v[140:143]
ds_read_b128 v[180:183], v232 offset:10240
v_mfma_f32_16x16x32_bf16 v[12:15], v[176:179], v[208:211], v[12:15]
ds_read_b128 v[176:179], v233 offset:10240
v_mfma_f32_16x16x32_bf16 v[12:15], v[156:159], v[204:207], v[12:15]
buffer_load_dwordx4 v246, s[16:19], s25 offen lds
v_mfma_f32_16x16x32_bf16 v[12:15], v[152:155], v[200:203], v[12:15]
v_exp_f32 v220, v4
v_mfma_f32_16x16x32_bf16 v[12:15], v[148:151], v[196:199], v[12:15]
v_exp_f32 v221, v5
v_mfma_f32_16x16x32_bf16 v[12:15], v[144:147], v[192:195], v[12:15]
v_cvt_pk_bf16_f32 v100, v220, v221
s_waitcnt lgkmcnt(2)
v_mfma_f32_16x16x32_bf16 v[16:19], v[160:163], a[192:195], v[128:131]
v_add_f32 v220, v220, v221
v_mfma_f32_16x16x32_bf16 v[16:19], v[164:167], a[196:199], v[16:19]
v_exp_f32 v222, v6
v_mfma_f32_16x16x32_bf16 v[16:19], v[168:171], a[200:203], v[16:19]
v_exp_f32 v223, v7
v_mfma_f32_16x16x32_bf16 v[16:19], v[172:175], a[204:207], v[16:19]
v_cvt_pk_bf16_f32 v101, v222, v223
s_waitcnt lgkmcnt(0)
v_mfma_f32_16x16x32_bf16 v[16:19], v[180:183], a[208:211], v[16:19]
v_add_f32 v222, v222, v223
v_mfma_f32_16x16x32_bf16 v[16:19], v[176:179], a[212:215], v[16:19]
v_add_f32 v225, v220, v222
v_mfma_f32_16x16x32_bf16 v[20:23], v[176:179], a[236:239], v[132:135]
v_exp_f32 v216, v8
v_mfma_f32_16x16x32_bf16 v[20:23], v[180:183], a[232:235], v[20:23]
ds_read_b128 v[144:147], v232 offset:12288
s_add_u32 m0, s24, 50176
v_mfma_f32_16x16x32_bf16 v[20:23], v[172:175], a[228:231], v[20:23]
buffer_load_dwordx4 v245, s[12:15], s25 offen lds
v_mfma_f32_16x16x32_bf16 v[20:23], v[168:171], a[224:227], v[20:23]
ds_read_b128 v[148:151], v233 offset:12288
v_mfma_f32_16x16x32_bf16 v[20:23], v[164:167], a[220:223], v[20:23]
ds_read_b128 v[152:155], v232 offset:14336
v_mfma_f32_16x16x32_bf16 v[20:23], v[160:163], a[216:219], v[20:23]
v_exp_f32 v217, v9
v_mfma_f32_16x16x32_bf16 v[24:27], v[160:163], a[240:243], v[136:139]
ds_read_b128 v[156:159], v233 offset:14336
v_cvt_pk_bf16_f32 v104, v216, v217
v_mfma_f32_16x16x32_bf16 v[24:27], v[164:167], a[244:247], v[24:27]
v_add_f32 v216, v216, v217
v_mfma_f32_16x16x32_bf16 v[24:27], v[168:171], a[248:251], v[24:27]
v_exp_f32 v218, v10
v_mfma_f32_16x16x32_bf16 v[24:27], v[172:175], a[252:255], v[24:27]
v_exp_f32 v219, v11
v_mfma_f32_16x16x32_bf16 v[24:27], v[180:183], v[184:187], v[24:27]
v_cvt_pk_bf16_f32 v105, v218, v219
v_add_f32 v218, v218, v219
v_mfma_f32_16x16x32_bf16 v[24:27], v[176:179], v[188:191], v[24:27]
v_add_f32 v226, v216, v218
v_mfma_f32_16x16x32_bf16 v[28:31], v[176:179], v[212:215], v[140:143]
ds_read_b128 v[176:179], v232 offset:16384
v_mfma_f32_16x16x32_bf16 v[28:31], v[180:183], v[208:211], v[28:31]
ds_read_b128 v[180:183], v233 offset:16384
v_mfma_f32_16x16x32_bf16 v[28:31], v[172:175], v[204:207], v[28:31]
v_exp_f32 v220, v12
v_mfma_f32_16x16x32_bf16 v[28:31], v[168:171], v[200:203], v[28:31]
s_add_u32 m0, s24, 96256
v_mfma_f32_16x16x32_bf16 v[28:31], v[164:167], v[196:199], v[28:31]
v_exp_f32 v221, v13
v_mfma_f32_16x16x32_bf16 v[28:31], v[160:163], v[192:195], v[28:31]
v_cvt_pk_bf16_f32 v108, v220, v221
s_waitcnt lgkmcnt(2)
v_mfma_f32_16x16x32_bf16 v[32:35], v[144:147], a[192:195], v[128:131]
buffer_load_dwordx4 v246, s[16:19], s25 offen offset:3072 lds
v_mfma_f32_16x16x32_bf16 v[32:35], v[148:151], a[196:199], v[32:35]
v_exp_f32 v222, v14
v_mfma_f32_16x16x32_bf16 v[32:35], v[152:155], a[200:203], v[32:35]
v_add_f32 v220, v220, v221
v_mfma_f32_16x16x32_bf16 v[32:35], v[156:159], a[204:207], v[32:35]
s_waitcnt lgkmcnt(0)
v_mfma_f32_16x16x32_bf16 v[32:35], v[176:179], a[208:211], v[32:35]
v_exp_f32 v223, v15
v_mfma_f32_16x16x32_bf16 v[32:35], v[180:183], a[212:215], v[32:35]
v_cvt_pk_bf16_f32 v109, v222, v223
v_add_f32 v222, v222, v223
v_mfma_f32_16x16x32_bf16 v[36:39], v[180:183], a[236:239], v[132:135]
v_exp_f32 v216, v16
v_mfma_f32_16x16x32_bf16 v[36:39], v[176:179], a[232:235], v[36:39]
ds_read_b128 v[160:163], v232 offset:18432
v_add_f32 v227, v220, v222
v_mfma_f32_16x16x32_bf16 v[36:39], v[156:159], a[228:231], v[36:39]
ds_read_b128 v[164:167], v233 offset:18432
v_mfma_f32_16x16x32_bf16 v[36:39], v[152:155], a[224:227], v[36:39]
v_exp_f32 v217, v17
v_mfma_f32_16x16x32_bf16 v[36:39], v[148:151], a[220:223], v[36:39]
ds_read_b128 v[168:171], v232 offset:20480
v_cvt_pk_bf16_f32 v98, v216, v217
v_mfma_f32_16x16x32_bf16 v[36:39], v[144:147], a[216:219], v[36:39]
ds_read_b128 v[172:175], v233 offset:20480
s_add_u32 m0, s24, 51072
v_mfma_f32_16x16x32_bf16 v[40:43], v[144:147], a[240:243], v[136:139]
v_exp_f32 v218, v18
v_mfma_f32_16x16x32_bf16 v[40:43], v[148:151], a[244:247], v[40:43]
buffer_load_dwordx4 v244, s[12:15], s25 offen offset:128 lds
v_mfma_f32_16x16x32_bf16 v[40:43], v[152:155], a[248:251], v[40:43]
v_add_f32 v216, v216, v217
v_mfma_f32_16x16x32_bf16 v[40:43], v[156:159], a[252:255], v[40:43]
v_exp_f32 v219, v19
v_mfma_f32_16x16x32_bf16 v[40:43], v[176:179], v[184:187], v[40:43]
v_cvt_pk_bf16_f32 v99, v218, v219
v_add_f32 v218, v218, v219
v_mfma_f32_16x16x32_bf16 v[40:43], v[180:183], v[188:191], v[40:43]
v_exp_f32 v220, v20
v_mfma_f32_16x16x32_bf16 v[44:47], v[180:183], v[212:215], v[140:143]
ds_read_b128 v[180:183], v232 offset:22528
v_add_f32 v224, v224, v216
v_mfma_f32_16x16x32_bf16 v[44:47], v[176:179], v[208:211], v[44:47]
ds_read_b128 v[176:179], v233 offset:22528
v_add_f32 v224, v224, v218
v_mfma_f32_16x16x32_bf16 v[44:47], v[156:159], v[204:207], v[44:47]
v_exp_f32 v221, v21
v_mfma_f32_16x16x32_bf16 v[44:47], v[152:155], v[200:203], v[44:47]
v_cvt_pk_bf16_f32 v102, v220, v221
v_add_f32 v220, v220, v221
v_mfma_f32_16x16x32_bf16 v[44:47], v[148:151], v[196:199], v[44:47]
v_add_f32 v225, v225, v220
v_mfma_f32_16x16x32_bf16 v[44:47], v[144:147], v[192:195], v[44:47]
ds_read_b64_tr_b16 v[144:145], v240 offset:0
s_waitcnt lgkmcnt(3)
v_mfma_f32_16x16x32_bf16 v[48:51], v[160:163], a[192:195], v[128:131]
v_exp_f32 v222, v22
v_mfma_f32_16x16x32_bf16 v[48:51], v[164:167], a[196:199], v[48:51]
ds_read_b64_tr_b16 v[146:147], v240 offset:6144
s_add_u32 m0, s24, 100224
v_mfma_f32_16x16x32_bf16 v[48:51], v[168:171], a[200:203], v[48:51]
v_exp_f32 v223, v23
v_mfma_f32_16x16x32_bf16 v[48:51], v[172:175], a[204:207], v[48:51]
v_cvt_pk_bf16_f32 v103, v222, v223
s_waitcnt lgkmcnt(2)
v_mfma_f32_16x16x32_bf16 v[48:51], v[180:183], a[208:211], v[48:51]
v_exp_f32 v216, v24
v_mfma_f32_16x16x32_bf16 v[48:51], v[176:179], a[212:215], v[48:51]
buffer_load_dwordx4 v246, s[16:19], s25 offen offset:128 lds
v_mfma_f32_16x16x32_bf16 v[52:55], v[176:179], a[236:239], v[132:135]
ds_read_b64_tr_b16 v[148:149], v240 offset:12288
v_add_f32 v222, v222, v223
v_mfma_f32_16x16x32_bf16 v[52:55], v[180:183], a[232:235], v[52:55]
v_exp_f32 v217, v25
v_mfma_f32_16x16x32_bf16 v[52:55], v[172:175], a[228:231], v[52:55]
ds_read_b64_tr_b16 v[150:151], v240 offset:18432
v_add_f32 v225, v225, v222
v_mfma_f32_16x16x32_bf16 v[52:55], v[168:171], a[224:227], v[52:55]
ds_read_b64_tr_b16 v[152:153], v241 offset:0
v_cvt_pk_bf16_f32 v106, v216, v217
v_mfma_f32_16x16x32_bf16 v[52:55], v[164:167], a[220:223], v[52:55]
v_exp_f32 v218, v26
v_mfma_f32_16x16x32_bf16 v[52:55], v[160:163], a[216:219], v[52:55]
ds_read_b64_tr_b16 v[154:155], v241 offset:6144
v_add_f32 v216, v216, v217
v_mfma_f32_16x16x32_bf16 v[56:59], v[160:163], a[240:243], v[136:139]
ds_read_b64_tr_b16 v[156:157], v241 offset:12288
v_add_f32 v226, v226, v216
v_mfma_f32_16x16x32_bf16 v[56:59], v[164:167], a[244:247], v[56:59]
v_exp_f32 v219, v27
v_mfma_f32_16x16x32_bf16 v[56:59], v[168:171], a[248:251], v[56:59]
ds_read_b64_tr_b16 v[158:159], v241 offset:18432
v_cvt_pk_bf16_f32 v107, v218, v219
v_mfma_f32_16x16x32_bf16 v[56:59], v[172:175], a[252:255], v[56:59]
v_exp_f32 v220, v28
v_mfma_f32_16x16x32_bf16 v[56:59], v[180:183], v[184:187], v[56:59]
s_add_u32 m0, s24, 52096
v_add_f32 v218, v218, v219
v_mfma_f32_16x16x32_bf16 v[56:59], v[176:179], v[188:191], v[56:59]
buffer_load_dwordx4 v245, s[12:15], s25 offen offset:128 lds
v_mfma_f32_16x16x32_bf16 v[60:63], v[176:179], v[212:215], v[140:143]
v_exp_f32 v221, v29
v_mfma_f32_16x16x32_bf16 v[60:63], v[180:183], v[208:211], v[60:63]
ds_read_b64_tr_b16 v[176:177], v242 offset:0
v_add_f32 v226, v226, v218
v_mfma_f32_16x16x32_bf16 v[60:63], v[172:175], v[204:207], v[60:63]
ds_read_b64_tr_b16 v[178:179], v242 offset:6144
v_cvt_pk_bf16_f32 v110, v220, v221
v_mfma_f32_16x16x32_bf16 v[60:63], v[168:171], v[200:203], v[60:63]
v_exp_f32 v222, v30
v_mfma_f32_16x16x32_bf16 v[60:63], v[164:167], v[196:199], v[60:63]
ds_read_b64_tr_b16 v[180:181], v242 offset:12288
v_add_f32 v220, v220, v221
v_mfma_f32_16x16x32_bf16 v[60:63], v[160:163], v[192:195], v[60:63]
ds_read_b64_tr_b16 v[182:183], v242 offset:18432
s_waitcnt lgkmcnt(4)
v_mfma_f32_16x16x32_bf16 a[0:3], v[144:147], v[64:67], a[0:3]
v_exp_f32 v223, v31
v_mfma_f32_16x16x32_bf16 a[0:3], v[148:151], v[80:83], a[0:3]
ds_read_b64_tr_b16 v[160:161], v243 offset:0
v_cvt_pk_bf16_f32 v111, v222, v223
v_mfma_f32_16x16x32_bf16 a[4:7], v[148:151], v[84:87], a[4:7]
v_exp_f32 v216, v32
v_mfma_f32_16x16x32_bf16 a[4:7], v[144:147], v[68:71], a[4:7]
ds_read_b64_tr_b16 v[162:163], v243 offset:6144
v_add_f32 v222, v222, v223
v_mfma_f32_16x16x32_bf16 a[8:11], v[144:147], v[72:75], a[8:11]
ds_read_b64_tr_b16 v[164:165], v243 offset:12288
v_add_f32 v227, v227, v220
v_mfma_f32_16x16x32_bf16 a[8:11], v[148:151], v[88:91], a[8:11]
v_exp_f32 v217, v33
v_mfma_f32_16x16x32_bf16 a[12:15], v[148:151], v[92:95], a[12:15]
ds_read_b64_tr_b16 v[166:167], v243 offset:18432
s_add_u32 m0, s24, 98176
v_mfma_f32_16x16x32_bf16 a[12:15], v[144:147], v[76:79], a[12:15]
buffer_load_dwordx4 v246, s[16:19], s25 offen offset:3200 lds
v_mfma_f32_16x16x32_bf16 a[16:19], v[152:155], v[64:67], a[16:19]
v_exp_f32 v218, v34
v_mfma_f32_16x16x32_bf16 a[16:19], v[156:159], v[80:83], a[16:19]
v_add_f32 v227, v227, v222
v_cvt_pk_bf16_f32 v112, v216, v217
v_mfma_f32_16x16x32_bf16 a[20:23], v[156:159], v[84:87], a[20:23]
ds_read_b64_tr_b16 v[168:169], v240 offset:2048
v_add_f32 v216, v216, v217
v_mfma_f32_16x16x32_bf16 a[20:23], v[152:155], v[68:71], a[20:23]
v_exp_f32 v219, v35
v_mfma_f32_16x16x32_bf16 a[24:27], v[152:155], v[72:75], a[24:27]
v_cvt_pk_bf16_f32 v113, v218, v219
v_add_f32 v218, v218, v219
v_mfma_f32_16x16x32_bf16 a[24:27], v[156:159], v[88:91], a[24:27]
v_exp_f32 v220, v36
v_mfma_f32_16x16x32_bf16 a[28:31], v[156:159], v[92:95], a[28:31]
ds_read_b64_tr_b16 v[170:171], v240 offset:8192
v_add_f32 v224, v224, v216
v_mfma_f32_16x16x32_bf16 a[28:31], v[152:155], v[76:79], a[28:31]
v_add_f32 v224, v224, v218
s_waitcnt lgkmcnt(2)
v_mfma_f32_16x16x32_bf16 a[32:35], v[176:179], v[64:67], a[32:35]
v_exp_f32 v221, v37
v_mfma_f32_16x16x32_bf16 a[32:35], v[180:183], v[80:83], a[32:35]
ds_read_b64_tr_b16 v[172:173], v240 offset:14336
v_cvt_pk_bf16_f32 v116, v220, v221
v_mfma_f32_16x16x32_bf16 a[36:39], v[180:183], v[84:87], a[36:39]
ds_read_b64_tr_b16 v[174:175], v240 offset:20480
v_add_f32 v220, v220, v221
v_mfma_f32_16x16x32_bf16 a[36:39], v[176:179], v[68:71], a[36:39]
v_exp_f32 v222, v38
v_mfma_f32_16x16x32_bf16 a[40:43], v[176:179], v[72:75], a[40:43]
ds_read_b64_tr_b16 v[144:145], v241 offset:2048
s_add_u32 m0, s24, 52992
v_mfma_f32_16x16x32_bf16 a[40:43], v[180:183], v[88:91], a[40:43]
ds_read_b64_tr_b16 v[146:147], v241 offset:8192
v_add_f32 v225, v225, v220
v_mfma_f32_16x16x32_bf16 a[44:47], v[180:183], v[92:95], a[44:47]
v_exp_f32 v223, v39
v_mfma_f32_16x16x32_bf16 a[44:47], v[176:179], v[76:79], a[44:47]
ds_read_b64_tr_b16 v[148:149], v241 offset:14336
v_cvt_pk_bf16_f32 v117, v222, v223
v_mfma_f32_16x16x32_bf16 a[48:51], v[160:163], v[64:67], a[48:51]
ds_read_b64_tr_b16 v[150:151], v241 offset:20480
v_add_f32 v222, v222, v223
v_mfma_f32_16x16x32_bf16 a[48:51], v[164:167], v[80:83], a[48:51]
buffer_load_dwordx4 v244, s[12:15], s25 offen offset:256 lds
v_mfma_f32_16x16x32_bf16 a[52:55], v[164:167], v[84:87], a[52:55]
v_exp_f32 v216, v40
v_mfma_f32_16x16x32_bf16 a[52:55], v[160:163], v[68:71], a[52:55]
v_exp_f32 v217, v41
v_mfma_f32_16x16x32_bf16 a[56:59], v[160:163], v[72:75], a[56:59]
ds_read_b64_tr_b16 v[176:177], v242 offset:2048
v_add_f32 v225, v225, v222
v_mfma_f32_16x16x32_bf16 a[56:59], v[164:167], v[88:91], a[56:59]
ds_read_b64_tr_b16 v[178:179], v242 offset:8192
v_cvt_pk_bf16_f32 v120, v216, v217
v_mfma_f32_16x16x32_bf16 a[60:63], v[164:167], v[92:95], a[60:63]
v_exp_f32 v218, v42
v_mfma_f32_16x16x32_bf16 a[60:63], v[160:163], v[76:79], a[60:63]
ds_read_b64_tr_b16 v[180:181], v242 offset:14336
s_waitcnt lgkmcnt(3)
v_mfma_f32_16x16x32_bf16 a[64:67], v[168:171], v[64:67], a[64:67]
ds_read_b64_tr_b16 v[182:183], v242 offset:20480
v_add_f32 v216, v216, v217
v_mfma_f32_16x16x32_bf16 a[64:67], v[172:175], v[80:83], a[64:67]
v_exp_f32 v219, v43
v_mfma_f32_16x16x32_bf16 a[68:71], v[172:175], v[84:87], a[68:71]
ds_read_b64_tr_b16 v[160:161], v243 offset:2048
s_add_u32 m0, s24, 102144
v_mfma_f32_16x16x32_bf16 a[68:71], v[168:171], v[68:71], a[68:71]
v_exp_f32 v220, v44
v_mfma_f32_16x16x32_bf16 a[72:75], v[168:171], v[72:75], a[72:75]
buffer_load_dwordx4 v246, s[16:19], s25 offen offset:256 lds
v_mfma_f32_16x16x32_bf16 a[72:75], v[172:175], v[88:91], a[72:75]
ds_read_b64_tr_b16 v[162:163], v243 offset:8192
v_cvt_pk_bf16_f32 v121, v218, v219
v_mfma_f32_16x16x32_bf16 a[76:79], v[172:175], v[92:95], a[76:79]
v_exp_f32 v221, v45
v_mfma_f32_16x16x32_bf16 a[76:79], v[168:171], v[76:79], a[76:79]
ds_read_b64_tr_b16 v[164:165], v243 offset:14336
v_add_f32 v218, v218, v219
v_mfma_f32_16x16x32_bf16 a[80:83], v[144:147], v[64:67], a[80:83]
ds_read_b64_tr_b16 v[166:167], v243 offset:20480
v_add_f32 v226, v226, v216
v_mfma_f32_16x16x32_bf16 a[80:83], v[148:151], v[80:83], a[80:83]
v_exp_f32 v222, v46
v_mfma_f32_16x16x32_bf16 a[84:87], v[148:151], v[84:87], a[84:87]
v_add_f32 v226, v226, v218
v_cvt_pk_bf16_f32 v124, v220, v221
v_mfma_f32_16x16x32_bf16 a[84:87], v[144:147], v[68:71], a[84:87]
ds_read_b64_tr_b16 v[152:153], v240 offset:4096
v_add_f32 v220, v220, v221
v_mfma_f32_16x16x32_bf16 a[88:91], v[144:147], v[72:75], a[88:91]
v_exp_f32 v223, v47
v_mfma_f32_16x16x32_bf16 a[88:91], v[148:151], v[88:91], a[88:91]
v_cvt_pk_bf16_f32 v125, v222, v223
v_add_f32 v222, v222, v223
v_mfma_f32_16x16x32_bf16 a[92:95], v[148:151], v[92:95], a[92:95]
v_exp_f32 v216, v48
v_mfma_f32_16x16x32_bf16 a[92:95], v[144:147], v[76:79], a[92:95]
s_add_u32 m0, s24, 54016
s_waitcnt lgkmcnt(1)
v_mfma_f32_16x16x32_bf16 a[96:99], v[176:179], v[64:67], a[96:99]
buffer_load_dwordx4 v245, s[12:15], s25 offen offset:256 lds
v_mfma_f32_16x16x32_bf16 a[96:99], v[180:183], v[80:83], a[96:99]
v_exp_f32 v217, v49
v_mfma_f32_16x16x32_bf16 a[100:103], v[180:183], v[84:87], a[100:103]
ds_read_b64_tr_b16 v[154:155], v240 offset:10240
v_add_f32 v227, v227, v220
v_mfma_f32_16x16x32_bf16 a[100:103], v[176:179], v[68:71], a[100:103]
ds_read_b64_tr_b16 v[156:157], v240 offset:16384
v_add_f32 v227, v227, v222
v_mfma_f32_16x16x32_bf16 a[104:107], v[176:179], v[72:75], a[104:107]
v_exp_f32 v218, v50
v_mfma_f32_16x16x32_bf16 a[104:107], v[180:183], v[88:91], a[104:107]
ds_read_b64_tr_b16 v[158:159], v240 offset:22528
v_cvt_pk_bf16_f32 v114, v216, v217
v_mfma_f32_16x16x32_bf16 a[108:111], v[180:183], v[92:95], a[108:111]
ds_read_b64_tr_b16 v[144:145], v241 offset:4096
v_add_f32 v216, v216, v217
v_mfma_f32_16x16x32_bf16 a[108:111], v[176:179], v[76:79], a[108:111]
ds_read_b64_tr_b16 v[146:147], v241 offset:10240
v_add_f32 v224, v224, v216
v_mfma_f32_16x16x32_bf16 a[112:115], v[160:163], v[64:67], a[112:115]
ds_read_b64_tr_b16 v[148:149], v241 offset:16384
ds_read_b64_tr_b16 v[150:151], v241 offset:22528
v_mfma_f32_16x16x32_bf16 a[112:115], v[164:167], v[80:83], a[112:115]
v_exp_f32 v219, v51
v_mfma_f32_16x16x32_bf16 a[116:119], v[164:167], v[84:87], a[116:119]
v_exp_f32 v220, v52
v_mfma_f32_16x16x32_bf16 a[116:119], v[160:163], v[68:71], a[116:119]
v_cvt_pk_bf16_f32 v115, v218, v219
v_add_f32 v218, v218, v219
v_mfma_f32_16x16x32_bf16 a[120:123], v[160:163], v[72:75], a[120:123]
v_exp_f32 v221, v53
v_mfma_f32_16x16x32_bf16 a[120:123], v[164:167], v[88:91], a[120:123]
s_add_u32 m0, s24, 100096
v_add_f32 v224, v224, v218
v_mfma_f32_16x16x32_bf16 a[124:127], v[164:167], v[92:95], a[124:127]
buffer_load_dwordx4 v246, s[16:19], s25 offen offset:3328 lds
v_mfma_f32_16x16x32_bf16 a[124:127], v[160:163], v[76:79], a[124:127]
ds_read_b64_tr_b16 v[176:177], v242 offset:4096
s_waitcnt lgkmcnt(1)
v_mfma_f32_16x16x32_bf16 a[128:131], v[152:155], v[64:67], a[128:131]
v_exp_f32 v222, v54
v_mfma_f32_16x16x32_bf16 a[128:131], v[156:159], v[80:83], a[128:131]
ds_read_b64_tr_b16 v[178:179], v242 offset:10240
v_cvt_pk_bf16_f32 v118, v220, v221
v_mfma_f32_16x16x32_bf16 a[132:135], v[156:159], v[84:87], a[132:135]
v_exp_f32 v223, v55
v_mfma_f32_16x16x32_bf16 a[132:135], v[152:155], v[68:71], a[132:135]
ds_read_b64_tr_b16 v[180:181], v242 offset:16384
v_add_f32 v220, v220, v221
v_mfma_f32_16x16x32_bf16 a[136:139], v[152:155], v[72:75], a[136:139]
v_exp_f32 v216, v56
v_mfma_f32_16x16x32_bf16 a[136:139], v[156:159], v[88:91], a[136:139]
ds_read_b64_tr_b16 v[182:183], v242 offset:22528
v_cvt_pk_bf16_f32 v119, v222, v223
v_mfma_f32_16x16x32_bf16 a[140:143], v[156:159], v[92:95], a[140:143]
ds_read_b64_tr_b16 v[168:169], v243 offset:4096
v_add_f32 v222, v222, v223
v_mfma_f32_16x16x32_bf16 a[140:143], v[152:155], v[76:79], a[140:143]
ds_read_b64_tr_b16 v[170:171], v243 offset:10240
v_add_f32 v225, v225, v220
v_mfma_f32_16x16x32_bf16 a[144:147], v[144:147], v[64:67], a[144:147]
ds_read_b64_tr_b16 v[172:173], v243 offset:16384
ds_read_b64_tr_b16 v[174:175], v243 offset:22528
v_mfma_f32_16x16x32_bf16 a[144:147], v[148:151], v[80:83], a[144:147]
v_exp_f32 v217, v57
v_mfma_f32_16x16x32_bf16 a[148:151], v[148:151], v[84:87], a[148:151]
v_exp_f32 v218, v58
v_mfma_f32_16x16x32_bf16 a[148:151], v[144:147], v[68:71], a[148:151]
v_add_f32 v225, v225, v222
v_cvt_pk_bf16_f32 v122, v216, v217
v_mfma_f32_16x16x32_bf16 a[152:155], v[144:147], v[72:75], a[152:155]
s_add_u32 s25, s25, 24576
v_add_f32 v216, v216, v217
v_mfma_f32_16x16x32_bf16 a[152:155], v[148:151], v[88:91], a[152:155]
v_exp_f32 v219, v59
v_mfma_f32_16x16x32_bf16 a[156:159], v[148:151], v[92:95], a[156:159]
v_cvt_pk_bf16_f32 v123, v218, v219
v_add_f32 v218, v218, v219
v_mfma_f32_16x16x32_bf16 a[156:159], v[144:147], v[76:79], a[156:159]
s_waitcnt vmcnt(12) lgkmcnt(0)
s_barrier
v_mfma_f32_16x16x32_bf16 a[160:163], v[176:179], v[64:67], a[160:163]
v_exp_f32 v220, v60
v_mfma_f32_16x16x32_bf16 a[160:163], v[180:183], v[80:83], a[160:163]
ds_read_b128 v[144:147], v232 offset:24576
v_add_f32 v226, v226, v216
v_mfma_f32_16x16x32_bf16 a[164:167], v[180:183], v[84:87], a[164:167]
v_exp_f32 v221, v61
v_mfma_f32_16x16x32_bf16 a[164:167], v[176:179], v[68:71], a[164:167]
ds_read_b128 v[148:151], v233 offset:24576
v_cvt_pk_bf16_f32 v126, v220, v221
v_mfma_f32_16x16x32_bf16 a[168:171], v[176:179], v[72:75], a[168:171]
ds_read_b128 v[152:155], v232 offset:26624
v_add_f32 v220, v220, v221
v_mfma_f32_16x16x32_bf16 a[168:171], v[180:183], v[88:91], a[168:171]
v_exp_f32 v222, v62
v_mfma_f32_16x16x32_bf16 a[172:175], v[180:183], v[92:95], a[172:175]
ds_read_b128 v[156:159], v233 offset:26624
v_add_f32 v226, v226, v218
v_mfma_f32_16x16x32_bf16 a[172:175], v[176:179], v[76:79], a[172:175]
v_exp_f32 v223, v63
v_mfma_f32_16x16x32_bf16 a[176:179], v[168:171], v[64:67], a[176:179]
v_cvt_pk_bf16_f32 v127, v222, v223
v_add_f32 v222, v222, v223
v_mfma_f32_16x16x32_bf16 a[176:179], v[172:175], v[80:83], a[176:179]
ds_read_b128 v[176:179], v232 offset:28672
v_add_f32 v227, v227, v220
v_mfma_f32_16x16x32_bf16 a[180:183], v[172:175], v[84:87], a[180:183]
ds_read_b128 v[180:183], v233 offset:28672
v_add_f32 v227, v227, v222
v_mfma_f32_16x16x32_bf16 a[180:183], v[168:171], v[68:71], a[180:183]
v_max3_f32 v247, v224, v225, v226
v_mfma_f32_16x16x32_bf16 a[184:187], v[168:171], v[72:75], a[184:187]
v_max_f32 v247, v247, v227
v_mfma_f32_16x16x32_bf16 a[184:187], v[172:175], v[88:91], a[184:187]
v_cmp_lt_f32 vcc, s27, v247
v_mfma_f32_16x16x32_bf16 a[188:191], v[172:175], v[92:95], a[188:191]
s_waitcnt lgkmcnt(2)
v_mfma_f32_16x16x32_bf16 a[188:191], v[168:171], v[76:79], a[188:191]
s_cbranch_vccnz L_stub_2
L_back_2:
v_mfma_f32_16x16x32_bf16 v[0:3], v[144:147], a[192:195], v[128:131]
v_add_f32 v228, v228, v224
v_add_f32 v229, v229, v225
v_mfma_f32_16x16x32_bf16 v[0:3], v[148:151], a[196:199], v[0:3]
v_add_f32 v230, v230, v226
v_add_f32 v231, v231, v227
v_mfma_f32_16x16x32_bf16 v[0:3], v[152:155], a[200:203], v[0:3]
v_mfma_f32_16x16x32_bf16 v[0:3], v[156:159], a[204:207], v[0:3]
s_add_u32 m0, s24, 0
s_waitcnt lgkmcnt(0)
v_mfma_f32_16x16x32_bf16 v[0:3], v[176:179], a[208:211], v[0:3]
buffer_load_dwordx4 v244, s[12:15], s25 offen lds
v_mfma_f32_16x16x32_bf16 v[0:3], v[180:183], a[212:215], v[0:3]
v_mfma_f32_16x16x32_bf16 v[4:7], v[180:183], a[236:239], v[132:135]
v_mfma_f32_16x16x32_bf16 v[4:7], v[176:179], a[232:235], v[4:7]
ds_read_b128 v[160:163], v232 offset:30720
v_mfma_f32_16x16x32_bf16 v[4:7], v[156:159], a[228:231], v[4:7]
ds_read_b128 v[164:167], v233 offset:30720
v_mfma_f32_16x16x32_bf16 v[4:7], v[152:155], a[224:227], v[4:7]
ds_read_b128 v[168:171], v232 offset:32768
v_mfma_f32_16x16x32_bf16 v[4:7], v[148:151], a[220:223], v[4:7]
v_exp_f32 v216, v0
v_mfma_f32_16x16x32_bf16 v[4:7], v[144:147], a[216:219], v[4:7]
ds_read_b128 v[172:175], v233 offset:32768
v_mfma_f32_16x16x32_bf16 v[8:11], v[144:147], a[240:243], v[136:139]
v_exp_f32 v217, v1
v_mfma_f32_16x16x32_bf16 v[8:11], v[148:151], a[244:247], v[8:11]
v_cvt_pk_bf16_f32 v64, v216, v217
v_add_f32 v216, v216, v217
v_mfma_f32_16x16x32_bf16 v[8:11], v[152:155], a[248:251], v[8:11]
v_exp_f32 v218, v2
v_mfma_f32_16x16x32_bf16 v[8:11], v[156:159], a[252:255], v[8:11]
v_exp_f32 v219, v3
v_mfma_f32_16x16x32_bf16 v[8:11], v[176:179], v[184:187], v[8:11]
v_cvt_pk_bf16_f32 v65, v218, v219
v_add_f32 v218, v218, v219
v_mfma_f32_16x16x32_bf16 v[8:11], v[180:183], v[188:191], v[8:11]
s_add_u32 m0, s24, 122880
v_add_f32 v224, v216, v218
v_mfma_f32_16x16x32_bf16 v[12:15], v[180:183], v[212:215], v[140:143]
ds_read_b128 v[180:183], v232 offset:34816
v_mfma_f32_16x16x32_bf16 v[12:15], v[176:179], v[208:211], v[12:15]
ds_read_b128 v[176:179], v233 offset:34816
v_mfma_f32_16x16x32_bf16 v[12:15], v[156:159], v[204:207], v[12:15]
buffer_load_dwordx4 v246, s[16:19], s25 offen lds
v_mfma_f32_16x16x32_bf16 v[12:15], v[152:155], v[200:203], v[12:15]
v_exp_f32 v220, v4
v_mfma_f32_16x16x32_bf16 v[12:15], v[148:151], v[196:199], v[12:15]
v_exp_f32 v221, v5
v_mfma_f32_16x16x32_bf16 v[12:15], v[144:147], v[192:195], v[12:15]
v_cvt_pk_bf16_f32 v68, v220, v221
s_waitcnt lgkmcnt(2)
v_mfma_f32_16x16x32_bf16 v[16:19], v[160:163], a[192:195], v[128:131]
v_add_f32 v220, v220, v221
v_mfma_f32_16x16x32_bf16 v[16:19], v[164:167], a[196:199], v[16:19]
v_exp_f32 v222, v6
v_mfma_f32_16x16x32_bf16 v[16:19], v[168:171], a[200:203], v[16:19]
v_exp_f32 v223, v7
v_mfma_f32_16x16x32_bf16 v[16:19], v[172:175], a[204:207], v[16:19]
v_cvt_pk_bf16_f32 v69, v222, v223
s_waitcnt lgkmcnt(0)
v_mfma_f32_16x16x32_bf16 v[16:19], v[180:183], a[208:211], v[16:19]
v_add_f32 v222, v222, v223
v_mfma_f32_16x16x32_bf16 v[16:19], v[176:179], a[212:215], v[16:19]
v_add_f32 v225, v220, v222
v_mfma_f32_16x16x32_bf16 v[20:23], v[176:179], a[236:239], v[132:135]
v_exp_f32 v216, v8
v_mfma_f32_16x16x32_bf16 v[20:23], v[180:183], a[232:235], v[20:23]
ds_read_b128 v[144:147], v232 offset:36864
s_add_u32 m0, s24, 1024
v_mfma_f32_16x16x32_bf16 v[20:23], v[172:175], a[228:231], v[20:23]
buffer_load_dwordx4 v245, s[12:15], s25 offen lds
v_mfma_f32_16x16x32_bf16 v[20:23], v[168:171], a[224:227], v[20:23]
ds_read_b128 v[148:151], v233 offset:36864
v_mfma_f32_16x16x32_bf16 v[20:23], v[164:167], a[220:223], v[20:23]
ds_read_b128 v[152:155], v232 offset:38912
v_mfma_f32_16x16x32_bf16 v[20:23], v[160:163], a[216:219], v[20:23]
v_exp_f32 v217, v9
v_mfma_f32_16x16x32_bf16 v[24:27], v[160:163], a[240:243], v[136:139]
ds_read_b128 v[156:159], v233 offset:38912
v_cvt_pk_bf16_f32 v72, v216, v217
v_mfma_f32_16x16x32_bf16 v[24:27], v[164:167], a[244:247], v[24:27]
v_add_f32 v216, v216, v217
v_mfma_f32_16x16x32_bf16 v[24:27], v[168:171], a[248:251], v[24:27]
v_exp_f32 v218, v10
v_mfma_f32_16x16x32_bf16 v[24:27], v[172:175], a[252:255], v[24:27]
v_exp_f32 v219, v11
v_mfma_f32_16x16x32_bf16 v[24:27], v[180:183], v[184:187], v[24:27]
v_cvt_pk_bf16_f32 v73, v218, v219
v_add_f32 v218, v218, v219
v_mfma_f32_16x16x32_bf16 v[24:27], v[176:179], v[188:191], v[24:27]
v_add_f32 v226, v216, v218
v_mfma_f32_16x16x32_bf16 v[28:31], v[176:179], v[212:215], v[140:143]
ds_read_b128 v[176:179], v232 offset:40960
v_mfma_f32_16x16x32_bf16 v[28:31], v[180:183], v[208:211], v[28:31]
ds_read_b128 v[180:183], v233 offset:40960
v_mfma_f32_16x16x32_bf16 v[28:31], v[172:175], v[204:207], v[28:31]
v_exp_f32 v220, v12
v_mfma_f32_16x16x32_bf16 v[28:31], v[168:171], v[200:203], v[28:31]
s_add_u32 m0, s24, 120832
v_mfma_f32_16x16x32_bf16 v[28:31], v[164:167], v[196:199], v[28:31]
v_exp_f32 v221, v13
v_mfma_f32_16x16x32_bf16 v[28:31], v[160:163], v[192:195], v[28:31]
v_cvt_pk_bf16_f32 v76, v220, v221
s_waitcnt lgkmcnt(2)
v_mfma_f32_16x16x32_bf16 v[32:35], v[144:147], a[192:195], v[128:131]
buffer_load_dwordx4 v246, s[16:19], s25 offen offset:3072 lds
v_mfma_f32_16x16x32_bf16 v[32:35], v[148:151], a[196:199], v[32:35]
v_exp_f32 v222, v14
v_mfma_f32_16x16x32_bf16 v[32:35], v[152:155], a[200:203], v[32:35]
v_add_f32 v220, v220, v221
v_mfma_f32_16x16x32_bf16 v[32:35], v[156:159], a[204:207], v[32:35]
s_waitcnt lgkmcnt(0)
v_mfma_f32_16x16x32_bf16 v[32:35], v[176:179], a[208:211], v[32:35]
v_exp_f32 v223, v15
v_mfma_f32_16x16x32_bf16 v[32:35], v[180:183], a[212:215], v[32:35]
v_cvt_pk_bf16_f32 v77, v222, v223
v_add_f32 v222, v222, v223
v_mfma_f32_16x16x32_bf16 v[36:39], v[180:183], a[236:239], v[132:135]
v_exp_f32 v216, v16
v_mfma_f32_16x16x32_bf16 v[36:39], v[176:179], a[232:235], v[36:39]
ds_read_b128 v[160:163], v232 offset:43008
v_add_f32 v227, v220, v222
v_mfma_f32_16x16x32_bf16 v[36:39], v[156:159], a[228:231], v[36:39]
ds_read_b128 v[164:167], v233 offset:43008
v_mfma_f32_16x16x32_bf16 v[36:39], v[152:155], a[224:227], v[36:39]
v_exp_f32 v217, v17
v_mfma_f32_16x16x32_bf16 v[36:39], v[148:151], a[220:223], v[36:39]
ds_read_b128 v[168:171], v232 offset:45056
v_cvt_pk_bf16_f32 v66, v216, v217
v_mfma_f32_16x16x32_bf16 v[36:39], v[144:147], a[216:219], v[36:39]
ds_read_b128 v[172:175], v233 offset:45056
s_add_u32 m0, s24, 1920
v_mfma_f32_16x16x32_bf16 v[40:43], v[144:147], a[240:243], v[136:139]
v_exp_f32 v218, v18
v_mfma_f32_16x16x32_bf16 v[40:43], v[148:151], a[244:247], v[40:43]
buffer_load_dwordx4 v244, s[12:15], s25 offen offset:128 lds
v_mfma_f32_16x16x32_bf16 v[40:43], v[152:155], a[248:251], v[40:43]
v_add_f32 v216, v216, v217
v_mfma_f32_16x16x32_bf16 v[40:43], v[156:159], a[252:255], v[40:43]
v_exp_f32 v219, v19
v_mfma_f32_16x16x32_bf16 v[40:43], v[176:179], v[184:187], v[40:43]
v_cvt_pk_bf16_f32 v67, v218, v219
v_add_f32 v218, v218, v219
v_mfma_f32_16x16x32_bf16 v[40:43], v[180:183], v[188:191], v[40:43]
v_exp_f32 v220, v20
v_mfma_f32_16x16x32_bf16 v[44:47], v[180:183], v[212:215], v[140:143]
ds_read_b128 v[180:183], v232 offset:47104
v_add_f32 v224, v224, v216
v_mfma_f32_16x16x32_bf16 v[44:47], v[176:179], v[208:211], v[44:47]
ds_read_b128 v[176:179], v233 offset:47104
v_add_f32 v224, v224, v218
v_mfma_f32_16x16x32_bf16 v[44:47], v[156:159], v[204:207], v[44:47]
v_exp_f32 v221, v21
v_mfma_f32_16x16x32_bf16 v[44:47], v[152:155], v[200:203], v[44:47]
v_cvt_pk_bf16_f32 v70, v220, v221
v_add_f32 v220, v220, v221
v_mfma_f32_16x16x32_bf16 v[44:47], v[148:151], v[196:199], v[44:47]
v_add_f32 v225, v225, v220
v_mfma_f32_16x16x32_bf16 v[44:47], v[144:147], v[192:195], v[44:47]
ds_read_b64_tr_b16 v[144:145], v236 offset:0
s_waitcnt lgkmcnt(3)
v_mfma_f32_16x16x32_bf16 v[48:51], v[160:163], a[192:195], v[128:131]
v_exp_f32 v222, v22
v_mfma_f32_16x16x32_bf16 v[48:51], v[164:167], a[196:199], v[48:51]
ds_read_b64_tr_b16 v[146:147], v236 offset:6144
s_add_u32 m0, s24, 124800
v_mfma_f32_16x16x32_bf16 v[48:51], v[168:171], a[200:203], v[48:51]
v_exp_f32 v223, v23
v_mfma_f32_16x16x32_bf16 v[48:51], v[172:175], a[204:207], v[48:51]
v_cvt_pk_bf16_f32 v71, v222, v223
s_waitcnt lgkmcnt(2)
v_mfma_f32_16x16x32_bf16 v[48:51], v[180:183], a[208:211], v[48:51]
v_exp_f32 v216, v24
v_mfma_f32_16x16x32_bf16 v[48:51], v[176:179], a[212:215], v[48:51]
buffer_load_dwordx4 v246, s[16:19], s25 offen offset:128 lds
v_mfma_f32_16x16x32_bf16 v[52:55], v[176:179], a[236:239], v[132:135]
ds_read_b64_tr_b16 v[148:149], v236 offset:12288
v_add_f32 v222, v222, v223
v_mfma_f32_16x16x32_bf16 v[52:55], v[180:183], a[232:235], v[52:55]
v_exp_f32 v217, v25
v_mfma_f32_16x16x32_bf16 v[52:55], v[172:175], a[228:231], v[52:55]
ds_read_b64_tr_b16 v[150:151], v236 offset:18432
v_add_f32 v225, v225, v222
v_mfma_f32_16x16x32_bf16 v[52:55], v[168:171], a[224:227], v[52:55]
ds_read_b64_tr_b16 v[152:153], v237 offset:0
v_cvt_pk_bf16_f32 v74, v216, v217
v_mfma_f32_16x16x32_bf16 v[52:55], v[164:167], a[220:223], v[52:55]
v_exp_f32 v218, v26
v_mfma_f32_16x16x32_bf16 v[52:55], v[160:163], a[216:219], v[52:55]
ds_read_b64_tr_b16 v[154:155], v237 offset:6144
v_add_f32 v216, v216, v217
v_mfma_f32_16x16x32_bf16 v[56:59], v[160:163], a[240:243], v[136:139]
ds_read_b64_tr_b16 v[156:157], v237 offset:12288
v_add_f32 v226, v226, v216
v_mfma_f32_16x16x32_bf16 v[56:59], v[164:167], a[244:247], v[56:59]
v_exp_f32 v219, v27
v_mfma_f32_16x16x32_bf16 v[56:59], v[168:171], a[248:251], v[56:59]
ds_read_b64_tr_b16 v[158:159], v237 offset:18432
v_cvt_pk_bf16_f32 v75, v218, v219
v_mfma_f32_16x16x32_bf16 v[56:59], v[172:175], a[252:255], v[56:59]
v_exp_f32 v220, v28
v_mfma_f32_16x16x32_bf16 v[56:59], v[180:183], v[184:187], v[56:59]
s_add_u32 m0, s24, 2944
v_add_f32 v218, v218, v219
v_mfma_f32_16x16x32_bf16 v[56:59], v[176:179], v[188:191], v[56:59]
buffer_load_dwordx4 v245, s[12:15], s25 offen offset:128 lds
v_mfma_f32_16x16x32_bf16 v[60:63], v[176:179], v[212:215], v[140:143]
v_exp_f32 v221, v29
v_mfma_f32_16x16x32_bf16 v[60:63], v[180:183], v[208:211], v[60:63]
ds_read_b64_tr_b16 v[176:177], v238 offset:0
v_add_f32 v226, v226, v218
v_mfma_f32_16x16x32_bf16 v[60:63], v[172:175], v[204:207], v[60:63]
ds_read_b64_tr_b16 v[178:179], v238 offset:6144
v_cvt_pk_bf16_f32 v78, v220, v221
v_mfma_f32_16x16x32_bf16 v[60:63], v[168:171], v[200:203], v[60:63]
v_exp_f32 v222, v30
v_mfma_f32_16x16x32_bf16 v[60:63], v[164:167], v[196:199], v[60:63]
ds_read_b64_tr_b16 v[180:181], v238 offset:12288
v_add_f32 v220, v220, v221
v_mfma_f32_16x16x32_bf16 v[60:63], v[160:163], v[192:195], v[60:63]
ds_read_b64_tr_b16 v[182:183], v238 offset:18432
s_waitcnt lgkmcnt(4)
v_mfma_f32_16x16x32_bf16 a[0:3], v[144:147], v[96:99], a[0:3]
v_exp_f32 v223, v31
v_mfma_f32_16x16x32_bf16 a[0:3], v[148:151], v[112:115], a[0:3]
ds_read_b64_tr_b16 v[160:161], v239 offset:0
v_cvt_pk_bf16_f32 v79, v222, v223
v_mfma_f32_16x16x32_bf16 a[4:7], v[148:151], v[116:119], a[4:7]
v_exp_f32 v216, v32
v_mfma_f32_16x16x32_bf16 a[4:7], v[144:147], v[100:103], a[4:7]
ds_read_b64_tr_b16 v[162:163], v239 offset:6144
v_add_f32 v222, v222, v223
v_mfma_f32_16x16x32_bf16 a[8:11], v[144:147], v[104:107], a[8:11]
ds_read_b64_tr_b16 v[164:165], v239 offset:12288
v_add_f32 v227, v227, v220
v_mfma_f32_16x16x32_bf16 a[8:11], v[148:151], v[120:123], a[8:11]
v_exp_f32 v217, v33
v_mfma_f32_16x16x32_bf16 a[12:15], v[148:151], v[124:127], a[12:15]
ds_read_b64_tr_b16 v[166:167], v239 offset:18432
s_add_u32 m0, s24, 122752
v_mfma_f32_16x16x32_bf16 a[12:15], v[144:147], v[108:111], a[12:15]
buffer_load_dwordx4 v246, s[16:19], s25 offen offset:3200 lds
v_mfma_f32_16x16x32_bf16 a[16:19], v[152:155], v[96:99], a[16:19]
v_exp_f32 v218, v34
v_mfma_f32_16x16x32_bf16 a[16:19], v[156:159], v[112:115], a[16:19]
v_add_f32 v227, v227, v222
v_cvt_pk_bf16_f32 v80, v216, v217
v_mfma_f32_16x16x32_bf16 a[20:23], v[156:159], v[116:119], a[20:23]
ds_read_b64_tr_b16 v[168:169], v236 offset:2048
v_add_f32 v216, v216, v217
v_mfma_f32_16x16x32_bf16 a[20:23], v[152:155], v[100:103], a[20:23]
v_exp_f32 v219, v35
v_mfma_f32_16x16x32_bf16 a[24:27], v[152:155], v[104:107], a[24:27]
v_cvt_pk_bf16_f32 v81, v218, v219
v_add_f32 v218, v218, v219
v_mfma_f32_16x16x32_bf16 a[24:27], v[156:159], v[120:123], a[24:27]
v_exp_f32 v220, v36
v_mfma_f32_16x16x32_bf16 a[28:31], v[156:159], v[124:127], a[28:31]
ds_read_b64_tr_b16 v[170:171], v236 offset:8192
v_add_f32 v224, v224, v216
v_mfma_f32_16x16x32_bf16 a[28:31], v[152:155], v[108:111], a[28:31]
v_add_f32 v224, v224, v218
s_waitcnt lgkmcnt(2)
v_mfma_f32_16x16x32_bf16 a[32:35], v[176:179], v[96:99], a[32:35]
v_exp_f32 v221, v37
v_mfma_f32_16x16x32_bf16 a[32:35], v[180:183], v[112:115], a[32:35]
ds_read_b64_tr_b16 v[172:173], v236 offset:14336
v_cvt_pk_bf16_f32 v84, v220, v221
v_mfma_f32_16x16x32_bf16 a[36:39], v[180:183], v[116:119], a[36:39]
ds_read_b64_tr_b16 v[174:175], v236 offset:20480
v_add_f32 v220, v220, v221
v_mfma_f32_16x16x32_bf16 a[36:39], v[176:179], v[100:103], a[36:39]
v_exp_f32 v222, v38
v_mfma_f32_16x16x32_bf16 a[40:43], v[176:179], v[104:107], a[40:43]
ds_read_b64_tr_b16 v[144:145], v237 offset:2048
s_add_u32 m0, s24, 3840
v_mfma_f32_16x16x32_bf16 a[40:43], v[180:183], v[120:123], a[40:43]
ds_read_b64_tr_b16 v[146:147], v237 offset:8192
v_add_f32 v225, v225, v220
v_mfma_f32_16x16x32_bf16 a[44:47], v[180:183], v[124:127], a[44:47]
v_exp_f32 v223, v39
v_mfma_f32_16x16x32_bf16 a[44:47], v[176:179], v[108:111], a[44:47]
ds_read_b64_tr_b16 v[148:149], v237 offset:14336
v_cvt_pk_bf16_f32 v85, v222, v223
v_mfma_f32_16x16x32_bf16 a[48:51], v[160:163], v[96:99], a[48:51]
ds_read_b64_tr_b16 v[150:151], v237 offset:20480
v_add_f32 v222, v222, v223
v_mfma_f32_16x16x32_bf16 a[48:51], v[164:167], v[112:115], a[48:51]
buffer_load_dwordx4 v244, s[12:15], s25 offen offset:256 lds
v_mfma_f32_16x16x32_bf16 a[52:55], v[164:167], v[116:119], a[52:55]
v_exp_f32 v216, v40
v_mfma_f32_16x16x32_bf16 a[52:55], v[160:163], v[100:103], a[52:55]
v_exp_f32 v217, v41
v_mfma_f32_16x16x32_bf16 a[56:59], v[160:163], v[104:107], a[56:59]
ds_read_b64_tr_b16 v[176:177], v238 offset:2048
v_add_f32 v225, v225, v222
v_mfma_f32_16x16x32_bf16 a[56:59], v[164:167], v[120:123], a[56:59]
ds_read_b64_tr_b16 v[178:179], v238 offset:8192
v_cvt_pk_bf16_f32 v88, v216, v217
v_mfma_f32_16x16x32_bf16 a[60:63], v[164:167], v[124:127], a[60:63]
v_exp_f32 v218, v42
v_mfma_f32_16x16x32_bf16 a[60:63], v[160:163], v[108:111], a[60:63]
ds_read_b64_tr_b16 v[180:181], v238 offset:14336
s_waitcnt lgkmcnt(3)
v_mfma_f32_16x16x32_bf16 a[64:67], v[168:171], v[96:99], a[64:67]
ds_read_b64_tr_b16 v[182:183], v238 offset:20480
v_add_f32 v216, v216, v217
v_mfma_f32_16x16x32_bf16 a[64:67], v[172:175], v[112:115], a[64:67]
v_exp_f32 v219, v43
v_mfma_f32_16x16x32_bf16 a[68:71], v[172:175], v[116:119], a[68:71]
ds_read_b64_tr_b16 v[160:161], v239 offset:2048
s_add_u32 m0, s24, 126720
v_mfma_f32_16x16x32_bf16 a[68:71], v[168:171], v[100:103], a[68:71]
v_exp_f32 v220, v44
v_mfma_f32_16x16x32_bf16 a[72:75], v[168:171], v[104:107], a[72:75]
buffer_load_dwordx4 v246, s[16:19], s25 offen offset:256 lds
v_mfma_f32_16x16x32_bf16 a[72:75], v[172:175], v[120:123], a[72:75]
ds_read_b64_tr_b16 v[162:163], v239 offset:8192
v_cvt_pk_bf16_f32 v89, v218, v219
v_mfma_f32_16x16x32_bf16 a[76:79], v[172:175], v[124:127], a[76:79]
v_exp_f32 v221, v45
v_mfma_f32_16x16x32_bf16 a[76:79], v[168:171], v[108:111], a[76:79]
ds_read_b64_tr_b16 v[164:165], v239 offset:14336
v_add_f32 v218, v218, v219
v_mfma_f32_16x16x32_bf16 a[80:83], v[144:147], v[96:99], a[80:83]
ds_read_b64_tr_b16 v[166:167], v239 offset:20480
v_add_f32 v226, v226, v216
v_mfma_f32_16x16x32_bf16 a[80:83], v[148:151], v[112:115], a[80:83]
v_exp_f32 v222, v46
v_mfma_f32_16x16x32_bf16 a[84:87], v[148:151], v[116:119], a[84:87]
v_add_f32 v226, v226, v218
v_cvt_pk_bf16_f32 v92, v220, v221
v_mfma_f32_16x16x32_bf16 a[84:87], v[144:147], v[100:103], a[84:87]
ds_read_b64_tr_b16 v[152:153], v236 offset:4096
v_add_f32 v220, v220, v221
v_mfma_f32_16x16x32_bf16 a[88:91], v[144:147], v[104:107], a[88:91]
v_exp_f32 v223, v47
v_mfma_f32_16x16x32_bf16 a[88:91], v[148:151], v[120:123], a[88:91]
v_cvt_pk_bf16_f32 v93, v222, v223
v_add_f32 v222, v222, v223
v_mfma_f32_16x16x32_bf16 a[92:95], v[148:151], v[124:127], a[92:95]
v_exp_f32 v216, v48
v_mfma_f32_16x16x32_bf16 a[92:95], v[144:147], v[108:111], a[92:95]
s_add_u32 m0, s24, 4864
s_waitcnt lgkmcnt(1)
v_mfma_f32_16x16x32_bf16 a[96:99], v[176:179], v[96:99], a[96:99]
buffer_load_dwordx4 v245, s[12:15], s25 offen offset:256 lds
v_mfma_f32_16x16x32_bf16 a[96:99], v[180:183], v[112:115], a[96:99]
v_exp_f32 v217, v49
v_mfma_f32_16x16x32_bf16 a[100:103], v[180:183], v[116:119], a[100:103]
ds_read_b64_tr_b16 v[154:155], v236 offset:10240
v_add_f32 v227, v227, v220
v_mfma_f32_16x16x32_bf16 a[100:103], v[176:179], v[100:103], a[100:103]
ds_read_b64_tr_b16 v[156:157], v236 offset:16384
v_add_f32 v227, v227, v222
v_mfma_f32_16x16x32_bf16 a[104:107], v[176:179], v[104:107], a[104:107]
v_exp_f32 v218, v50
v_mfma_f32_16x16x32_bf16 a[104:107], v[180:183], v[120:123], a[104:107]
ds_read_b64_tr_b16 v[158:159], v236 offset:22528
v_cvt_pk_bf16_f32 v82, v216, v217
v_mfma_f32_16x16x32_bf16 a[108:111], v[180:183], v[124:127], a[108:111]
ds_read_b64_tr_b16 v[144:145], v237 offset:4096
v_add_f32 v216, v216, v217
v_mfma_f32_16x16x32_bf16 a[108:111], v[176:179], v[108:111], a[108:111]
ds_read_b64_tr_b16 v[146:147], v237 offset:10240
v_add_f32 v224, v224, v216
v_mfma_f32_16x16x32_bf16 a[112:115], v[160:163], v[96:99], a[112:115]
ds_read_b64_tr_b16 v[148:149], v237 offset:16384
ds_read_b64_tr_b16 v[150:151], v237 offset:22528
v_mfma_f32_16x16x32_bf16 a[112:115], v[164:167], v[112:115], a[112:115]
v_exp_f32 v219, v51
v_mfma_f32_16x16x32_bf16 a[116:119], v[164:167], v[116:119], a[116:119]
v_exp_f32 v220, v52
v_mfma_f32_16x16x32_bf16 a[116:119], v[160:163], v[100:103], a[116:119]
v_cvt_pk_bf16_f32 v83, v218, v219
v_add_f32 v218, v218, v219
v_mfma_f32_16x16x32_bf16 a[120:123], v[160:163], v[104:107], a[120:123]
v_exp_f32 v221, v53
v_mfma_f32_16x16x32_bf16 a[120:123], v[164:167], v[120:123], a[120:123]
s_add_u32 m0, s24, 124672
v_add_f32 v224, v224, v218
v_mfma_f32_16x16x32_bf16 a[124:127], v[164:167], v[124:127], a[124:127]
buffer_load_dwordx4 v246, s[16:19], s25 offen offset:3328 lds
v_mfma_f32_16x16x32_bf16 a[124:127], v[160:163], v[108:111], a[124:127]
ds_read_b64_tr_b16 v[176:177], v238 offset:4096
s_waitcnt lgkmcnt(1)
v_mfma_f32_16x16x32_bf16 a[128:131], v[152:155], v[96:99], a[128:131]
v_exp_f32 v222, v54
v_mfma_f32_16x16x32_bf16 a[128:131], v[156:159], v[112:115], a[128:131]
ds_read_b64_tr_b16 v[178:179], v238 offset:10240
v_cvt_pk_bf16_f32 v86, v220, v221
v_mfma_f32_16x16x32_bf16 a[132:135], v[156:159], v[116:119], a[132:135]
v_exp_f32 v223, v55
v_mfma_f32_16x16x32_bf16 a[132:135], v[152:155], v[100:103], a[132:135]
ds_read_b64_tr_b16 v[180:181], v238 offset:16384
v_add_f32 v220, v220, v221
v_mfma_f32_16x16x32_bf16 a[136:139], v[152:155], v[104:107], a[136:139]
v_exp_f32 v216, v56
v_mfma_f32_16x16x32_bf16 a[136:139], v[156:159], v[120:123], a[136:139]
ds_read_b64_tr_b16 v[182:183], v238 offset:22528
v_cvt_pk_bf16_f32 v87, v222, v223
v_mfma_f32_16x16x32_bf16 a[140:143], v[156:159], v[124:127], a[140:143]
ds_read_b64_tr_b16 v[168:169], v239 offset:4096
v_add_f32 v222, v222, v223
v_mfma_f32_16x16x32_bf16 a[140:143], v[152:155], v[108:111], a[140:143]
ds_read_b64_tr_b16 v[170:171], v239 offset:10240
v_add_f32 v225, v225, v220
v_mfma_f32_16x16x32_bf16 a[144:147], v[144:147], v[96:99], a[144:147]
ds_read_b64_tr_b16 v[172:173], v239 offset:16384
ds_read_b64_tr_b16 v[174:175], v239 offset:22528
v_mfma_f32_16x16x32_bf16 a[144:147], v[148:151], v[112:115], a[144:147]
v_exp_f32 v217, v57
v_mfma_f32_16x16x32_bf16 a[148:151], v[148:151], v[116:119], a[148:151]
v_exp_f32 v218, v58
v_mfma_f32_16x16x32_bf16 a[148:151], v[144:147], v[100:103], a[148:151]
v_add_f32 v225, v225, v222
v_cvt_pk_bf16_f32 v90, v216, v217
v_mfma_f32_16x16x32_bf16 a[152:155], v[144:147], v[104:107], a[152:155]
s_add_u32 s25, s25, 24576
v_add_f32 v216, v216, v217
v_mfma_f32_16x16x32_bf16 a[152:155], v[148:151], v[120:123], a[152:155]
v_exp_f32 v219, v59
v_mfma_f32_16x16x32_bf16 a[156:159], v[148:151], v[124:127], a[156:159]
v_cvt_pk_bf16_f32 v91, v218, v219
v_add_f32 v218, v218, v219
v_mfma_f32_16x16x32_bf16 a[156:159], v[144:147], v[108:111], a[156:159]
s_waitcnt vmcnt(12) lgkmcnt(0)
s_barrier
v_mfma_f32_16x16x32_bf16 a[160:163], v[176:179], v[96:99], a[160:163]
v_exp_f32 v220, v60
v_mfma_f32_16x16x32_bf16 a[160:163], v[180:183], v[112:115], a[160:163]
ds_read_b128 v[144:147], v234 offset:0
v_add_f32 v226, v226, v216
v_mfma_f32_16x16x32_bf16 a[164:167], v[180:183], v[116:119], a[164:167]
v_exp_f32 v221, v61
v_mfma_f32_16x16x32_bf16 a[164:167], v[176:179], v[100:103], a[164:167]
ds_read_b128 v[148:151], v235 offset:0
v_cvt_pk_bf16_f32 v94, v220, v221
v_mfma_f32_16x16x32_bf16 a[168:171], v[176:179], v[104:107], a[168:171]
ds_read_b128 v[152:155], v234 offset:2048
v_add_f32 v220, v220, v221
v_mfma_f32_16x16x32_bf16 a[168:171], v[180:183], v[120:123], a[168:171]
v_exp_f32 v222, v62
v_mfma_f32_16x16x32_bf16 a[172:175], v[180:183], v[124:127], a[172:175]
ds_read_b128 v[156:159], v235 offset:2048
v_add_f32 v226, v226, v218
v_mfma_f32_16x16x32_bf16 a[172:175], v[176:179], v[108:111], a[172:175]
v_exp_f32 v223, v63
v_mfma_f32_16x16x32_bf16 a[176:179], v[168:171], v[96:99], a[176:179]
v_cvt_pk_bf16_f32 v95, v222, v223
v_add_f32 v222, v222, v223
v_mfma_f32_16x16x32_bf16 a[176:179], v[172:175], v[112:115], a[176:179]
ds_read_b128 v[176:179], v234 offset:4096
v_add_f32 v227, v227, v220
v_mfma_f32_16x16x32_bf16 a[180:183], v[172:175], v[116:119], a[180:183]
ds_read_b128 v[180:183], v235 offset:4096
v_add_f32 v227, v227, v222
v_mfma_f32_16x16x32_bf16 a[180:183], v[168:171], v[100:103], a[180:183]
v_max3_f32 v247, v224, v225, v226
v_mfma_f32_16x16x32_bf16 a[184:187], v[168:171], v[104:107], a[184:187]
v_max_f32 v247, v247, v227
v_mfma_f32_16x16x32_bf16 a[184:187], v[172:175], v[120:123], a[184:187]
v_cmp_lt_f32 vcc, s27, v247
v_mfma_f32_16x16x32_bf16 a[188:191], v[172:175], v[124:127], a[188:191]
s_waitcnt lgkmcnt(2)
v_mfma_f32_16x16x32_bf16 a[188:191], v[168:171], v[108:111], a[188:191]
s_cbranch_vccnz L_stub_3
L_back_3:
v_mfma_f32_16x16x32_bf16 v[0:3], v[144:147], a[192:195], v[128:131]
v_add_f32 v228, v228, v224
v_add_f32 v229, v229, v225
v_mfma_f32_16x16x32_bf16 v[0:3], v[148:151], a[196:199], v[0:3]
v_add_f32 v230, v230, v226
v_add_f32 v231, v231, v227
v_mfma_f32_16x16x32_bf16 v[0:3], v[152:155], a[200:203], v[0:3]
v_mfma_f32_16x16x32_bf16 v[0:3], v[156:159], a[204:207], v[0:3]
s_add_u32 m0, s24, 24576
s_waitcnt lgkmcnt(0)
v_mfma_f32_16x16x32_bf16 v[0:3], v[176:179], a[208:211], v[0:3]
buffer_load_dwordx4 v244, s[12:15], s25 offen lds
v_mfma_f32_16x16x32_bf16 v[0:3], v[180:183], a[212:215], v[0:3]
v_mfma_f32_16x16x32_bf16 v[4:7], v[180:183], a[236:239], v[132:135]
v_mfma_f32_16x16x32_bf16 v[4:7], v[176:179], a[232:235], v[4:7]
ds_read_b128 v[160:163], v234 offset:6144
v_mfma_f32_16x16x32_bf16 v[4:7], v[156:159], a[228:231], v[4:7]
ds_read_b128 v[164:167], v235 offset:6144
v_mfma_f32_16x16x32_bf16 v[4:7], v[152:155], a[224:227], v[4:7]
ds_read_b128 v[168:171], v234 offset:8192
v_mfma_f32_16x16x32_bf16 v[4:7], v[148:151], a[220:223], v[4:7]
v_exp_f32 v216, v0
v_mfma_f32_16x16x32_bf16 v[4:7], v[144:147], a[216:219], v[4:7]
ds_read_b128 v[172:175], v235 offset:8192
v_mfma_f32_16x16x32_bf16 v[8:11], v[144:147], a[240:243], v[136:139]
v_exp_f32 v217, v1
v_mfma_f32_16x16x32_bf16 v[8:11], v[148:151], a[244:247], v[8:11]
v_cvt_pk_bf16_f32 v96, v216, v217
v_add_f32 v216, v216, v217
v_mfma_f32_16x16x32_bf16 v[8:11], v[152:155], a[248:251], v[8:11]
v_exp_f32 v218, v2
v_mfma_f32_16x16x32_bf16 v[8:11], v[156:159], a[252:255], v[8:11]
v_exp_f32 v219, v3
v_mfma_f32_16x16x32_bf16 v[8:11], v[176:179], v[184:187], v[8:11]
v_cvt_pk_bf16_f32 v97, v218, v219
v_add_f32 v218, v218, v219
v_mfma_f32_16x16x32_bf16 v[8:11], v[180:183], v[188:191], v[8:11]
s_add_u32 m0, s24, 73728
v_add_f32 v224, v216, v218
v_mfma_f32_16x16x32_bf16 v[12:15], v[180:183], v[212:215], v[140:143]
ds_read_b128 v[180:183], v234 offset:10240
v_mfma_f32_16x16x32_bf16 v[12:15], v[176:179], v[208:211], v[12:15]
ds_read_b128 v[176:179], v235 offset:10240
v_mfma_f32_16x16x32_bf16 v[12:15], v[156:159], v[204:207], v[12:15]
buffer_load_dwordx4 v246, s[16:19], s25 offen lds
v_mfma_f32_16x16x32_bf16 v[12:15], v[152:155], v[200:203], v[12:15]
v_exp_f32 v220, v4
v_mfma_f32_16x16x32_bf16 v[12:15], v[148:151], v[196:199], v[12:15]
v_exp_f32 v221, v5
v_mfma_f32_16x16x32_bf16 v[12:15], v[144:147], v[192:195], v[12:15]
v_cvt_pk_bf16_f32 v100, v220, v221
s_waitcnt lgkmcnt(2)
v_mfma_f32_16x16x32_bf16 v[16:19], v[160:163], a[192:195], v[128:131]
v_add_f32 v220, v220, v221
v_mfma_f32_16x16x32_bf16 v[16:19], v[164:167], a[196:199], v[16:19]
v_exp_f32 v222, v6
v_mfma_f32_16x16x32_bf16 v[16:19], v[168:171], a[200:203], v[16:19]
v_exp_f32 v223, v7
v_mfma_f32_16x16x32_bf16 v[16:19], v[172:175], a[204:207], v[16:19]
v_cvt_pk_bf16_f32 v101, v222, v223
s_waitcnt lgkmcnt(0)
v_mfma_f32_16x16x32_bf16 v[16:19], v[180:183], a[208:211], v[16:19]
v_add_f32 v222, v222, v223
v_mfma_f32_16x16x32_bf16 v[16:19], v[176:179], a[212:215], v[16:19]
v_add_f32 v225, v220, v222
v_mfma_f32_16x16x32_bf16 v[20:23], v[176:179], a[236:239], v[132:135]
v_exp_f32 v216, v8
v_mfma_f32_16x16x32_bf16 v[20:23], v[180:183], a[232:235], v[20:23]
ds_read_b128 v[144:147], v234 offset:12288
s_add_u32 m0, s24, 25600
v_mfma_f32_16x16x32_bf16 v[20:23], v[172:175], a[228:231], v[20:23]
buffer_load_dwordx4 v245, s[12:15], s25 offen lds
v_mfma_f32_16x16x32_bf16 v[20:23], v[168:171], a[224:227], v[20:23]
ds_read_b128 v[148:151], v235 offset:12288
v_mfma_f32_16x16x32_bf16 v[20:23], v[164:167], a[220:223], v[20:23]
ds_read_b128 v[152:155], v234 offset:14336
v_mfma_f32_16x16x32_bf16 v[20:23], v[160:163], a[216:219], v[20:23]
v_exp_f32 v217, v9
v_mfma_f32_16x16x32_bf16 v[24:27], v[160:163], a[240:243], v[136:139]
ds_read_b128 v[156:159], v235 offset:14336
v_cvt_pk_bf16_f32 v104, v216, v217
v_mfma_f32_16x16x32_bf16 v[24:27], v[164:167], a[244:247], v[24:27]
v_add_f32 v216, v216, v217
v_mfma_f32_16x16x32_bf16 v[24:27], v[168:171], a[248:251], v[24:27]
v_exp_f32 v218, v10
v_mfma_f32_16x16x32_bf16 v[24:27], v[172:175], a[252:255], v[24:27]
v_exp_f32 v219, v11
v_mfma_f32_16x16x32_bf16 v[24:27], v[180:183], v[184:187], v[24:27]
v_cvt_pk_bf16_f32 v105, v218, v219
v_add_f32 v218, v218, v219
v_mfma_f32_16x16x32_bf16 v[24:27], v[176:179], v[188:191], v[24:27]
v_add_f32 v226, v216, v218
v_mfma_f32_16x16x32_bf16 v[28:31], v[176:179], v[212:215], v[140:143]
ds_read_b128 v[176:179], v234 offset:16384
v_mfma_f32_16x16x32_bf16 v[28:31], v[180:183], v[208:211], v[28:31]
ds_read_b128 v[180:183], v235 offset:16384
v_mfma_f32_16x16x32_bf16 v[28:31], v[172:175], v[204:207], v[28:31]
v_exp_f32 v220, v12
v_mfma_f32_16x16x32_bf16 v[28:31], v[168:171], v[200:203], v[28:31]
s_add_u32 m0, s24, 71680
v_mfma_f32_16x16x32_bf16 v[28:31], v[164:167], v[196:199], v[28:31]
v_exp_f32 v221, v13
v_mfma_f32_16x16x32_bf16 v[28:31], v[160:163], v[192:195], v[28:31]
v_cvt_pk_bf16_f32 v108, v220, v221
s_waitcnt lgkmcnt(2)
v_mfma_f32_16x16x32_bf16 v[32:35], v[144:147], a[192:195], v[128:131]
buffer_load_dwordx4 v246, s[16:19], s25 offen offset:3072 lds
v_mfma_f32_16x16x32_bf16 v[32:35], v[148:151], a[196:199], v[32:35]
v_exp_f32 v222, v14
v_mfma_f32_16x16x32_bf16 v[32:35], v[152:155], a[200:203], v[32:35]
v_add_f32 v220, v220, v221
v_mfma_f32_16x16x32_bf16 v[32:35], v[156:159], a[204:207], v[32:35]
s_waitcnt lgkmcnt(0)
v_mfma_f32_16x16x32_bf16 v[32:35], v[176:179], a[208:211], v[32:35]
v_exp_f32 v223, v15
v_mfma_f32_16x16x32_bf16 v[32:35], v[180:183], a[212:215], v[32:35]
v_cvt_pk_bf16_f32 v109, v222, v223
v_add_f32 v222, v222, v223
v_mfma_f32_16x16x32_bf16 v[36:39], v[180:183], a[236:239], v[132:135]
v_exp_f32 v216, v16
v_mfma_f32_16x16x32_bf16 v[36:39], v[176:179], a[232:235], v[36:39]
ds_read_b128 v[160:163], v234 offset:18432
v_add_f32 v227, v220, v222
v_mfma_f32_16x16x32_bf16 v[36:39], v[156:159], a[228:231], v[36:39]
ds_read_b128 v[164:167], v235 offset:18432
v_mfma_f32_16x16x32_bf16 v[36:39], v[152:155], a[224:227], v[36:39]
v_exp_f32 v217, v17
v_mfma_f32_16x16x32_bf16 v[36:39], v[148:151], a[220:223], v[36:39]
ds_read_b128 v[168:171], v234 offset:20480
v_cvt_pk_bf16_f32 v98, v216, v217
v_mfma_f32_16x16x32_bf16 v[36:39], v[144:147], a[216:219], v[36:39]
ds_read_b128 v[172:175], v235 offset:20480
s_add_u32 m0, s24, 26496
v_mfma_f32_16x16x32_bf16 v[40:43], v[144:147], a[240:243], v[136:139]
v_exp_f32 v218, v18
v_mfma_f32_16x16x32_bf16 v[40:43], v[148:151], a[244:247], v[40:43]
buffer_load_dwordx4 v244, s[12:15], s25 offen offset:128 lds
v_mfma_f32_16x16x32_bf16 v[40:43], v[152:155], a[248:251], v[40:43]
v_add_f32 v216, v216, v217
v_mfma_f32_16x16x32_bf16 v[40:43], v[156:159], a[252:255], v[40:43]
v_exp_f32 v219, v19
v_mfma_f32_16x16x32_bf16 v[40:43], v[176:179], v[184:187], v[40:43]
v_cvt_pk_bf16_f32 v99, v218, v219
v_add_f32 v218, v218, v219
v_mfma_f32_16x16x32_bf16 v[40:43], v[180:183], v[188:191], v[40:43]
v_exp_f32 v220, v20
v_mfma_f32_16x16x32_bf16 v[44:47], v[180:183], v[212:215], v[140:143]
ds_read_b128 v[180:183], v234 offset:22528
v_add_f32 v224, v224, v216
v_mfma_f32_16x16x32_bf16 v[44:47], v[176:179], v[208:211], v[44:47]
ds_read_b128 v[176:179], v235 offset:22528
v_add_f32 v224, v224, v218
v_mfma_f32_16x16x32_bf16 v[44:47], v[156:159], v[204:207], v[44:47]
v_exp_f32 v221, v21
v_mfma_f32_16x16x32_bf16 v[44:47], v[152:155], v[200:203], v[44:47]
v_cvt_pk_bf16_f32 v102, v220, v221
v_add_f32 v220, v220, v221
v_mfma_f32_16x16x32_bf16 v[44:47], v[148:151], v[196:199], v[44:47]
v_add_f32 v225, v225, v220
v_mfma_f32_16x16x32_bf16 v[44:47], v[144:147], v[192:195], v[44:47]
ds_read_b64_tr_b16 v[144:145], v236 offset:24576
s_waitcnt lgkmcnt(3)
v_mfma_f32_16x16x32_bf16 v[48:51], v[160:163], a[192:195], v[128:131]
v_exp_f32 v222, v22
v_mfma_f32_16x16x32_bf16 v[48:51], v[164:167], a[196:199], v[48:51]
ds_read_b64_tr_b16 v[146:147], v236 offset:30720
s_add_u32 m0, s24, 75648
v_mfma_f32_16x16x32_bf16 v[48:51], v[168:171], a[200:203], v[48:51]
v_exp_f32 v223, v23
v_mfma_f32_16x16x32_bf16 v[48:51], v[172:175], a[204:207], v[48:51]
v_cvt_pk_bf16_f32 v103, v222, v223
s_waitcnt lgkmcnt(2)
v_mfma_f32_16x16x32_bf16 v[48:51], v[180:183], a[208:211], v[48:51]
v_exp_f32 v216, v24
v_mfma_f32_16x16x32_bf16 v[48:51], v[176:179], a[212:215], v[48:51]
buffer_load_dwordx4 v246, s[16:19], s25 offen offset:128 lds
v_mfma_f32_16x16x32_bf16 v[52:55], v[176:179], a[236:239], v[132:135]
ds_read_b64_tr_b16 v[148:149], v236 offset:36864
v_add_f32 v222, v222, v223
v_mfma_f32_16x16x32_bf16 v[52:55], v[180:183], a[232:235], v[52:55]
v_exp_f32 v217, v25
v_mfma_f32_16x16x32_bf16 v[52:55], v[172:175], a[228:231], v[52:55]
ds_read_b64_tr_b16 v[150:151], v236 offset:43008
v_add_f32 v225, v225, v222
v_mfma_f32_16x16x32_bf16 v[52:55], v[168:171], a[224:227], v[52:55]
ds_read_b64_tr_b16 v[152:153], v237 offset:24576
v_cvt_pk_bf16_f32 v106, v216, v217
v_mfma_f32_16x16x32_bf16 v[52:55], v[164:167], a[220:223], v[52:55]
v_exp_f32 v218, v26
v_mfma_f32_16x16x32_bf16 v[52:55], v[160:163], a[216:219], v[52:55]
ds_read_b64_tr_b16 v[154:155], v237 offset:30720
v_add_f32 v216, v216, v217
v_mfma_f32_16x16x32_bf16 v[56:59], v[160:163], a[240:243], v[136:139]
ds_read_b64_tr_b16 v[156:157], v237 offset:36864
v_add_f32 v226, v226, v216
v_mfma_f32_16x16x32_bf16 v[56:59], v[164:167], a[244:247], v[56:59]
v_exp_f32 v219, v27
v_mfma_f32_16x16x32_bf16 v[56:59], v[168:171], a[248:251], v[56:59]
ds_read_b64_tr_b16 v[158:159], v237 offset:43008
v_cvt_pk_bf16_f32 v107, v218, v219
v_mfma_f32_16x16x32_bf16 v[56:59], v[172:175], a[252:255], v[56:59]
v_exp_f32 v220, v28
v_mfma_f32_16x16x32_bf16 v[56:59], v[180:183], v[184:187], v[56:59]
s_add_u32 m0, s24, 27520
v_add_f32 v218, v218, v219
v_mfma_f32_16x16x32_bf16 v[56:59], v[176:179], v[188:191], v[56:59]
buffer_load_dwordx4 v245, s[12:15], s25 offen offset:128 lds
v_mfma_f32_16x16x32_bf16 v[60:63], v[176:179], v[212:215], v[140:143]
v_exp_f32 v221, v29
v_mfma_f32_16x16x32_bf16 v[60:63], v[180:183], v[208:211], v[60:63]
ds_read_b64_tr_b16 v[176:177], v238 offset:24576
v_add_f32 v226, v226, v218
v_mfma_f32_16x16x32_bf16 v[60:63], v[172:175], v[204:207], v[60:63]
ds_read_b64_tr_b16 v[178:179], v238 offset:30720
v_cvt_pk_bf16_f32 v110, v220, v221
v_mfma_f32_16x16x32_bf16 v[60:63], v[168:171], v[200:203], v[60:63]
v_exp_f32 v222, v30
v_mfma_f32_16x16x32_bf16 v[60:63], v[164:167], v[196:199], v[60:63]
ds_read_b64_tr_b16 v[180:181], v238 offset:36864
v_add_f32 v220, v220, v221
v_mfma_f32_16x16x32_bf16 v[60:63], v[160:163], v[192:195], v[60:63]
ds_read_b64_tr_b16 v[182:183], v238 offset:43008
s_waitcnt lgkmcnt(4)
v_mfma_f32_16x16x32_bf16 a[0:3], v[144:147], v[64:67], a[0:3]
v_exp_f32 v223, v31
v_mfma_f32_16x16x32_bf16 a[0:3], v[148:151], v[80:83], a[0:3]
ds_read_b64_tr_b16 v[160:161], v239 offset:24576
v_cvt_pk_bf16_f32 v111, v222, v223
v_mfma_f32_16x16x32_bf16 a[4:7], v[148:151], v[84:87], a[4:7]
v_exp_f32 v216, v32
v_mfma_f32_16x16x32_bf16 a[4:7], v[144:147], v[68:71], a[4:7]
ds_read_b64_tr_b16 v[162:163], v239 offset:30720
v_add_f32 v222, v222, v223
v_mfma_f32_16x16x32_bf16 a[8:11], v[144:147], v[72:75], a[8:11]
ds_read_b64_tr_b16 v[164:165], v239 offset:36864
v_add_f32 v227, v227, v220
v_mfma_f32_16x16x32_bf16 a[8:11], v[148:151], v[88:91], a[8:11]
v_exp_f32 v217, v33
v_mfma_f32_16x16x32_bf16 a[12:15], v[148:151], v[92:95], a[12:15]
ds_read_b64_tr_b16 v[166:167], v239 offset:43008
s_add_u32 m0, s24, 73600
v_mfma_f32_16x16x32_bf16 a[12:15], v[144:147], v[76:79], a[12:15]
buffer_load_dwordx4 v246, s[16:19], s25 offen offset:3200 lds
v_mfma_f32_16x16x32_bf16 a[16:19], v[152:155], v[64:67], a[16:19]
v_exp_f32 v218, v34
v_mfma_f32_16x16x32_bf16 a[16:19], v[156:159], v[80:83], a[16:19]
v_add_f32 v227, v227, v222
v_cvt_pk_bf16_f32 v112, v216, v217
v_mfma_f32_16x16x32_bf16 a[20:23], v[156:159], v[84:87], a[20:23]
ds_read_b64_tr_b16 v[168:169], v236 offset:26624
v_add_f32 v216, v216, v217
v_mfma_f32_16x16x32_bf16 a[20:23], v[152:155], v[68:71], a[20:23]
v_exp_f32 v219, v35
v_mfma_f32_16x16x32_bf16 a[24:27], v[152:155], v[72:75], a[24:27]
v_cvt_pk_bf16_f32 v113, v218, v219
v_add_f32 v218, v218, v219
v_mfma_f32_16x16x32_bf16 a[24:27], v[156:159], v[88:91], a[24:27]
v_exp_f32 v220, v36
v_mfma_f32_16x16x32_bf16 a[28:31], v[156:159], v[92:95], a[28:31]
ds_read_b64_tr_b16 v[170:171], v236 offset:32768
v_add_f32 v224, v224, v216
v_mfma_f32_16x16x32_bf16 a[28:31], v[152:155], v[76:79], a[28:31]
v_add_f32 v224, v224, v218
s_waitcnt lgkmcnt(2)
v_mfma_f32_16x16x32_bf16 a[32:35], v[176:179], v[64:67], a[32:35]
v_exp_f32 v221, v37
v_mfma_f32_16x16x32_bf16 a[32:35], v[180:183], v[80:83], a[32:35]
ds_read_b64_tr_b16 v[172:173], v236 offset:38912
v_cvt_pk_bf16_f32 v116, v220, v221
v_mfma_f32_16x16x32_bf16 a[36:39], v[180:183], v[84:87], a[36:39]
ds_read_b64_tr_b16 v[174:175], v236 offset:45056
v_add_f32 v220, v220, v221
v_mfma_f32_16x16x32_bf16 a[36:39], v[176:179], v[68:71], a[36:39]
v_exp_f32 v222, v38
v_mfma_f32_16x16x32_bf16 a[40:43], v[176:179], v[72:75], a[40:43]
ds_read_b64_tr_b16 v[144:145], v237 offset:26624
s_add_u32 m0, s24, 28416
v_mfma_f32_16x16x32_bf16 a[40:43], v[180:183], v[88:91], a[40:43]
ds_read_b64_tr_b16 v[146:147], v237 offset:32768
v_add_f32 v225, v225, v220
v_mfma_f32_16x16x32_bf16 a[44:47], v[180:183], v[92:95], a[44:47]
v_exp_f32 v223, v39
v_mfma_f32_16x16x32_bf16 a[44:47], v[176:179], v[76:79], a[44:47]
ds_read_b64_tr_b16 v[148:149], v237 offset:38912
v_cvt_pk_bf16_f32 v117, v222, v223
v_mfma_f32_16x16x32_bf16 a[48:51], v[160:163], v[64:67], a[48:51]
ds_read_b64_tr_b16 v[150:151], v237 offset:45056
v_add_f32 v222, v222, v223
v_mfma_f32_16x16x32_bf16 a[48:51], v[164:167], v[80:83], a[48:51]
buffer_load_dwordx4 v244, s[12:15], s25 offen offset:256 lds
v_mfma_f32_16x16x32_bf16 a[52:55], v[164:167], v[84:87], a[52:55]
v_exp_f32 v216, v40
v_mfma_f32_16x16x32_bf16 a[52:55], v[160:163], v[68:71], a[52:55]
v_exp_f32 v217, v41
v_mfma_f32_16x16x32_bf16 a[56:59], v[160:163], v[72:75], a[56:59]
ds_read_b64_tr_b16 v[176:177], v238 offset:26624
v_add_f32 v225, v225, v222
v_mfma_f32_16x16x32_bf16 a[56:59], v[164:167], v[88:91], a[56:59]
ds_read_b64_tr_b16 v[178:179], v238 offset:32768
v_cvt_pk_bf16_f32 v120, v216, v217
v_mfma_f32_16x16x32_bf16 a[60:63], v[164:167], v[92:95], a[60:63]
v_exp_f32 v218, v42
v_mfma_f32_16x16x32_bf16 a[60:63], v[160:163], v[76:79], a[60:63]
ds_read_b64_tr_b16 v[180:181], v238 offset:38912
s_waitcnt lgkmcnt(3)
v_mfma_f32_16x16x32_bf16 a[64:67], v[168:171], v[64:67], a[64:67]
ds_read_b64_tr_b16 v[182:183], v238 offset:45056
v_add_f32 v216, v216, v217
v_mfma_f32_16x16x32_bf16 a[64:67], v[172:175], v[80:83], a[64:67]
v_exp_f32 v219, v43
v_mfma_f32_16x16x32_bf16 a[68:71], v[172:175], v[84:87], a[68:71]
ds_read_b64_tr_b16 v[160:161], v239 offset:26624
s_add_u32 m0, s24, 77568
v_mfma_f32_16x16x32_bf16 a[68:71], v[168:171], v[68:71], a[68:71]
v_exp_f32 v220, v44
v_mfma_f32_16x16x32_bf16 a[72:75], v[168:171], v[72:75], a[72:75]
buffer_load_dwordx4 v246, s[16:19], s25 offen offset:256 lds
v_mfma_f32_16x16x32_bf16 a[72:75], v[172:175], v[88:91], a[72:75]
ds_read_b64_tr_b16 v[162:163], v239 offset:32768
v_cvt_pk_bf16_f32 v121, v218, v219
v_mfma_f32_16x16x32_bf16 a[76:79], v[172:175], v[92:95], a[76:79]
v_exp_f32 v221, v45
v_mfma_f32_16x16x32_bf16 a[76:79], v[168:171], v[76:79], a[76:79]
ds_read_b64_tr_b16 v[164:165], v239 offset:38912
v_add_f32 v218, v218, v219
v_mfma_f32_16x16x32_bf16 a[80:83], v[144:147], v[64:67], a[80:83]
ds_read_b64_tr_b16 v[166:167], v239 offset:45056
v_add_f32 v226, v226, v216
v_mfma_f32_16x16x32_bf16 a[80:83], v[148:151], v[80:83], a[80:83]
v_exp_f32 v222, v46
v_mfma_f32_16x16x32_bf16 a[84:87], v[148:151], v[84:87], a[84:87]
v_add_f32 v226, v226, v218
v_cvt_pk_bf16_f32 v124, v220, v221
v_mfma_f32_16x16x32_bf16 a[84:87], v[144:147], v[68:71], a[84:87]
ds_read_b64_tr_b16 v[152:153], v236 offset:28672
v_add_f32 v220, v220, v221
v_mfma_f32_16x16x32_bf16 a[88:91], v[144:147], v[72:75], a[88:91]
v_exp_f32 v223, v47
v_mfma_f32_16x16x32_bf16 a[88:91], v[148:151], v[88:91], a[88:91]
v_cvt_pk_bf16_f32 v125, v222, v223
v_add_f32 v222, v222, v223
v_mfma_f32_16x16x32_bf16 a[92:95], v[148:151], v[92:95], a[92:95]
v_exp_f32 v216, v48
v_mfma_f32_16x16x32_bf16 a[92:95], v[144:147], v[76:79], a[92:95]
s_add_u32 m0, s24, 29440
s_waitcnt lgkmcnt(1)
v_mfma_f32_16x16x32_bf16 a[96:99], v[176:179], v[64:67], a[96:99]
buffer_load_dwordx4 v245, s[12:15], s25 offen offset:256 lds
v_mfma_f32_16x16x32_bf16 a[96:99], v[180:183], v[80:83], a[96:99]
v_exp_f32 v217, v49
v_mfma_f32_16x16x32_bf16 a[100:103], v[180:183], v[84:87], a[100:103]
ds_read_b64_tr_b16 v[154:155], v236 offset:34816
v_add_f32 v227, v227, v220
v_mfma_f32_16x16x32_bf16 a[100:103], v[176:179], v[68:71], a[100:103]
ds_read_b64_tr_b16 v[156:157], v236 offset:40960
v_add_f32 v227, v227, v222
v_mfma_f32_16x16x32_bf16 a[104:107], v[176:179], v[72:75], a[104:107]
v_exp_f32 v218, v50
v_mfma_f32_16x16x32_bf16 a[104:107], v[180:183], v[88:91], a[104:107]
ds_read_b64_tr_b16 v[158:159], v236 offset:47104
v_cvt_pk_bf16_f32 v114, v216, v217
v_mfma_f32_16x16x32_bf16 a[108:111], v[180:183], v[92:95], a[108:111]
ds_read_b64_tr_b16 v[144:145], v237 offset:28672
v_add_f32 v216, v216, v217
v_mfma_f32_16x16x32_bf16 a[108:111], v[176:179], v[76:79], a[108:111]
ds_read_b64_tr_b16 v[146:147], v237 offset:34816
v_add_f32 v224, v224, v216
v_mfma_f32_16x16x32_bf16 a[112:115], v[160:163], v[64:67], a[112:115]
ds_read_b64_tr_b16 v[148:149], v237 offset:40960
ds_read_b64_tr_b16 v[150:151], v237 offset:47104
v_mfma_f32_16x16x32_bf16 a[112:115], v[164:167], v[80:83], a[112:115]
v_exp_f32 v219, v51
v_mfma_f32_16x16x32_bf16 a[116:119], v[164:167], v[84:87], a[116:119]
v_exp_f32 v220, v52
v_mfma_f32_16x16x32_bf16 a[116:119], v[160:163], v[68:71], a[116:119]
v_cvt_pk_bf16_f32 v115, v218, v219
v_add_f32 v218, v218, v219
v_mfma_f32_16x16x32_bf16 a[120:123], v[160:163], v[72:75], a[120:123]
v_exp_f32 v221, v53
v_mfma_f32_16x16x32_bf16 a[120:123], v[164:167], v[88:91], a[120:123]
s_add_u32 m0, s24, 75520
v_add_f32 v224, v224, v218
v_mfma_f32_16x16x32_bf16 a[124:127], v[164:167], v[92:95], a[124:127]
buffer_load_dwordx4 v246, s[16:19], s25 offen offset:3328 lds
v_mfma_f32_16x16x32_bf16 a[124:127], v[160:163], v[76:79], a[124:127]
ds_read_b64_tr_b16 v[176:177], v238 offset:28672
s_waitcnt lgkmcnt(1)
v_mfma_f32_16x16x32_bf16 a[128:131], v[152:155], v[64:67], a[128:131]
v_exp_f32 v222, v54
v_mfma_f32_16x16x32_bf16 a[128:131], v[156:159], v[80:83], a[128:131]
ds_read_b64_tr_b16 v[178:179], v238 offset:34816
v_cvt_pk_bf16_f32 v118, v220, v221
v_mfma_f32_16x16x32_bf16 a[132:135], v[156:159], v[84:87], a[132:135]
v_exp_f32 v223, v55
v_mfma_f32_16x16x32_bf16 a[132:135], v[152:155], v[68:71], a[132:135]
ds_read_b64_tr_b16 v[180:181], v238 offset:40960
v_add_f32 v220, v220, v221
v_mfma_f32_16x16x32_bf16 a[136:139], v[152:155], v[72:75], a[136:139]
v_exp_f32 v216, v56
v_mfma_f32_16x16x32_bf16 a[136:139], v[156:159], v[88:91], a[136:139]
ds_read_b64_tr_b16 v[182:183], v238 offset:47104
v_cvt_pk_bf16_f32 v119, v222, v223
v_mfma_f32_16x16x32_bf16 a[140:143], v[156:159], v[92:95], a[140:143]
ds_read_b64_tr_b16 v[168:169], v239 offset:28672
v_add_f32 v222, v222, v223
v_mfma_f32_16x16x32_bf16 a[140:143], v[152:155], v[76:79], a[140:143]
ds_read_b64_tr_b16 v[170:171], v239 offset:34816
v_add_f32 v225, v225, v220
v_mfma_f32_16x16x32_bf16 a[144:147], v[144:147], v[64:67], a[144:147]
ds_read_b64_tr_b16 v[172:173], v239 offset:40960
ds_read_b64_tr_b16 v[174:175], v239 offset:47104
v_mfma_f32_16x16x32_bf16 a[144:147], v[148:151], v[80:83], a[144:147]
v_exp_f32 v217, v57
v_mfma_f32_16x16x32_bf16 a[148:151], v[148:151], v[84:87], a[148:151]
v_exp_f32 v218, v58
v_mfma_f32_16x16x32_bf16 a[148:151], v[144:147], v[68:71], a[148:151]
v_add_f32 v225, v225, v222
v_cvt_pk_bf16_f32 v122, v216, v217
v_mfma_f32_16x16x32_bf16 a[152:155], v[144:147], v[72:75], a[152:155]
s_add_u32 s25, s25, 24576
v_add_f32 v216, v216, v217
v_mfma_f32_16x16x32_bf16 a[152:155], v[148:151], v[88:91], a[152:155]
v_exp_f32 v219, v59
v_mfma_f32_16x16x32_bf16 a[156:159], v[148:151], v[92:95], a[156:159]
v_cvt_pk_bf16_f32 v123, v218, v219
v_add_f32 v218, v218, v219
v_mfma_f32_16x16x32_bf16 a[156:159], v[144:147], v[76:79], a[156:159]
s_waitcnt vmcnt(12) lgkmcnt(0)
s_barrier
v_mfma_f32_16x16x32_bf16 a[160:163], v[176:179], v[64:67], a[160:163]
v_exp_f32 v220, v60
v_mfma_f32_16x16x32_bf16 a[160:163], v[180:183], v[80:83], a[160:163]
ds_read_b128 v[144:147], v232 offset:0
v_add_f32 v226, v226, v216
v_mfma_f32_16x16x32_bf16 a[164:167], v[180:183], v[84:87], a[164:167]
v_exp_f32 v221, v61
v_mfma_f32_16x16x32_bf16 a[164:167], v[176:179], v[68:71], a[164:167]
ds_read_b128 v[148:151], v233 offset:0
v_cvt_pk_bf16_f32 v126, v220, v221
v_mfma_f32_16x16x32_bf16 a[168:171], v[176:179], v[72:75], a[168:171]
ds_read_b128 v[152:155], v232 offset:2048
v_add_f32 v220, v220, v221
v_mfma_f32_16x16x32_bf16 a[168:171], v[180:183], v[88:91], a[168:171]
v_exp_f32 v222, v62
v_mfma_f32_16x16x32_bf16 a[172:175], v[180:183], v[92:95], a[172:175]
ds_read_b128 v[156:159], v233 offset:2048
v_add_f32 v226, v226, v218
v_mfma_f32_16x16x32_bf16 a[172:175], v[176:179], v[76:79], a[172:175]
v_exp_f32 v223, v63
v_mfma_f32_16x16x32_bf16 a[176:179], v[168:171], v[64:67], a[176:179]
v_cvt_pk_bf16_f32 v127, v222, v223
v_add_f32 v222, v222, v223
v_mfma_f32_16x16x32_bf16 a[176:179], v[172:175], v[80:83], a[176:179]
ds_read_b128 v[176:179], v232 offset:4096
v_add_f32 v227, v227, v220
v_mfma_f32_16x16x32_bf16 a[180:183], v[172:175], v[84:87], a[180:183]
ds_read_b128 v[180:183], v233 offset:4096
v_add_f32 v227, v227, v222
v_mfma_f32_16x16x32_bf16 a[180:183], v[168:171], v[68:71], a[180:183]
v_max3_f32 v247, v224, v225, v226
v_mfma_f32_16x16x32_bf16 a[184:187], v[168:171], v[72:75], a[184:187]
v_max_f32 v247, v247, v227
v_mfma_f32_16x16x32_bf16 a[184:187], v[172:175], v[88:91], a[184:187]
v_cmp_lt_f32 vcc, s27, v247
v_mfma_f32_16x16x32_bf16 a[188:191], v[172:175], v[92:95], a[188:191]
s_waitcnt lgkmcnt(2)
v_mfma_f32_16x16x32_bf16 a[188:191], v[168:171], v[76:79], a[188:191]
s_cbranch_vccnz L_stub_4
L_back_4:
v_mfma_f32_16x16x32_bf16 v[0:3], v[144:147], a[192:195], v[128:131]
v_add_f32 v228, v228, v224
v_add_f32 v229, v229, v225
v_mfma_f32_16x16x32_bf16 v[0:3], v[148:151], a[196:199], v[0:3]
v_add_f32 v230, v230, v226
v_add_f32 v231, v231, v227
v_mfma_f32_16x16x32_bf16 v[0:3], v[152:155], a[200:203], v[0:3]
v_mfma_f32_16x16x32_bf16 v[0:3], v[156:159], a[204:207], v[0:3]
s_add_u32 m0, s24, 49152
s_waitcnt lgkmcnt(0)
v_mfma_f32_16x16x32_bf16 v[0:3], v[176:179], a[208:211], v[0:3]
buffer_load_dwordx4 v244, s[12:15], s25 offen lds
v_mfma_f32_16x16x32_bf16 v[0:3], v[180:183], a[212:215], v[0:3]
v_mfma_f32_16x16x32_bf16 v[4:7], v[180:183], a[236:239], v[132:135]
v_mfma_f32_16x16x32_bf16 v[4:7], v[176:179], a[232:235], v[4:7]
ds_read_b128 v[160:163], v232 offset:6144
v_mfma_f32_16x16x32_bf16 v[4:7], v[156:159], a[228:231], v[4:7]
ds_read_b128 v[164:167], v233 offset:6144
v_mfma_f32_16x16x32_bf16 v[4:7], v[152:155], a[224:227], v[4:7]
ds_read_b128 v[168:171], v232 offset:8192
v_mfma_f32_16x16x32_bf16 v[4:7], v[148:151], a[220:223], v[4:7]
v_exp_f32 v216, v0
v_mfma_f32_16x16x32_bf16 v[4:7], v[144:147], a[216:219], v[4:7]
ds_read_b128 v[172:175], v233 offset:8192
v_mfma_f32_16x16x32_bf16 v[8:11], v[144:147], a[240:243], v[136:139]
v_exp_f32 v217, v1
v_mfma_f32_16x16x32_bf16 v[8:11], v[148:151], a[244:247], v[8:11]
v_cvt_pk_bf16_f32 v64, v216, v217
v_add_f32 v216, v216, v217
v_mfma_f32_16x16x32_bf16 v[8:11], v[152:155], a[248:251], v[8:11]
v_exp_f32 v218, v2
v_mfma_f32_16x16x32_bf16 v[8:11], v[156:159], a[252:255], v[8:11]
v_exp_f32 v219, v3
v_mfma_f32_16x16x32_bf16 v[8:11], v[176:179], v[184:187], v[8:11]
v_cvt_pk_bf16_f32 v65, v218, v219
v_add_f32 v218, v218, v219
v_mfma_f32_16x16x32_bf16 v[8:11], v[180:183], v[188:191], v[8:11]
s_add_u32 m0, s24, 98304
v_add_f32 v224, v216, v218
v_mfma_f32_16x16x32_bf16 v[12:15], v[180:183], v[212:215], v[140:143]
ds_read_b128 v[180:183], v232 offset:10240
v_mfma_f32_16x16x32_bf16 v[12:15], v[176:179], v[208:211], v[12:15]
ds_read_b128 v[176:179], v233 offset:10240
v_mfma_f32_16x16x32_bf16 v[12:15], v[156:159], v[204:207], v[12:15]
buffer_load_dwordx4 v246, s[16:19], s25 offen lds
v_mfma_f32_16x16x32_bf16 v[12:15], v[152:155], v[200:203], v[12:15]
v_exp_f32 v220, v4
v_mfma_f32_16x16x32_bf16 v[12:15], v[148:151], v[196:199], v[12:15]
v_exp_f32 v221, v5
v_mfma_f32_16x16x32_bf16 v[12:15], v[144:147], v[192:195], v[12:15]
v_cvt_pk_bf16_f32 v68, v220, v221
s_waitcnt lgkmcnt(2)
v_mfma_f32_16x16x32_bf16 v[16:19], v[160:163], a[192:195], v[128:131]
v_add_f32 v220, v220, v221
v_mfma_f32_16x16x32_bf16 v[16:19], v[164:167], a[196:199], v[16:19]
v_exp_f32 v222, v6
v_mfma_f32_16x16x32_bf16 v[16:19], v[168:171], a[200:203], v[16:19]
v_exp_f32 v223, v7
v_mfma_f32_16x16x32_bf16 v[16:19], v[172:175], a[204:207], v[16:19]
v_cvt_pk_bf16_f32 v69, v222, v223
s_waitcnt lgkmcnt(0)
v_mfma_f32_16x16x32_bf16 v[16:19], v[180:183], a[208:211], v[16:19]
v_add_f32 v222, v222, v223
v_mfma_f32_16x16x32_bf16 v[16:19], v[176:179], a[212:215], v[16:19]
v_add_f32 v225, v220, v222
v_mfma_f32_16x16x32_bf16 v[20:23], v[176:179], a[236:239], v[132:135]
v_exp_f32 v216, v8
v_mfma_f32_16x16x32_bf16 v[20:23], v[180:183], a[232:235], v[20:23]
ds_read_b128 v[144:147], v232 offset:12288
s_add_u32 m0, s24, 50176
v_mfma_f32_16x16x32_bf16 v[20:23], v[172:175], a[228:231], v[20:23]
buffer_load_dwordx4 v245, s[12:15], s25 offen lds
v_mfma_f32_16x16x32_bf16 v[20:23], v[168:171], a[224:227], v[20:23]
ds_read_b128 v[148:151], v233 offset:12288
v_mfma_f32_16x16x32_bf16 v[20:23], v[164:167], a[220:223], v[20:23]
ds_read_b128 v[152:155], v232 offset:14336
v_mfma_f32_16x16x32_bf16 v[20:23], v[160:163], a[216:219], v[20:23]
v_exp_f32 v217, v9
v_mfma_f32_16x16x32_bf16 v[24:27], v[160:163], a[240:243], v[136:139]
ds_read_b128 v[156:159], v233 offset:14336
v_cvt_pk_bf16_f32 v72, v216, v217
v_mfma_f32_16x16x32_bf16 v[24:27], v[164:167], a[244:247], v[24:27]
v_add_f32 v216, v216, v217
v_mfma_f32_16x16x32_bf16 v[24:27], v[168:171], a[248:251], v[24:27]
v_exp_f32 v218, v10
v_mfma_f32_16x16x32_bf16 v[24:27], v[172:175], a[252:255], v[24:27]
v_exp_f32 v219, v11
v_mfma_f32_16x16x32_bf16 v[24:27], v[180:183], v[184:187], v[24:27]
v_cvt_pk_bf16_f32 v73, v218, v219
v_add_f32 v218, v218, v219
v_mfma_f32_16x16x32_bf16 v[24:27], v[176:179], v[188:191], v[24:27]
v_add_f32 v226, v216, v218
v_mfma_f32_16x16x32_bf16 v[28:31], v[176:179], v[212:215], v[140:143]
ds_read_b128 v[176:179], v232 offset:16384
v_mfma_f32_16x16x32_bf16 v[28:31], v[180:183], v[208:211], v[28:31]
ds_read_b128 v[180:183], v233 offset:16384
v_mfma_f32_16x16x32_bf16 v[28:31], v[172:175], v[204:207], v[28:31]
v_exp_f32 v220, v12
v_mfma_f32_16x16x32_bf16 v[28:31], v[168:171], v[200:203], v[28:31]
s_add_u32 m0, s24, 96256
v_mfma_f32_16x16x32_bf16 v[28:31], v[164:167], v[196:199], v[28:31]
v_exp_f32 v221, v13
v_mfma_f32_16x16x32_bf16 v[28:31], v[160:163], v[192:195], v[28:31]
v_cvt_pk_bf16_f32 v76, v220, v221
s_waitcnt lgkmcnt(2)
v_mfma_f32_16x16x32_bf16 v[32:35], v[144:147], a[192:195], v[128:131]
buffer_load_dwordx4 v246, s[16:19], s25 offen offset:3072 lds
v_mfma_f32_16x16x32_bf16 v[32:35], v[148:151], a[196:199], v[32:35]
v_exp_f32 v222, v14
v_mfma_f32_16x16x32_bf16 v[32:35], v[152:155], a[200:203], v[32:35]
v_add_f32 v220, v220, v221
v_mfma_f32_16x16x32_bf16 v[32:35], v[156:159], a[204:207], v[32:35]
s_waitcnt lgkmcnt(0)
v_mfma_f32_16x16x32_bf16 v[32:35], v[176:179], a[208:211], v[32:35]
v_exp_f32 v223, v15
v_mfma_f32_16x16x32_bf16 v[32:35], v[180:183], a[212:215], v[32:35]
v_cvt_pk_bf16_f32 v77, v222, v223
v_add_f32 v222, v222, v223
v_mfma_f32_16x16x32_bf16 v[36:39], v[180:183], a[236:239], v[132:135]
v_exp_f32 v216, v16
v_mfma_f32_16x16x32_bf16 v[36:39], v[176:179], a[232:235], v[36:39]
ds_read_b128 v[160:163], v232 offset:18432
v_add_f32 v227, v220, v222
v_mfma_f32_16x16x32_bf16 v[36:39], v[156:159], a[228:231], v[36:39]
ds_read_b128 v[164:167], v233 offset:18432
v_mfma_f32_16x16x32_bf16 v[36:39], v[152:155], a[224:227], v[36:39]
v_exp_f32 v217, v17
v_mfma_f32_16x16x32_bf16 v[36:39], v[148:151], a[220:223], v[36:39]
ds_read_b128 v[168:171], v232 offset:20480
v_cvt_pk_bf16_f32 v66, v216, v217
v_mfma_f32_16x16x32_bf16 v[36:39], v[144:147], a[216:219], v[36:39]
ds_read_b128 v[172:175], v233 offset:20480
s_add_u32 m0, s24, 51072
v_mfma_f32_16x16x32_bf16 v[40:43], v[144:147], a[240:243], v[136:139]
v_exp_f32 v218, v18
v_mfma_f32_16x16x32_bf16 v[40:43], v[148:151], a[244:247], v[40:43]
buffer_load_dwordx4 v244, s[12:15], s25 offen offset:128 lds
v_mfma_f32_16x16x32_bf16 v[40:43], v[152:155], a[248:251], v[40:43]
v_add_f32 v216, v216, v217
v_mfma_f32_16x16x32_bf16 v[40:43], v[156:159], a[252:255], v[40:43]
v_exp_f32 v219, v19
v_mfma_f32_16x16x32_bf16 v[40:43], v[176:179], v[184:187], v[40:43]
v_cvt_pk_bf16_f32 v67, v218, v219
v_add_f32 v218, v218, v219
v_mfma_f32_16x16x32_bf16 v[40:43], v[180:183], v[188:191], v[40:43]
v_exp_f32 v220, v20
v_mfma_f32_16x16x32_bf16 v[44:47], v[180:183], v[212:215], v[140:143]
ds_read_b128 v[180:183], v232 offset:22528
v_add_f32 v224, v224, v216
v_mfma_f32_16x16x32_bf16 v[44:47], v[176:179], v[208:211], v[44:47]
ds_read_b128 v[176:179], v233 offset:22528
v_add_f32 v224, v224, v218
v_mfma_f32_16x16x32_bf16 v[44:47], v[156:159], v[204:207], v[44:47]
v_exp_f32 v221, v21
v_mfma_f32_16x16x32_bf16 v[44:47], v[152:155], v[200:203], v[44:47]
v_cvt_pk_bf16_f32 v70, v220, v221
v_add_f32 v220, v220, v221
v_mfma_f32_16x16x32_bf16 v[44:47], v[148:151], v[196:199], v[44:47]
v_add_f32 v225, v225, v220
v_mfma_f32_16x16x32_bf16 v[44:47], v[144:147], v[192:195], v[44:47]
ds_read_b64_tr_b16 v[144:145], v240 offset:0
s_waitcnt lgkmcnt(3)
v_mfma_f32_16x16x32_bf16 v[48:51], v[160:163], a[192:195], v[128:131]
v_exp_f32 v222, v22
v_mfma_f32_16x16x32_bf16 v[48:51], v[164:167], a[196:199], v[48:51]
ds_read_b64_tr_b16 v[146:147], v240 offset:6144
s_add_u32 m0, s24, 100224
v_mfma_f32_16x16x32_bf16 v[48:51], v[168:171], a[200:203], v[48:51]
v_exp_f32 v223, v23
v_mfma_f32_16x16x32_bf16 v[48:51], v[172:175], a[204:207], v[48:51]
v_cvt_pk_bf16_f32 v71, v222, v223
s_waitcnt lgkmcnt(2)
v_mfma_f32_16x16x32_bf16 v[48:51], v[180:183], a[208:211], v[48:51]
v_exp_f32 v216, v24
v_mfma_f32_16x16x32_bf16 v[48:51], v[176:179], a[212:215], v[48:51]
buffer_load_dwordx4 v246, s[16:19], s25 offen offset:128 lds
v_mfma_f32_16x16x32_bf16 v[52:55], v[176:179], a[236:239], v[132:135]
ds_read_b64_tr_b16 v[148:149], v240 offset:12288
v_add_f32 v222, v222, v223
v_mfma_f32_16x16x32_bf16 v[52:55], v[180:183], a[232:235], v[52:55]
v_exp_f32 v217, v25
v_mfma_f32_16x16x32_bf16 v[52:55], v[172:175], a[228:231], v[52:55]
ds_read_b64_tr_b16 v[150:151], v240 offset:18432
v_add_f32 v225, v225, v222
v_mfma_f32_16x16x32_bf16 v[52:55], v[168:171], a[224:227], v[52:55]
ds_read_b64_tr_b16 v[152:153], v241 offset:0
v_cvt_pk_bf16_f32 v74, v216, v217
v_mfma_f32_16x16x32_bf16 v[52:55], v[164:167], a[220:223], v[52:55]
v_exp_f32 v218, v26
v_mfma_f32_16x16x32_bf16 v[52:55], v[160:163], a[216:219], v[52:55]
ds_read_b64_tr_b16 v[154:155], v241 offset:6144
v_add_f32 v216, v216, v217
v_mfma_f32_16x16x32_bf16 v[56:59], v[160:163], a[240:243], v[136:139]
ds_read_b64_tr_b16 v[156:157], v241 offset:12288
v_add_f32 v226, v226, v216
v_mfma_f32_16x16x32_bf16 v[56:59], v[164:167], a[244:247], v[56:59]
v_exp_f32 v219, v27
v_mfma_f32_16x16x32_bf16 v[56:59], v[168:171], a[248:251], v[56:59]
ds_read_b64_tr_b16 v[158:159], v241 offset:18432
v_cvt_pk_bf16_f32 v75, v218, v219
v_mfma_f32_16x16x32_bf16 v[56:59], v[172:175], a[252:255], v[56:59]
v_exp_f32 v220, v28
v_mfma_f32_16x16x32_bf16 v[56:59], v[180:183], v[184:187], v[56:59]
s_add_u32 m0, s24, 52096
v_add_f32 v218, v218, v219
v_mfma_f32_16x16x32_bf16 v[56:59], v[176:179], v[188:191], v[56:59]
buffer_load_dwordx4 v245, s[12:15], s25 offen offset:128 lds
v_mfma_f32_16x16x32_bf16 v[60:63], v[176:179], v[212:215], v[140:143]
v_exp_f32 v221, v29
v_mfma_f32_16x16x32_bf16 v[60:63], v[180:183], v[208:211], v[60:63]
ds_read_b64_tr_b16 v[176:177], v242 offset:0
v_add_f32 v226, v226, v218
v_mfma_f32_16x16x32_bf16 v[60:63], v[172:175], v[204:207], v[60:63]
ds_read_b64_tr_b16 v[178:179], v242 offset:6144
v_cvt_pk_bf16_f32 v78, v220, v221
v_mfma_f32_16x16x32_bf16 v[60:63], v[168:171], v[200:203], v[60:63]
v_exp_f32 v222, v30
v_mfma_f32_16x16x32_bf16 v[60:63], v[164:167], v[196:199], v[60:63]
ds_read_b64_tr_b16 v[180:181], v242 offset:12288
v_add_f32 v220, v220, v221
v_mfma_f32_16x16x32_bf16 v[60:63], v[160:163], v[192:195], v[60:63]
ds_read_b64_tr_b16 v[182:183], v242 offset:18432
s_waitcnt lgkmcnt(4)
v_mfma_f32_16x16x32_bf16 a[0:3], v[144:147], v[96:99], a[0:3]
v_exp_f32 v223, v31
v_mfma_f32_16x16x32_bf16 a[0:3], v[148:151], v[112:115], a[0:3]
ds_read_b64_tr_b16 v[160:161], v243 offset:0
v_cvt_pk_bf16_f32 v79, v222, v223
v_mfma_f32_16x16x32_bf16 a[4:7], v[148:151], v[116:119], a[4:7]
v_exp_f32 v216, v32
v_mfma_f32_16x16x32_bf16 a[4:7], v[144:147], v[100:103], a[4:7]
ds_read_b64_tr_b16 v[162:163], v243 offset:6144
v_add_f32 v222, v222, v223
v_mfma_f32_16x16x32_bf16 a[8:11], v[144:147], v[104:107], a[8:11]
ds_read_b64_tr_b16 v[164:165], v243 offset:12288
v_add_f32 v227, v227, v220
v_mfma_f32_16x16x32_bf16 a[8:11], v[148:151], v[120:123], a[8:11]
v_exp_f32 v217, v33
v_mfma_f32_16x16x32_bf16 a[12:15], v[148:151], v[124:127], a[12:15]
ds_read_b64_tr_b16 v[166:167], v243 offset:18432
s_add_u32 m0, s24, 98176
v_mfma_f32_16x16x32_bf16 a[12:15], v[144:147], v[108:111], a[12:15]
buffer_load_dwordx4 v246, s[16:19], s25 offen offset:3200 lds
v_mfma_f32_16x16x32_bf16 a[16:19], v[152:155], v[96:99], a[16:19]
v_exp_f32 v218, v34
v_mfma_f32_16x16x32_bf16 a[16:19], v[156:159], v[112:115], a[16:19]
v_add_f32 v227, v227, v222
v_cvt_pk_bf16_f32 v80, v216, v217
v_mfma_f32_16x16x32_bf16 a[20:23], v[156:159], v[116:119], a[20:23]
ds_read_b64_tr_b16 v[168:169], v240 offset:2048
v_add_f32 v216, v216, v217
v_mfma_f32_16x16x32_bf16 a[20:23], v[152:155], v[100:103], a[20:23]
v_exp_f32 v219, v35
v_mfma_f32_16x16x32_bf16 a[24:27], v[152:155], v[104:107], a[24:27]
v_cvt_pk_bf16_f32 v81, v218, v219
v_add_f32 v218, v218, v219
v_mfma_f32_16x16x32_bf16 a[24:27], v[156:159], v[120:123], a[24:27]
v_exp_f32 v220, v36
v_mfma_f32_16x16x32_bf16 a[28:31], v[156:159], v[124:127], a[28:31]
ds_read_b64_tr_b16 v[170:171], v240 offset:8192
v_add_f32 v224, v224, v216
v_mfma_f32_16x16x32_bf16 a[28:31], v[152:155], v[108:111], a[28:31]
v_add_f32 v224, v224, v218
s_waitcnt lgkmcnt(2)
v_mfma_f32_16x16x32_bf16 a[32:35], v[176:179], v[96:99], a[32:35]
v_exp_f32 v221, v37
v_mfma_f32_16x16x32_bf16 a[32:35], v[180:183], v[112:115], a[32:35]
ds_read_b64_tr_b16 v[172:173], v240 offset:14336
v_cvt_pk_bf16_f32 v84, v220, v221
v_mfma_f32_16x16x32_bf16 a[36:39], v[180:183], v[116:119], a[36:39]
ds_read_b64_tr_b16 v[174:175], v240 offset:20480
v_add_f32 v220, v220, v221
v_mfma_f32_16x16x32_bf16 a[36:39], v[176:179], v[100:103], a[36:39]
v_exp_f32 v222, v38
v_mfma_f32_16x16x32_bf16 a[40:43], v[176:179], v[104:107], a[40:43]
ds_read_b64_tr_b16 v[144:145], v241 offset:2048
s_add_u32 m0, s24, 52992
v_mfma_f32_16x16x32_bf16 a[40:43], v[180:183], v[120:123], a[40:43]
ds_read_b64_tr_b16 v[146:147], v241 offset:8192
v_add_f32 v225, v225, v220
v_mfma_f32_16x16x32_bf16 a[44:47], v[180:183], v[124:127], a[44:47]
v_exp_f32 v223, v39
v_mfma_f32_16x16x32_bf16 a[44:47], v[176:179], v[108:111], a[44:47]
ds_read_b64_tr_b16 v[148:149], v241 offset:14336
v_cvt_pk_bf16_f32 v85, v222, v223
v_mfma_f32_16x16x32_bf16 a[48:51], v[160:163], v[96:99], a[48:51]
ds_read_b64_tr_b16 v[150:151], v241 offset:20480
v_add_f32 v222, v222, v223
v_mfma_f32_16x16x32_bf16 a[48:51], v[164:167], v[112:115], a[48:51]
buffer_load_dwordx4 v244, s[12:15], s25 offen offset:256 lds
v_mfma_f32_16x16x32_bf16 a[52:55], v[164:167], v[116:119], a[52:55]
v_exp_f32 v216, v40
v_mfma_f32_16x16x32_bf16 a[52:55], v[160:163], v[100:103], a[52:55]
v_exp_f32 v217, v41
v_mfma_f32_16x16x32_bf16 a[56:59], v[160:163], v[104:107], a[56:59]
ds_read_b64_tr_b16 v[176:177], v242 offset:2048
v_add_f32 v225, v225, v222
v_mfma_f32_16x16x32_bf16 a[56:59], v[164:167], v[120:123], a[56:59]
ds_read_b64_tr_b16 v[178:179], v242 offset:8192
v_cvt_pk_bf16_f32 v88, v216, v217
v_mfma_f32_16x16x32_bf16 a[60:63], v[164:167], v[124:127], a[60:63]
v_exp_f32 v218, v42
v_mfma_f32_16x16x32_bf16 a[60:63], v[160:163], v[108:111], a[60:63]
ds_read_b64_tr_b16 v[180:181], v242 offset:14336
s_waitcnt lgkmcnt(3)
v_mfma_f32_16x16x32_bf16 a[64:67], v[168:171], v[96:99], a[64:67]
ds_read_b64_tr_b16 v[182:183], v242 offset:20480
v_add_f32 v216, v216, v217
v_mfma_f32_16x16x32_bf16 a[64:67], v[172:175], v[112:115], a[64:67]
v_exp_f32 v219, v43
v_mfma_f32_16x16x32_bf16 a[68:71], v[172:175], v[116:119], a[68:71]
ds_read_b64_tr_b16 v[160:161], v243 offset:2048
s_add_u32 m0, s24, 102144
v_mfma_f32_16x16x32_bf16 a[68:71], v[168:171], v[100:103], a[68:71]
v_exp_f32 v220, v44
v_mfma_f32_16x16x32_bf16 a[72:75], v[168:171], v[104:107], a[72:75]
buffer_load_dwordx4 v246, s[16:19], s25 offen offset:256 lds
v_mfma_f32_16x16x32_bf16 a[72:75], v[172:175], v[120:123], a[72:75]
ds_read_b64_tr_b16 v[162:163], v243 offset:8192
v_cvt_pk_bf16_f32 v89, v218, v219
v_mfma_f32_16x16x32_bf16 a[76:79], v[172:175], v[124:127], a[76:79]
v_exp_f32 v221, v45
v_mfma_f32_16x16x32_bf16 a[76:79], v[168:171], v[108:111], a[76:79]
ds_read_b64_tr_b16 v[164:165], v243 offset:14336
v_add_f32 v218, v218, v219
v_mfma_f32_16x16x32_bf16 a[80:83], v[144:147], v[96:99], a[80:83]
ds_read_b64_tr_b16 v[166:167], v243 offset:20480
v_add_f32 v226, v226, v216
v_mfma_f32_16x16x32_bf16 a[80:83], v[148:151], v[112:115], a[80:83]
v_exp_f32 v222, v46
v_mfma_f32_16x16x32_bf16 a[84:87], v[148:151], v[116:119], a[84:87]
v_add_f32 v226, v226, v218
v_cvt_pk_bf16_f32 v92, v220, v221
v_mfma_f32_16x16x32_bf16 a[84:87], v[144:147], v[100:103], a[84:87]
ds_read_b64_tr_b16 v[152:153], v240 offset:4096
v_add_f32 v220, v220, v221
v_mfma_f32_16x16x32_bf16 a[88:91], v[144:147], v[104:107], a[88:91]
v_exp_f32 v223, v47
v_mfma_f32_16x16x32_bf16 a[88:91], v[148:151], v[120:123], a[88:91]
v_cvt_pk_bf16_f32 v93, v222, v223
v_add_f32 v222, v222, v223
v_mfma_f32_16x16x32_bf16 a[92:95], v[148:151], v[124:127], a[92:95]
v_exp_f32 v216, v48
v_mfma_f32_16x16x32_bf16 a[92:95], v[144:147], v[108:111], a[92:95]
s_add_u32 m0, s24, 54016
s_waitcnt lgkmcnt(1)
v_mfma_f32_16x16x32_bf16 a[96:99], v[176:179], v[96:99], a[96:99]
buffer_load_dwordx4 v245, s[12:15], s25 offen offset:256 lds
v_mfma_f32_16x16x32_bf16 a[96:99], v[180:183], v[112:115], a[96:99]
v_exp_f32 v217, v49
v_mfma_f32_16x16x32_bf16 a[100:103], v[180:183], v[116:119], a[100:103]
ds_read_b64_tr_b16 v[154:155], v240 offset:10240
v_add_f32 v227, v227, v220
v_mfma_f32_16x16x32_bf16 a[100:103], v[176:179], v[100:103], a[100:103]
ds_read_b64_tr_b16 v[156:157], v240 offset:16384
v_add_f32 v227, v227, v222
v_mfma_f32_16x16x32_bf16 a[104:107], v[176:179], v[104:107], a[104:107]
v_exp_f32 v218, v50
v_mfma_f32_16x16x32_bf16 a[104:107], v[180:183], v[120:123], a[104:107]
ds_read_b64_tr_b16 v[158:159], v240 offset:22528
v_cvt_pk_bf16_f32 v82, v216, v217
v_mfma_f32_16x16x32_bf16 a[108:111], v[180:183], v[124:127], a[108:111]
ds_read_b64_tr_b16 v[144:145], v241 offset:4096
v_add_f32 v216, v216, v217
v_mfma_f32_16x16x32_bf16 a[108:111], v[176:179], v[108:111], a[108:111]
ds_read_b64_tr_b16 v[146:147], v241 offset:10240
v_add_f32 v224, v224, v216
v_mfma_f32_16x16x32_bf16 a[112:115], v[160:163], v[96:99], a[112:115]
ds_read_b64_tr_b16 v[148:149], v241 offset:16384
ds_read_b64_tr_b16 v[150:151], v241 offset:22528
v_mfma_f32_16x16x32_bf16 a[112:115], v[164:167], v[112:115], a[112:115]
v_exp_f32 v219, v51
v_mfma_f32_16x16x32_bf16 a[116:119], v[164:167], v[116:119], a[116:119]
v_exp_f32 v220, v52
v_mfma_f32_16x16x32_bf16 a[116:119], v[160:163], v[100:103], a[116:119]
v_cvt_pk_bf16_f32 v83, v218, v219
v_add_f32 v218, v218, v219
v_mfma_f32_16x16x32_bf16 a[120:123], v[160:163], v[104:107], a[120:123]
v_exp_f32 v221, v53
v_mfma_f32_16x16x32_bf16 a[120:123], v[164:167], v[120:123], a[120:123]
s_add_u32 m0, s24, 100096
v_add_f32 v224, v224, v218
v_mfma_f32_16x16x32_bf16 a[124:127], v[164:167], v[124:127], a[124:127]
buffer_load_dwordx4 v246, s[16:19], s25 offen offset:3328 lds
v_mfma_f32_16x16x32_bf16 a[124:127], v[160:163], v[108:111], a[124:127]
ds_read_b64_tr_b16 v[176:177], v242 offset:4096
s_waitcnt lgkmcnt(1)
v_mfma_f32_16x16x32_bf16 a[128:131], v[152:155], v[96:99], a[128:131]
v_exp_f32 v222, v54
v_mfma_f32_16x16x32_bf16 a[128:131], v[156:159], v[112:115], a[128:131]
ds_read_b64_tr_b16 v[178:179], v242 offset:10240
v_cvt_pk_bf16_f32 v86, v220, v221
v_mfma_f32_16x16x32_bf16 a[132:135], v[156:159], v[116:119], a[132:135]
v_exp_f32 v223, v55
v_mfma_f32_16x16x32_bf16 a[132:135], v[152:155], v[100:103], a[132:135]
ds_read_b64_tr_b16 v[180:181], v242 offset:16384
v_add_f32 v220, v220, v221
v_mfma_f32_16x16x32_bf16 a[136:139], v[152:155], v[104:107], a[136:139]
v_exp_f32 v216, v56
v_mfma_f32_16x16x32_bf16 a[136:139], v[156:159], v[120:123], a[136:139]
ds_read_b64_tr_b16 v[182:183], v242 offset:22528
v_cvt_pk_bf16_f32 v87, v222, v223
v_mfma_f32_16x16x32_bf16 a[140:143], v[156:159], v[124:127], a[140:143]
ds_read_b64_tr_b16 v[168:169], v243 offset:4096
v_add_f32 v222, v222, v223
v_mfma_f32_16x16x32_bf16 a[140:143], v[152:155], v[108:111], a[140:143]
ds_read_b64_tr_b16 v[170:171], v243 offset:10240
v_add_f32 v225, v225, v220
v_mfma_f32_16x16x32_bf16 a[144:147], v[144:147], v[96:99], a[144:147]
ds_read_b64_tr_b16 v[172:173], v243 offset:16384
ds_read_b64_tr_b16 v[174:175], v243 offset:22528
v_mfma_f32_16x16x32_bf16 a[144:147], v[148:151], v[112:115], a[144:147]
v_exp_f32 v217, v57
v_mfma_f32_16x16x32_bf16 a[148:151], v[148:151], v[116:119], a[148:151]
v_exp_f32 v218, v58
v_mfma_f32_16x16x32_bf16 a[148:151], v[144:147], v[100:103], a[148:151]
v_add_f32 v225, v225, v222
v_cvt_pk_bf16_f32 v90, v216, v217
v_mfma_f32_16x16x32_bf16 a[152:155], v[144:147], v[104:107], a[152:155]
s_add_u32 s25, s25, 24576
v_add_f32 v216, v216, v217
v_mfma_f32_16x16x32_bf16 a[152:155], v[148:151], v[120:123], a[152:155]
v_exp_f32 v219, v59
v_mfma_f32_16x16x32_bf16 a[156:159], v[148:151], v[124:127], a[156:159]
v_cvt_pk_bf16_f32 v91, v218, v219
v_add_f32 v218, v218, v219
v_mfma_f32_16x16x32_bf16 a[156:159], v[144:147], v[108:111], a[156:159]
s_waitcnt vmcnt(12) lgkmcnt(0)
s_barrier
v_mfma_f32_16x16x32_bf16 a[160:163], v[176:179], v[96:99], a[160:163]
v_exp_f32 v220, v60
v_mfma_f32_16x16x32_bf16 a[160:163], v[180:183], v[112:115], a[160:163]
ds_read_b128 v[144:147], v232 offset:24576
v_add_f32 v226, v226, v216
v_mfma_f32_16x16x32_bf16 a[164:167], v[180:183], v[116:119], a[164:167]
v_exp_f32 v221, v61
v_mfma_f32_16x16x32_bf16 a[164:167], v[176:179], v[100:103], a[164:167]
ds_read_b128 v[148:151], v233 offset:24576
v_cvt_pk_bf16_f32 v94, v220, v221
v_mfma_f32_16x16x32_bf16 a[168:171], v[176:179], v[104:107], a[168:171]
ds_read_b128 v[152:155], v232 offset:26624
v_add_f32 v220, v220, v221
v_mfma_f32_16x16x32_bf16 a[168:171], v[180:183], v[120:123], a[168:171]
v_exp_f32 v222, v62
v_mfma_f32_16x16x32_bf16 a[172:175], v[180:183], v[124:127], a[172:175]
ds_read_b128 v[156:159], v233 offset:26624
v_add_f32 v226, v226, v218
v_mfma_f32_16x16x32_bf16 a[172:175], v[176:179], v[108:111], a[172:175]
v_exp_f32 v223, v63
v_mfma_f32_16x16x32_bf16 a[176:179], v[168:171], v[96:99], a[176:179]
v_cvt_pk_bf16_f32 v95, v222, v223
v_add_f32 v222, v222, v223
v_mfma_f32_16x16x32_bf16 a[176:179], v[172:175], v[112:115], a[176:179]
s_sub_u32 s26, s26, 1
v_add_f32 v227, v227, v220
v_mfma_f32_16x16x32_bf16 a[180:183], v[172:175], v[116:119], a[180:183]
ds_read_b128 v[176:179], v232 offset:28672
v_add_f32 v227, v227, v222
v_mfma_f32_16x16x32_bf16 a[180:183], v[168:171], v[100:103], a[180:183]
ds_read_b128 v[180:183], v233 offset:28672
v_max3_f32 v247, v224, v225, v226
v_mfma_f32_16x16x32_bf16 a[184:187], v[168:171], v[104:107], a[184:187]
v_max_f32 v247, v247, v227
v_mfma_f32_16x16x32_bf16 a[184:187], v[172:175], v[120:123], a[184:187]
v_cmp_lt_f32 vcc, s27, v247
s_cmp_lg_u32 s26, 0
v_mfma_f32_16x16x32_bf16 a[188:191], v[172:175], v[124:127], a[188:191]
s_waitcnt lgkmcnt(2)
v_mfma_f32_16x16x32_bf16 a[188:191], v[168:171], v[108:111], a[188:191]
s_cbranch_vccnz L_stub_5
L_back_5:
s_cbranch_scc1 L_loop
v_mfma_f32_16x16x32_bf16 v[0:3], v[144:147], a[192:195], v[128:131]
v_add_f32 v228, v228, v224
v_add_f32 v229, v229, v225
v_mfma_f32_16x16x32_bf16 v[0:3], v[148:151], a[196:199], v[0:3]
v_add_f32 v230, v230, v226
v_add_f32 v231, v231, v227
v_mfma_f32_16x16x32_bf16 v[0:3], v[152:155], a[200:203], v[0:3]
v_mfma_f32_16x16x32_bf16 v[0:3], v[156:159], a[204:207], v[0:3]
s_waitcnt lgkmcnt(0)
v_mfma_f32_16x16x32_bf16 v[0:3], v[176:179], a[208:211], v[0:3]
v_mfma_f32_16x16x32_bf16 v[0:3], v[180:183], a[212:215], v[0:3]
v_mfma_f32_16x16x32_bf16 v[4:7], v[180:183], a[236:239], v[132:135]
v_mfma_f32_16x16x32_bf16 v[4:7], v[176:179], a[232:235], v[4:7]
ds_read_b128 v[160:163], v232 offset:30720
v_mfma_f32_16x16x32_bf16 v[4:7], v[156:159], a[228:231], v[4:7]
ds_read_b128 v[164:167], v233 offset:30720
v_mfma_f32_16x16x32_bf16 v[4:7], v[152:155], a[224:227], v[4:7]
ds_read_b128 v[168:171], v232 offset:32768
v_mfma_f32_16x16x32_bf16 v[4:7], v[148:151], a[220:223], v[4:7]
v_exp_f32 v216, v0
v_mfma_f32_16x16x32_bf16 v[4:7], v[144:147], a[216:219], v[4:7]
ds_read_b128 v[172:175], v233 offset:32768
v_mfma_f32_16x16x32_bf16 v[8:11], v[144:147], a[240:243], v[136:139]
v_exp_f32 v217, v1
v_mfma_f32_16x16x32_bf16 v[8:11], v[148:151], a[244:247], v[8:11]
v_cvt_pk_bf16_f32 v96, v216, v217
v_add_f32 v216, v216, v217
v_mfma_f32_16x16x32_bf16 v[8:11], v[152:155], a[248:251], v[8:11]
v_exp_f32 v218, v2
v_mfma_f32_16x16x32_bf16 v[8:11], v[156:159], a[252:255], v[8:11]
v_exp_f32 v219, v3
v_mfma_f32_16x16x32_bf16 v[8:11], v[176:179], v[184:187], v[8:11]
v_cvt_pk_bf16_f32 v97, v218, v219
v_add_f32 v218, v218, v219
v_mfma_f32_16x16x32_bf16 v[8:11], v[180:183], v[188:191], v[8:11]
v_add_f32 v224, v216, v218
v_mfma_f32_16x16x32_bf16 v[12:15], v[180:183], v[212:215], v[140:143]
ds_read_b128 v[180:183], v232 offset:34816
v_mfma_f32_16x16x32_bf16 v[12:15], v[176:179], v[208:211], v[12:15]
ds_read_b128 v[176:179], v233 offset:34816
v_mfma_f32_16x16x32_bf16 v[12:15], v[156:159], v[204:207], v[12:15]
v_exp_f32 v220, v4
v_mfma_f32_16x16x32_bf16 v[12:15], v[152:155], v[200:203], v[12:15]
v_exp_f32 v221, v5
v_mfma_f32_16x16x32_bf16 v[12:15], v[148:151], v[196:199], v[12:15]
v_cvt_pk_bf16_f32 v100, v220, v221
v_add_f32 v220, v220, v221
v_mfma_f32_16x16x32_bf16 v[12:15], v[144:147], v[192:195], v[12:15]
s_waitcnt lgkmcnt(2)
v_mfma_f32_16x16x32_bf16 v[16:19], v[160:163], a[192:195], v[128:131]
v_exp_f32 v222, v6
v_mfma_f32_16x16x32_bf16 v[16:19], v[164:167], a[196:199], v[16:19]
v_exp_f32 v223, v7
v_mfma_f32_16x16x32_bf16 v[16:19], v[168:171], a[200:203], v[16:19]
v_cvt_pk_bf16_f32 v101, v222, v223
v_add_f32 v222, v222, v223
v_mfma_f32_16x16x32_bf16 v[16:19], v[172:175], a[204:207], v[16:19]
v_add_f32 v225, v220, v222
s_waitcnt lgkmcnt(0)
v_mfma_f32_16x16x32_bf16 v[16:19], v[180:183], a[208:211], v[16:19]
v_exp_f32 v216, v8
v_mfma_f32_16x16x32_bf16 v[16:19], v[176:179], a[212:215], v[16:19]
v_exp_f32 v217, v9
v_mfma_f32_16x16x32_bf16 v[20:23], v[176:179], a[236:239], v[132:135]
v_cvt_pk_bf16_f32 v104, v216, v217
v_add_f32 v216, v216, v217
v_mfma_f32_16x16x32_bf16 v[20:23], v[180:183], a[232:235], v[20:23]
ds_read_b128 v[144:147], v232 offset:36864
v_mfma_f32_16x16x32_bf16 v[20:23], v[172:175], a[228:231], v[20:23]
ds_read_b128 v[148:151], v233 offset:36864
v_mfma_f32_16x16x32_bf16 v[20:23], v[168:171], a[224:227], v[20:23]
ds_read_b128 v[152:155], v232 offset:38912
v_mfma_f32_16x16x32_bf16 v[20:23], v[164:167], a[220:223], v[20:23]
ds_read_b128 v[156:159], v233 offset:38912
v_mfma_f32_16x16x32_bf16 v[20:23], v[160:163], a[216:219], v[20:23]
v_exp_f32 v218, v10
v_mfma_f32_16x16x32_bf16 v[24:27], v[160:163], a[240:243], v[136:139]
v_exp_f32 v219, v11
v_mfma_f32_16x16x32_bf16 v[24:27], v[164:167], a[244:247], v[24:27]
v_cvt_pk_bf16_f32 v105, v218, v219
v_add_f32 v218, v218, v219
v_mfma_f32_16x16x32_bf16 v[24:27], v[168:171], a[248:251], v[24:27]
v_add_f32 v226, v216, v218
v_mfma_f32_16x16x32_bf16 v[24:27], v[172:175], a[252:255], v[24:27]
v_exp_f32 v220, v12
v_mfma_f32_16x16x32_bf16 v[24:27], v[180:183], v[184:187], v[24:27]
v_exp_f32 v221, v13
v_mfma_f32_16x16x32_bf16 v[24:27], v[176:179], v[188:191], v[24:27]
v_cvt_pk_bf16_f32 v108, v220, v221
v_add_f32 v220, v220, v221
v_mfma_f32_16x16x32_bf16 v[28:31], v[176:179], v[212:215], v[140:143]
ds_read_b128 v[176:179], v232 offset:40960
v_mfma_f32_16x16x32_bf16 v[28:31], v[180:183], v[208:211], v[28:31]
ds_read_b128 v[180:183], v233 offset:40960
v_mfma_f32_16x16x32_bf16 v[28:31], v[172:175], v[204:207], v[28:31]
v_exp_f32 v222, v14
v_mfma_f32_16x16x32_bf16 v[28:31], v[168:171], v[200:203], v[28:31]
v_exp_f32 v223, v15
v_mfma_f32_16x16x32_bf16 v[28:31], v[164:167], v[196:199], v[28:31]
v_cvt_pk_bf16_f32 v109, v222, v223
v_add_f32 v222, v222, v223
v_mfma_f32_16x16x32_bf16 v[28:31], v[160:163], v[192:195], v[28:31]
v_add_f32 v227, v220, v222
s_waitcnt lgkmcnt(2)
v_mfma_f32_16x16x32_bf16 v[32:35], v[144:147], a[192:195], v[128:131]
v_exp_f32 v216, v16
v_mfma_f32_16x16x32_bf16 v[32:35], v[148:151], a[196:199], v[32:35]
v_exp_f32 v217, v17
v_mfma_f32_16x16x32_bf16 v[32:35], v[152:155], a[200:203], v[32:35]
v_cvt_pk_bf16_f32 v98, v216, v217
v_add_f32 v216, v216, v217
v_mfma_f32_16x16x32_bf16 v[32:35], v[156:159], a[204:207], v[32:35]
v_add_f32 v224, v224, v216
s_waitcnt lgkmcnt(0)
v_mfma_f32_16x16x32_bf16 v[32:35], v[176:179], a[208:211], v[32:35]
v_exp_f32 v218, v18
v_mfma_f32_16x16x32_bf16 v[32:35], v[180:183], a[212:215], v[32:35]
v_exp_f32 v219, v19
v_mfma_f32_16x16x32_bf16 v[36:39], v[180:183], a[236:239], v[132:135]
v_cvt_pk_bf16_f32 v99, v218, v219
v_add_f32 v218, v218, v219
v_mfma_f32_16x16x32_bf16 v[36:39], v[176:179], a[232:235], v[36:39]
ds_read_b128 v[160:163], v232 offset:43008
v_add_f32 v224, v224, v218
v_mfma_f32_16x16x32_bf16 v[36:39], v[156:159], a[228:231], v[36:39]
ds_read_b128 v[164:167], v233 offset:43008
v_mfma_f32_16x16x32_bf16 v[36:39], v[152:155], a[224:227], v[36:39]
ds_read_b128 v[168:171], v232 offset:45056
v_mfma_f32_16x16x32_bf16 v[36:39], v[148:151], a[220:223], v[36:39]
ds_read_b128 v[172:175], v233 offset:45056
v_mfma_f32_16x16x32_bf16 v[36:39], v[144:147], a[216:219], v[36:39]
v_exp_f32 v220, v20
v_mfma_f32_16x16x32_bf16 v[40:43], v[144:147], a[240:243], v[136:139]
v_exp_f32 v221, v21
v_mfma_f32_16x16x32_bf16 v[40:43], v[148:151], a[244:247], v[40:43]
v_cvt_pk_bf16_f32 v102, v220, v221
v_add_f32 v220, v220, v221
v_mfma_f32_16x16x32_bf16 v[40:43], v[152:155], a[248:251], v[40:43]
v_add_f32 v225, v225, v220
v_mfma_f32_16x16x32_bf16 v[40:43], v[156:159], a[252:255], v[40:43]
v_exp_f32 v222, v22
v_mfma_f32_16x16x32_bf16 v[40:43], v[176:179], v[184:187], v[40:43]
v_exp_f32 v223, v23
v_mfma_f32_16x16x32_bf16 v[40:43], v[180:183], v[188:191], v[40:43]
v_cvt_pk_bf16_f32 v103, v222, v223
v_add_f32 v222, v222, v223
v_mfma_f32_16x16x32_bf16 v[44:47], v[180:183], v[212:215], v[140:143]
ds_read_b128 v[180:183], v232 offset:47104
v_add_f32 v225, v225, v222
v_mfma_f32_16x16x32_bf16 v[44:47], v[176:179], v[208:211], v[44:47]
ds_read_b128 v[176:179], v233 offset:47104
v_mfma_f32_16x16x32_bf16 v[44:47], v[156:159], v[204:207], v[44:47]
v_exp_f32 v216, v24
v_mfma_f32_16x16x32_bf16 v[44:47], v[152:155], v[200:203], v[44:47]
v_exp_f32 v217, v25
v_mfma_f32_16x16x32_bf16 v[44:47], v[148:151], v[196:199], v[44:47]
v_cvt_pk_bf16_f32 v106, v216, v217
v_add_f32 v216, v216, v217
v_mfma_f32_16x16x32_bf16 v[44:47], v[144:147], v[192:195], v[44:47]
ds_read_b64_tr_b16 v[144:145], v236 offset:0
s_waitcnt lgkmcnt(3)
v_mfma_f32_16x16x32_bf16 v[48:51], v[160:163], a[192:195], v[128:131]
ds_read_b64_tr_b16 v[146:147], v236 offset:6144
v_add_f32 v226, v226, v216
v_mfma_f32_16x16x32_bf16 v[48:51], v[164:167], a[196:199], v[48:51]
ds_read_b64_tr_b16 v[148:149], v236 offset:12288
v_mfma_f32_16x16x32_bf16 v[48:51], v[168:171], a[200:203], v[48:51]
ds_read_b64_tr_b16 v[150:151], v236 offset:18432
v_mfma_f32_16x16x32_bf16 v[48:51], v[172:175], a[204:207], v[48:51]
ds_read_b64_tr_b16 v[152:153], v237 offset:0
s_waitcnt lgkmcnt(5)
v_mfma_f32_16x16x32_bf16 v[48:51], v[180:183], a[208:211], v[48:51]
ds_read_b64_tr_b16 v[154:155], v237 offset:6144
v_mfma_f32_16x16x32_bf16 v[48:51], v[176:179], a[212:215], v[48:51]
ds_read_b64_tr_b16 v[156:157], v237 offset:12288
v_mfma_f32_16x16x32_bf16 v[52:55], v[176:179], a[236:239], v[132:135]
ds_read_b64_tr_b16 v[158:159], v237 offset:18432
v_mfma_f32_16x16x32_bf16 v[52:55], v[180:183], a[232:235], v[52:55]
v_exp_f32 v218, v26
v_mfma_f32_16x16x32_bf16 v[52:55], v[172:175], a[228:231], v[52:55]
v_exp_f32 v219, v27
v_mfma_f32_16x16x32_bf16 v[52:55], v[168:171], a[224:227], v[52:55]
v_cvt_pk_bf16_f32 v107, v218, v219
v_add_f32 v218, v218, v219
v_mfma_f32_16x16x32_bf16 v[52:55], v[164:167], a[220:223], v[52:55]
v_add_f32 v226, v226, v218
v_mfma_f32_16x16x32_bf16 v[52:55], v[160:163], a[216:219], v[52:55]
v_exp_f32 v220, v28
v_mfma_f32_16x16x32_bf16 v[56:59], v[160:163], a[240:243], v[136:139]
v_exp_f32 v221, v29
v_mfma_f32_16x16x32_bf16 v[56:59], v[164:167], a[244:247], v[56:59]
v_cvt_pk_bf16_f32 v110, v220, v221
v_add_f32 v220, v220, v221
v_mfma_f32_16x16x32_bf16 v[56:59], v[168:171], a[248:251], v[56:59]
v_add_f32 v227, v227, v220
v_mfma_f32_16x16x32_bf16 v[56:59], v[172:175], a[252:255], v[56:59]
v_exp_f32 v222, v30
v_mfma_f32_16x16x32_bf16 v[56:59], v[180:183], v[184:187], v[56:59]
v_exp_f32 v223, v31
v_mfma_f32_16x16x32_bf16 v[56:59], v[176:179], v[188:191], v[56:59]
v_cvt_pk_bf16_f32 v111, v222, v223
v_add_f32 v222, v222, v223
v_mfma_f32_16x16x32_bf16 v[60:63], v[176:179], v[212:215], v[140:143]
ds_read_b64_tr_b16 v[176:177], v238 offset:0
v_add_f32 v227, v227, v222
v_mfma_f32_16x16x32_bf16 v[60:63], v[180:183], v[208:211], v[60:63]
ds_read_b64_tr_b16 v[178:179], v238 offset:6144
v_mfma_f32_16x16x32_bf16 v[60:63], v[172:175], v[204:207], v[60:63]
ds_read_b64_tr_b16 v[180:181], v238 offset:12288
v_mfma_f32_16x16x32_bf16 v[60:63], v[168:171], v[200:203], v[60:63]
ds_read_b64_tr_b16 v[182:183], v238 offset:18432
v_mfma_f32_16x16x32_bf16 v[60:63], v[164:167], v[196:199], v[60:63]
ds_read_b64_tr_b16 v[164:165], v239 offset:12288
v_mfma_f32_16x16x32_bf16 v[60:63], v[160:163], v[192:195], v[60:63]
ds_read_b64_tr_b16 v[160:161], v239 offset:0
s_waitcnt lgkmcnt(6)
v_mfma_f32_16x16x32_bf16 a[0:3], v[144:147], v[64:67], a[0:3]
ds_read_b64_tr_b16 v[162:163], v239 offset:6144
v_mfma_f32_16x16x32_bf16 a[0:3], v[148:151], v[80:83], a[0:3]
ds_read_b64_tr_b16 v[166:167], v239 offset:18432
v_mfma_f32_16x16x32_bf16 a[4:7], v[148:151], v[84:87], a[4:7]
v_exp_f32 v216, v32
v_mfma_f32_16x16x32_bf16 a[4:7], v[144:147], v[68:71], a[4:7]
v_exp_f32 v217, v33
v_mfma_f32_16x16x32_bf16 a[8:11], v[144:147], v[72:75], a[8:11]
v_cvt_pk_bf16_f32 v112, v216, v217
v_add_f32 v216, v216, v217
v_mfma_f32_16x16x32_bf16 a[8:11], v[148:151], v[88:91], a[8:11]
v_add_f32 v224, v224, v216
v_mfma_f32_16x16x32_bf16 a[12:15], v[148:151], v[92:95], a[12:15]
v_exp_f32 v218, v34
v_mfma_f32_16x16x32_bf16 a[12:15], v[144:147], v[76:79], a[12:15]
ds_read_b64_tr_b16 v[168:169], v236 offset:2048
v_mfma_f32_16x16x32_bf16 a[16:19], v[152:155], v[64:67], a[16:19]
ds_read_b64_tr_b16 v[170:171], v236 offset:8192
v_mfma_f32_16x16x32_bf16 a[16:19], v[156:159], v[80:83], a[16:19]
ds_read_b64_tr_b16 v[172:173], v236 offset:14336
v_mfma_f32_16x16x32_bf16 a[20:23], v[156:159], v[84:87], a[20:23]
ds_read_b64_tr_b16 v[174:175], v236 offset:20480
v_mfma_f32_16x16x32_bf16 a[20:23], v[152:155], v[68:71], a[20:23]
v_exp_f32 v219, v35
v_mfma_f32_16x16x32_bf16 a[24:27], v[152:155], v[72:75], a[24:27]
v_cvt_pk_bf16_f32 v113, v218, v219
v_add_f32 v218, v218, v219
v_mfma_f32_16x16x32_bf16 a[24:27], v[156:159], v[88:91], a[24:27]
v_exp_f32 v220, v36
v_mfma_f32_16x16x32_bf16 a[28:31], v[156:159], v[92:95], a[28:31]
ds_read_b64_tr_b16 v[144:145], v237 offset:2048
v_add_f32 v224, v224, v218
v_mfma_f32_16x16x32_bf16 a[28:31], v[152:155], v[76:79], a[28:31]
ds_read_b64_tr_b16 v[146:147], v237 offset:8192
s_waitcnt lgkmcnt(6)
v_mfma_f32_16x16x32_bf16 a[32:35], v[176:179], v[64:67], a[32:35]
v_exp_f32 v221, v37
v_mfma_f32_16x16x32_bf16 a[32:35], v[180:183], v[80:83], a[32:35]
ds_read_b64_tr_b16 v[148:149], v237 offset:14336
v_cvt_pk_bf16_f32 v116, v220, v221
v_mfma_f32_16x16x32_bf16 a[36:39], v[180:183], v[84:87], a[36:39]
ds_read_b64_tr_b16 v[150:151], v237 offset:20480
v_add_f32 v220, v220, v221
v_mfma_f32_16x16x32_bf16 a[36:39], v[176:179], v[68:71], a[36:39]
v_exp_f32 v222, v38
v_mfma_f32_16x16x32_bf16 a[40:43], v[176:179], v[72:75], a[40:43]
v_add_f32 v225, v225, v220
v_mfma_f32_16x16x32_bf16 a[40:43], v[180:183], v[88:91], a[40:43]
v_exp_f32 v223, v39
v_mfma_f32_16x16x32_bf16 a[44:47], v[180:183], v[92:95], a[44:47]
v_cvt_pk_bf16_f32 v117, v222, v223
v_add_f32 v222, v222, v223
v_mfma_f32_16x16x32_bf16 a[44:47], v[176:179], v[76:79], a[44:47]
ds_read_b64_tr_b16 v[176:177], v238 offset:2048
v_add_f32 v225, v225, v222
v_mfma_f32_16x16x32_bf16 a[48:51], v[160:163], v[64:67], a[48:51]
v_exp_f32 v216, v40
v_mfma_f32_16x16x32_bf16 a[48:51], v[164:167], v[80:83], a[48:51]
ds_read_b64_tr_b16 v[178:179], v238 offset:8192
v_mfma_f32_16x16x32_bf16 a[52:55], v[164:167], v[84:87], a[52:55]
ds_read_b64_tr_b16 v[180:181], v238 offset:14336
v_mfma_f32_16x16x32_bf16 a[52:55], v[160:163], v[68:71], a[52:55]
v_exp_f32 v217, v41
v_mfma_f32_16x16x32_bf16 a[56:59], v[160:163], v[72:75], a[56:59]
ds_read_b64_tr_b16 v[182:183], v238 offset:20480
v_cvt_pk_bf16_f32 v120, v216, v217
v_mfma_f32_16x16x32_bf16 a[56:59], v[164:167], v[88:91], a[56:59]
v_add_f32 v216, v216, v217
v_mfma_f32_16x16x32_bf16 a[60:63], v[164:167], v[92:95], a[60:63]
v_exp_f32 v218, v42
v_mfma_f32_16x16x32_bf16 a[60:63], v[160:163], v[76:79], a[60:63]
ds_read_b64_tr_b16 v[160:161], v239 offset:2048
s_waitcnt lgkmcnt(5)
v_mfma_f32_16x16x32_bf16 a[64:67], v[168:171], v[64:67], a[64:67]
ds_read_b64_tr_b16 v[162:163], v239 offset:8192
v_add_f32 v226, v226, v216
v_mfma_f32_16x16x32_bf16 a[64:67], v[172:175], v[80:83], a[64:67]
v_exp_f32 v219, v43
v_mfma_f32_16x16x32_bf16 a[68:71], v[172:175], v[84:87], a[68:71]
ds_read_b64_tr_b16 v[164:165], v239 offset:14336
v_cvt_pk_bf16_f32 v121, v218, v219
v_mfma_f32_16x16x32_bf16 a[68:71], v[168:171], v[68:71], a[68:71]
v_exp_f32 v220, v44
v_mfma_f32_16x16x32_bf16 a[72:75], v[168:171], v[72:75], a[72:75]
ds_read_b64_tr_b16 v[166:167], v239 offset:20480
v_add_f32 v218, v218, v219
v_mfma_f32_16x16x32_bf16 a[72:75], v[172:175], v[88:91], a[72:75]
v_add_f32 v226, v226, v218
v_mfma_f32_16x16x32_bf16 a[76:79], v[172:175], v[92:95], a[76:79]
v_exp_f32 v221, v45
v_mfma_f32_16x16x32_bf16 a[76:79], v[168:171], v[76:79], a[76:79]
v_cvt_pk_bf16_f32 v124, v220, v221
v_add_f32 v220, v220, v221
v_mfma_f32_16x16x32_bf16 a[80:83], v[144:147], v[64:67], a[80:83]
ds_read_b64_tr_b16 v[152:153], v236 offset:4096
v_add_f32 v227, v227, v220
v_mfma_f32_16x16x32_bf16 a[80:83], v[148:151], v[80:83], a[80:83]
v_exp_f32 v222, v46
v_mfma_f32_16x16x32_bf16 a[84:87], v[148:151], v[84:87], a[84:87]
ds_read_b64_tr_b16 v[154:155], v236 offset:10240
v_mfma_f32_16x16x32_bf16 a[84:87], v[144:147], v[68:71], a[84:87]
ds_read_b64_tr_b16 v[156:157], v236 offset:16384
v_mfma_f32_16x16x32_bf16 a[88:91], v[144:147], v[72:75], a[88:91]
v_exp_f32 v223, v47
v_mfma_f32_16x16x32_bf16 a[88:91], v[148:151], v[88:91], a[88:91]
v_cvt_pk_bf16_f32 v125, v222, v223
v_add_f32 v222, v222, v223
v_mfma_f32_16x16x32_bf16 a[92:95], v[148:151], v[92:95], a[92:95]
v_exp_f32 v216, v48
v_mfma_f32_16x16x32_bf16 a[92:95], v[144:147], v[76:79], a[92:95]
ds_read_b64_tr_b16 v[158:159], v236 offset:22528
s_waitcnt lgkmcnt(4)
v_mfma_f32_16x16x32_bf16 a[96:99], v[176:179], v[64:67], a[96:99]
ds_read_b64_tr_b16 v[144:145], v237 offset:4096
v_add_f32 v227, v227, v222
v_mfma_f32_16x16x32_bf16 a[96:99], v[180:183], v[80:83], a[96:99]
v_exp_f32 v217, v49
v_mfma_f32_16x16x32_bf16 a[100:103], v[180:183], v[84:87], a[100:103]
ds_read_b64_tr_b16 v[146:147], v237 offset:10240
v_cvt_pk_bf16_f32 v114, v216, v217
v_mfma_f32_16x16x32_bf16 a[100:103], v[176:179], v[68:71], a[100:103]
ds_read_b64_tr_b16 v[148:149], v237 offset:16384
v_add_f32 v216, v216, v217
v_mfma_f32_16x16x32_bf16 a[104:107], v[176:179], v[72:75], a[104:107]
v_exp_f32 v218, v50
v_mfma_f32_16x16x32_bf16 a[104:107], v[180:183], v[88:91], a[104:107]
ds_read_b64_tr_b16 v[150:151], v237 offset:22528
v_add_f32 v224, v224, v216
v_mfma_f32_16x16x32_bf16 a[108:111], v[180:183], v[92:95], a[108:111]
v_exp_f32 v219, v51
v_mfma_f32_16x16x32_bf16 a[108:111], v[176:179], v[76:79], a[108:111]
v_cvt_pk_bf16_f32 v115, v218, v219
v_add_f32 v218, v218, v219
v_mfma_f32_16x16x32_bf16 a[112:115], v[160:163], v[64:67], a[112:115]
ds_read_b64_tr_b16 v[176:177], v238 offset:4096
v_add_f32 v224, v224, v218
v_mfma_f32_16x16x32_bf16 a[112:115], v[164:167], v[80:83], a[112:115]
v_exp_f32 v220, v52
v_mfma_f32_16x16x32_bf16 a[116:119], v[164:167], v[84:87], a[116:119]
ds_read_b64_tr_b16 v[178:179], v238 offset:10240
v_mfma_f32_16x16x32_bf16 a[116:119], v[160:163], v[68:71], a[116:119]
ds_read_b64_tr_b16 v[180:181], v238 offset:16384
v_mfma_f32_16x16x32_bf16 a[120:123], v[160:163], v[72:75], a[120:123]
v_exp_f32 v221, v53
v_mfma_f32_16x16x32_bf16 a[120:123], v[164:167], v[88:91], a[120:123]
ds_read_b64_tr_b16 v[182:183], v238 offset:22528
v_cvt_pk_bf16_f32 v118, v220, v221
v_mfma_f32_16x16x32_bf16 a[124:127], v[164:167], v[92:95], a[124:127]
ds_read_b64_tr_b16 v[168:169], v239 offset:4096
v_add_f32 v220, v220, v221
v_mfma_f32_16x16x32_bf16 a[124:127], v[160:163], v[76:79], a[124:127]
ds_read_b64_tr_b16 v[170:171], v239 offset:10240
s_waitcnt lgkmcnt(6)
v_mfma_f32_16x16x32_bf16 a[128:131], v[152:155], v[64:67], a[128:131]
v_exp_f32 v222, v54
v_mfma_f32_16x16x32_bf16 a[128:131], v[156:159], v[80:83], a[128:131]
ds_read_b64_tr_b16 v[172:173], v239 offset:16384
v_add_f32 v225, v225, v220
v_mfma_f32_16x16x32_bf16 a[132:135], v[156:159], v[84:87], a[132:135]
v_exp_f32 v223, v55
v_mfma_f32_16x16x32_bf16 a[132:135], v[152:155], v[68:71], a[132:135]
ds_read_b64_tr_b16 v[174:175], v239 offset:22528
v_cvt_pk_bf16_f32 v119, v222, v223
v_mfma_f32_16x16x32_bf16 a[136:139], v[152:155], v[72:75], a[136:139]
v_exp_f32 v216, v56
v_mfma_f32_16x16x32_bf16 a[136:139], v[156:159], v[88:91], a[136:139]
v_add_f32 v222, v222, v223
v_mfma_f32_16x16x32_bf16 a[140:143], v[156:159], v[92:95], a[140:143]
v_add_f32 v225, v225, v222
v_mfma_f32_16x16x32_bf16 a[140:143], v[152:155], v[76:79], a[140:143]
v_exp_f32 v217, v57
v_mfma_f32_16x16x32_bf16 a[144:147], v[144:147], v[64:67], a[144:147]
v_cvt_pk_bf16_f32 v122, v216, v217
v_add_f32 v216, v216, v217
v_mfma_f32_16x16x32_bf16 a[144:147], v[148:151], v[80:83], a[144:147]
v_add_f32 v226, v226, v216
v_mfma_f32_16x16x32_bf16 a[148:151], v[148:151], v[84:87], a[148:151]
v_exp_f32 v218, v58
v_mfma_f32_16x16x32_bf16 a[148:151], v[144:147], v[68:71], a[148:151]
v_exp_f32 v219, v59
v_mfma_f32_16x16x32_bf16 a[152:155], v[144:147], v[72:75], a[152:155]
v_cvt_pk_bf16_f32 v123, v218, v219
v_add_f32 v218, v218, v219
v_mfma_f32_16x16x32_bf16 a[152:155], v[148:151], v[88:91], a[152:155]
v_add_f32 v226, v226, v218
v_mfma_f32_16x16x32_bf16 a[156:159], v[148:151], v[92:95], a[156:159]
v_max3_f32 v247, v224, v225, v226
v_mfma_f32_16x16x32_bf16 a[156:159], v[144:147], v[76:79], a[156:159]
s_waitcnt vmcnt(0) lgkmcnt(0)
s_barrier
v_mfma_f32_16x16x32_bf16 a[160:163], v[176:179], v[64:67], a[160:163]
v_exp_f32 v220, v60
v_mfma_f32_16x16x32_bf16 a[160:163], v[180:183], v[80:83], a[160:163]
v_exp_f32 v221, v61
v_mfma_f32_16x16x32_bf16 a[164:167], v[180:183], v[84:87], a[164:167]
v_cvt_pk_bf16_f32 v126, v220, v221
v_add_f32 v220, v220, v221
v_mfma_f32_16x16x32_bf16 a[164:167], v[176:179], v[68:71], a[164:167]
v_add_f32 v227, v227, v220
v_mfma_f32_16x16x32_bf16 a[168:171], v[176:179], v[72:75], a[168:171]
v_exp_f32 v222, v62
v_mfma_f32_16x16x32_bf16 a[168:171], v[180:183], v[88:91], a[168:171]
v_exp_f32 v223, v63
v_mfma_f32_16x16x32_bf16 a[172:175], v[180:183], v[92:95], a[172:175]
v_cvt_pk_bf16_f32 v127, v222, v223
v_add_f32 v222, v222, v223
v_mfma_f32_16x16x32_bf16 a[172:175], v[176:179], v[76:79], a[172:175]
v_add_f32 v227, v227, v222
v_mfma_f32_16x16x32_bf16 a[176:179], v[168:171], v[64:67], a[176:179]
v_max_f32 v247, v247, v227
v_mfma_f32_16x16x32_bf16 a[176:179], v[172:175], v[80:83], a[176:179]
v_cmp_lt_f32 vcc, s27, v247
v_mfma_f32_16x16x32_bf16 a[180:183], v[172:175], v[84:87], a[180:183]
v_mfma_f32_16x16x32_bf16 a[180:183], v[168:171], v[68:71], a[180:183]
v_mfma_f32_16x16x32_bf16 a[184:187], v[168:171], v[72:75], a[184:187]
v_mfma_f32_16x16x32_bf16 a[184:187], v[172:175], v[88:91], a[184:187]
v_mfma_f32_16x16x32_bf16 a[188:191], v[172:175], v[92:95], a[188:191]
v_mfma_f32_16x16x32_bf16 a[188:191], v[168:171], v[76:79], a[188:191]
s_cbranch_vccnz L_stub_H
L_back_H:
s_waitcnt lgkmcnt(0)
ds_read_b64_tr_b16 v[144:145], v236 offset:24576
ds_read_b64_tr_b16 v[146:147], v236 offset:30720
ds_read_b64_tr_b16 v[148:149], v236 offset:36864
ds_read_b64_tr_b16 v[150:151], v236 offset:43008
ds_read_b64_tr_b16 v[152:153], v237 offset:24576
ds_read_b64_tr_b16 v[154:155], v237 offset:30720
ds_read_b64_tr_b16 v[156:157], v237 offset:36864
ds_read_b64_tr_b16 v[158:159], v237 offset:43008
s_waitcnt lgkmcnt(0)
v_mfma_f32_16x16x32_bf16 a[0:3], v[144:147], v[96:99], a[0:3]
ds_read_b64_tr_b16 v[176:177], v238 offset:24576
ds_read_b64_tr_b16 v[178:179], v238 offset:30720
v_mfma_f32_16x16x32_bf16 a[0:3], v[148:151], v[112:115], a[0:3]
ds_read_b64_tr_b16 v[180:181], v238 offset:36864
ds_read_b64_tr_b16 v[182:183], v238 offset:43008
v_mfma_f32_16x16x32_bf16 a[4:7], v[148:151], v[116:119], a[4:7]
ds_read_b64_tr_b16 v[160:161], v239 offset:24576
ds_read_b64_tr_b16 v[162:163], v239 offset:30720
v_mfma_f32_16x16x32_bf16 a[4:7], v[144:147], v[100:103], a[4:7]
ds_read_b64_tr_b16 v[164:165], v239 offset:36864
ds_read_b64_tr_b16 v[166:167], v239 offset:43008
v_mfma_f32_16x16x32_bf16 a[16:19], v[152:155], v[96:99], a[16:19]
v_add_f32 v228, v228, v224
v_add_f32 v229, v229, v225
v_mfma_f32_16x16x32_bf16 a[16:19], v[156:159], v[112:115], a[16:19]
ds_read_b64_tr_b16 v[168:169], v236 offset:26624
ds_read_b64_tr_b16 v[170:171], v236 offset:32768
v_mfma_f32_16x16x32_bf16 a[20:23], v[156:159], v[116:119], a[20:23]
ds_read_b64_tr_b16 v[172:173], v236 offset:38912
ds_read_b64_tr_b16 v[174:175], v236 offset:45056
v_mfma_f32_16x16x32_bf16 a[20:23], v[152:155], v[100:103], a[20:23]
v_mbcnt_lo_u32_b32 v13, -1, 0
s_waitcnt lgkmcnt(8)
v_mfma_f32_16x16x32_bf16 a[32:35], v[176:179], v[96:99], a[32:35]
v_mov_b32 v248, v228
v_mov_b32 v249, v229
v_mfma_f32_16x16x32_bf16 a[32:35], v[180:183], v[112:115], a[32:35]
ds_read_b64_tr_b16 v[144:145], v237 offset:26624
ds_read_b64_tr_b16 v[146:147], v237 offset:32768
v_mfma_f32_16x16x32_bf16 a[36:39], v[180:183], v[116:119], a[36:39]
ds_read_b64_tr_b16 v[148:149], v237 offset:38912
ds_read_b64_tr_b16 v[150:151], v237 offset:45056
v_mfma_f32_16x16x32_bf16 a[36:39], v[176:179], v[100:103], a[36:39]
v_mbcnt_hi_u32_b32 v13, -1, v13
s_waitcnt lgkmcnt(8)
v_mfma_f32_16x16x32_bf16 a[48:51], v[160:163], v[96:99], a[48:51]
v_permlane16_swap_b32 v228, v248
v_permlane16_swap_b32 v229, v249
v_mfma_f32_16x16x32_bf16 a[48:51], v[164:167], v[112:115], a[48:51]
ds_read_b64_tr_b16 v[176:177], v238 offset:26624
ds_read_b64_tr_b16 v[178:179], v238 offset:32768
v_mfma_f32_16x16x32_bf16 a[52:55], v[164:167], v[116:119], a[52:55]
ds_read_b64_tr_b16 v[180:181], v238 offset:38912
ds_read_b64_tr_b16 v[182:183], v238 offset:45056
v_mfma_f32_16x16x32_bf16 a[52:55], v[160:163], v[100:103], a[52:55]
v_and_b32 v14, 15, v13
s_waitcnt lgkmcnt(8)
v_mfma_f32_16x16x32_bf16 a[64:67], v[168:171], v[96:99], a[64:67]
v_add_f32 v228, v228, v248
v_add_f32 v229, v229, v249
v_mfma_f32_16x16x32_bf16 a[64:67], v[172:175], v[112:115], a[64:67]
ds_read_b64_tr_b16 v[160:161], v239 offset:26624
ds_read_b64_tr_b16 v[162:163], v239 offset:32768
v_mfma_f32_16x16x32_bf16 a[68:71], v[172:175], v[116:119], a[68:71]
ds_read_b64_tr_b16 v[164:165], v239 offset:38912
ds_read_b64_tr_b16 v[166:167], v239 offset:45056
v_mfma_f32_16x16x32_bf16 a[68:71], v[168:171], v[100:103], a[68:71]
v_lshrrev_b32 v15, 4, v13
s_waitcnt lgkmcnt(8)
v_mfma_f32_16x16x32_bf16 a[80:83], v[144:147], v[96:99], a[80:83]
v_mov_b32 v248, v228
v_mov_b32 v249, v229
v_mfma_f32_16x16x32_bf16 a[80:83], v[148:151], v[112:115], a[80:83]
ds_read_b64_tr_b16 v[152:153], v236 offset:28672
ds_read_b64_tr_b16 v[154:155], v236 offset:34816
v_mfma_f32_16x16x32_bf16 a[84:87], v[148:151], v[116:119], a[84:87]
ds_read_b64_tr_b16 v[156:157], v236 offset:40960
ds_read_b64_tr_b16 v[158:159], v236 offset:47104
v_mfma_f32_16x16x32_bf16 a[84:87], v[144:147], v[100:103], a[84:87]
v_lshlrev_b32 v12, 4, v13
s_waitcnt lgkmcnt(8)
v_mfma_f32_16x16x32_bf16 a[96:99], v[176:179], v[96:99], a[96:99]
v_permlane32_swap_b32 v228, v248
v_permlane32_swap_b32 v229, v249
v_mfma_f32_16x16x32_bf16 a[96:99], v[180:183], v[112:115], a[96:99]
ds_read_b64_tr_b16 v[144:145], v237 offset:28672
ds_read_b64_tr_b16 v[146:147], v237 offset:34816
v_mfma_f32_16x16x32_bf16 a[100:103], v[180:183], v[116:119], a[100:103]
ds_read_b64_tr_b16 v[148:149], v237 offset:40960
ds_read_b64_tr_b16 v[150:151], v237 offset:47104
v_mfma_f32_16x16x32_bf16 a[100:103], v[176:179], v[100:103], a[100:103]
v_add_u32 v12, s24, v12
s_waitcnt lgkmcnt(8)
v_mfma_f32_16x16x32_bf16 a[112:115], v[160:163], v[96:99], a[112:115]
v_add_f32 v228, v228, v248
v_add_f32 v229, v229, v249
v_mfma_f32_16x16x32_bf16 a[112:115], v[164:167], v[112:115], a[112:115]
ds_read_b64_tr_b16 v[176:177], v238 offset:28672
ds_read_b64_tr_b16 v[178:179], v238 offset:34816
v_mfma_f32_16x16x32_bf16 a[116:119], v[164:167], v[116:119], a[116:119]
ds_read_b64_tr_b16 v[180:181], v238 offset:40960
ds_read_b64_tr_b16 v[182:183], v238 offset:47104
v_mfma_f32_16x16x32_bf16 a[116:119], v[160:163], v[100:103], a[116:119]
v_lshrrev_b32 v18, 1, v14
s_waitcnt lgkmcnt(8)
v_mfma_f32_16x16x32_bf16 a[128:131], v[152:155], v[96:99], a[128:131]
v_rcp_f32 v228, v228
v_mfma_f32_16x16x32_bf16 a[128:131], v[156:159], v[112:115], a[128:131]
ds_read_b64_tr_b16 v[168:169], v239 offset:28672
ds_read_b64_tr_b16 v[170:171], v239 offset:34816
v_mfma_f32_16x16x32_bf16 a[132:135], v[156:159], v[116:119], a[132:135]
ds_read_b64_tr_b16 v[172:173], v239 offset:40960
ds_read_b64_tr_b16 v[174:175], v239 offset:47104
v_mfma_f32_16x16x32_bf16 a[132:135], v[152:155], v[100:103], a[132:135]
v_lshlrev_b32 v16, 7, v14
s_waitcnt lgkmcnt(8)
v_mfma_f32_16x16x32_bf16 a[144:147], v[144:147], v[96:99], a[144:147]
v_rcp_f32 v229, v229
v_mfma_f32_16x16x32_bf16 a[144:147], v[148:151], v[112:115], a[144:147]
v_add_u32 v16, s24, v16
v_mfma_f32_16x16x32_bf16 a[148:151], v[148:151], v[116:119], a[148:151]
v_and_b32 v17, 1, v15
v_mfma_f32_16x16x32_bf16 a[148:151], v[144:147], v[100:103], a[148:151]
v_lshl_add_u32 v16, v17, 3, v16
s_waitcnt lgkmcnt(4)
v_mfma_f32_16x16x32_bf16 a[160:163], v[176:179], v[96:99], a[160:163]
v_lshrrev_b32 v15, 1, v15
v_mfma_f32_16x16x32_bf16 a[160:163], v[180:183], v[112:115], a[160:163]
v_add_u32 v17, 0, v15
v_mfma_f32_16x16x32_bf16 a[164:167], v[180:183], v[116:119], a[164:167]
v_xor_b32 v17, v17, v18
v_mfma_f32_16x16x32_bf16 a[164:167], v[176:179], v[100:103], a[164:167]
v_lshl_add_u32 v8, v17, 4, v16
s_waitcnt lgkmcnt(0)
v_mfma_f32_16x16x32_bf16 a[176:179], v[168:171], v[96:99], a[176:179]
v_add_u32 v17, 2, v15
v_mfma_f32_16x16x32_bf16 a[176:179], v[172:175], v[112:115], a[176:179]
v_xor_b32 v17, v17, v18
v_mfma_f32_16x16x32_bf16 a[180:183], v[172:175], v[116:119], a[180:183]
v_lshl_add_u32 v9, v17, 4, v16
v_mfma_f32_16x16x32_bf16 a[180:183], v[168:171], v[100:103], a[180:183]
v_add_u32 v17, 4, v15
s_nop 1
v_xor_b32 v17, v17, v18
s_nop 1
v_lshl_add_u32 v10, v17, 4, v16
s_nop 1
v_add_u32 v17, 6, v15
s_nop 1
v_xor_b32 v17, v17, v18
s_nop 1
v_lshl_add_u32 v11, v17, 4, v16
s_mul_i32 s29, s28, 18432
s_waitcnt vmcnt(0)
v_mov_b32 v60, v228
v_mov_b32 v61, v228
v_accvgpr_read_b32 v20, a0
v_accvgpr_read_b32 v21, a1
v_accvgpr_read_b32 v22, a2
v_accvgpr_read_b32 v23, a3
v_accvgpr_read_b32 v24, a16
v_accvgpr_read_b32 v25, a17
v_accvgpr_read_b32 v26, a18
v_accvgpr_read_b32 v27, a19
v_accvgpr_read_b32 v28, a32
v_accvgpr_read_b32 v29, a33
v_accvgpr_read_b32 v30, a34
v_accvgpr_read_b32 v31, a35
v_accvgpr_read_b32 v32, a48
v_accvgpr_read_b32 v33, a49
v_accvgpr_read_b32 v34, a50
v_accvgpr_read_b32 v35, a51
v_pk_mul_f32 v[20:21], v[20:21], v[60:61]
v_pk_mul_f32 v[22:23], v[22:23], v[60:61]
v_pk_mul_f32 v[24:25], v[24:25], v[60:61]
v_pk_mul_f32 v[26:27], v[26:27], v[60:61]
v_pk_mul_f32 v[28:29], v[28:29], v[60:61]
v_pk_mul_f32 v[30:31], v[30:31], v[60:61]
v_pk_mul_f32 v[32:33], v[32:33], v[60:61]
v_pk_mul_f32 v[34:35], v[34:35], v[60:61]
v_cvt_pk_bf16_f32 v36, v20, v21
v_cvt_pk_bf16_f32 v37, v22, v23
v_cvt_pk_bf16_f32 v38, v24, v25
v_cvt_pk_bf16_f32 v39, v26, v27
v_cvt_pk_bf16_f32 v40, v28, v29
v_cvt_pk_bf16_f32 v41, v30, v31
v_cvt_pk_bf16_f32 v42, v32, v33
v_cvt_pk_bf16_f32 v43, v34, v35
ds_write_b64 v8, v[36:37] offset:49152
ds_write_b64 v9, v[38:39] offset:49152
ds_write_b64 v10, v[40:41] offset:49152
ds_write_b64 v11, v[42:43] offset:49152
v_accvgpr_read_b32 v20, a64
v_accvgpr_read_b32 v21, a65
v_accvgpr_read_b32 v22, a66
v_accvgpr_read_b32 v23, a67
v_accvgpr_read_b32 v24, a80
v_accvgpr_read_b32 v25, a81
v_accvgpr_read_b32 v26, a82
v_accvgpr_read_b32 v27, a83
s_waitcnt lgkmcnt(0)
ds_read_b128 v[0:3], v12 offset:49152
ds_read_b128 v[4:7], v12 offset:50176
v_accvgpr_read_b32 v28, a96
v_accvgpr_read_b32 v29, a97
v_accvgpr_read_b32 v30, a98
v_accvgpr_read_b32 v31, a99
v_accvgpr_read_b32 v32, a112
v_accvgpr_read_b32 v33, a113
v_accvgpr_read_b32 v34, a114
v_accvgpr_read_b32 v35, a115
v_pk_mul_f32 v[20:21], v[20:21], v[60:61]
v_pk_mul_f32 v[22:23], v[22:23], v[60:61]
v_pk_mul_f32 v[24:25], v[24:25], v[60:61]
v_pk_mul_f32 v[26:27], v[26:27], v[60:61]
v_pk_mul_f32 v[28:29], v[28:29], v[60:61]
v_pk_mul_f32 v[30:31], v[30:31], v[60:61]
v_pk_mul_f32 v[32:33], v[32:33], v[60:61]
v_pk_mul_f32 v[34:35], v[34:35], v[60:61]
v_cvt_pk_bf16_f32 v36, v20, v21
v_cvt_pk_bf16_f32 v37, v22, v23
v_cvt_pk_bf16_f32 v38, v24, v25
v_cvt_pk_bf16_f32 v39, v26, v27
v_cvt_pk_bf16_f32 v40, v28, v29
v_cvt_pk_bf16_f32 v41, v30, v31
v_cvt_pk_bf16_f32 v42, v32, v33
v_cvt_pk_bf16_f32 v43, v34, v35
ds_write_b64 v8, v[36:37] offset:51200
ds_write_b64 v9, v[38:39] offset:51200
ds_write_b64 v10, v[40:41] offset:51200
ds_write_b64 v11, v[42:43] offset:51200
v_accvgpr_read_b32 v20, a128
v_accvgpr_read_b32 v21, a129
v_accvgpr_read_b32 v22, a130
v_accvgpr_read_b32 v23, a131
v_accvgpr_read_b32 v24, a144
v_accvgpr_read_b32 v25, a145
v_accvgpr_read_b32 v26, a146
v_accvgpr_read_b32 v27, a147
s_waitcnt lgkmcnt(0)
ds_read_b128 v[44:47], v12 offset:51200
ds_read_b128 v[48:51], v12 offset:52224
v_accvgpr_read_b32 v28, a160
v_accvgpr_read_b32 v29, a161
v_accvgpr_read_b32 v30, a162
v_accvgpr_read_b32 v31, a163
v_accvgpr_read_b32 v32, a176
v_accvgpr_read_b32 v33, a177
v_accvgpr_read_b32 v34, a178
v_accvgpr_read_b32 v35, a179
s_nop 0
s_add_u32 s32, s29, 0
buffer_store_dwordx4 v[0:3], v244, s[20:23], s32 offen sc0 sc1
buffer_store_dwordx4 v[4:7], v245, s[20:23], s32 offen sc0 sc1
v_pk_mul_f32 v[20:21], v[20:21], v[60:61]
v_pk_mul_f32 v[22:23], v[22:23], v[60:61]
v_pk_mul_f32 v[24:25], v[24:25], v[60:61]
v_pk_mul_f32 v[26:27], v[26:27], v[60:61]
v_pk_mul_f32 v[28:29], v[28:29], v[60:61]
v_pk_mul_f32 v[30:31], v[30:31], v[60:61]
v_pk_mul_f32 v[32:33], v[32:33], v[60:61]
v_pk_mul_f32 v[34:35], v[34:35], v[60:61]
v_cvt_pk_bf16_f32 v36, v20, v21
v_cvt_pk_bf16_f32 v37, v22, v23
v_cvt_pk_bf16_f32 v38, v24, v25
v_cvt_pk_bf16_f32 v39, v26, v27
v_cvt_pk_bf16_f32 v40, v28, v29
v_cvt_pk_bf16_f32 v41, v30, v31
v_cvt_pk_bf16_f32 v42, v32, v33
v_cvt_pk_bf16_f32 v43, v34, v35
ds_write_b64 v8, v[36:37] offset:53248
ds_write_b64 v9, v[38:39] offset:53248
ds_write_b64 v10, v[40:41] offset:53248
ds_write_b64 v11, v[42:43] offset:53248
v_mov_b32 v62, v229
v_mov_b32 v63, v229
v_accvgpr_read_b32 v20, a4
v_accvgpr_read_b32 v21, a5
v_accvgpr_read_b32 v22, a6
v_accvgpr_read_b32 v23, a7
v_accvgpr_read_b32 v24, a20
v_accvgpr_read_b32 v25, a21
v_accvgpr_read_b32 v26, a22
v_accvgpr_read_b32 v27, a23
s_waitcnt lgkmcnt(0)
ds_read_b128 v[52:55], v12 offset:53248
ds_read_b128 v[56:59], v12 offset:54272
v_accvgpr_read_b32 v28, a36
v_accvgpr_read_b32 v29, a37
v_accvgpr_read_b32 v30, a38
v_accvgpr_read_b32 v31, a39
v_accvgpr_read_b32 v32, a52
v_accvgpr_read_b32 v33, a53
v_accvgpr_read_b32 v34, a54
v_accvgpr_read_b32 v35, a55
s_nop 0
s_add_u32 s32, s29, 0
buffer_store_dwordx4 v[44:47], v244, s[20:23], s32 offen offset:128 sc0 sc1
buffer_store_dwordx4 v[48:51], v245, s[20:23], s32 offen offset:128 sc0 sc1
v_pk_mul_f32 v[20:21], v[20:21], v[62:63]
v_pk_mul_f32 v[22:23], v[22:23], v[62:63]
v_pk_mul_f32 v[24:25], v[24:25], v[62:63]
v_pk_mul_f32 v[26:27], v[26:27], v[62:63]
v_pk_mul_f32 v[28:29], v[28:29], v[62:63]
v_pk_mul_f32 v[30:31], v[30:31], v[62:63]
v_pk_mul_f32 v[32:33], v[32:33], v[62:63]
v_pk_mul_f32 v[34:35], v[34:35], v[62:63]
v_cvt_pk_bf16_f32 v36, v20, v21
v_cvt_pk_bf16_f32 v37, v22, v23
v_cvt_pk_bf16_f32 v38, v24, v25
v_cvt_pk_bf16_f32 v39, v26, v27
v_cvt_pk_bf16_f32 v40, v28, v29
v_cvt_pk_bf16_f32 v41, v30, v31
v_cvt_pk_bf16_f32 v42, v32, v33
v_cvt_pk_bf16_f32 v43, v34, v35
ds_write_b64 v8, v[36:37] offset:49152
ds_write_b64 v9, v[38:39] offset:49152
ds_write_b64 v10, v[40:41] offset:49152
ds_write_b64 v11, v[42:43] offset:49152
v_accvgpr_read_b32 v20, a68
v_accvgpr_read_b32 v21, a69
v_accvgpr_read_b32 v22, a70
v_accvgpr_read_b32 v23, a71
v_accvgpr_read_b32 v24, a84
v_accvgpr_read_b32 v25, a85
v_accvgpr_read_b32 v26, a86
v_accvgpr_read_b32 v27, a87
s_waitcnt lgkmcnt(0)
ds_read_b128 v[0:3], v12 offset:49152
ds_read_b128 v[4:7], v12 offset:50176
v_accvgpr_read_b32 v28, a100
v_accvgpr_read_b32 v29, a101
v_accvgpr_read_b32 v30, a102
v_accvgpr_read_b32 v31, a103
v_accvgpr_read_b32 v32, a116
v_accvgpr_read_b32 v33, a117
v_accvgpr_read_b32 v34, a118
v_accvgpr_read_b32 v35, a119
s_nop 0
s_add_u32 s32, s29, 0
buffer_store_dwordx4 v[52:55], v244, s[20:23], s32 offen offset:256 sc0 sc1
buffer_store_dwordx4 v[56:59], v245, s[20:23], s32 offen offset:256 sc0 sc1
v_pk_mul_f32 v[20:21], v[20:21], v[62:63]
v_pk_mul_f32 v[22:23], v[22:23], v[62:63]
v_pk_mul_f32 v[24:25], v[24:25], v[62:63]
v_pk_mul_f32 v[26:27], v[26:27], v[62:63]
v_pk_mul_f32 v[28:29], v[28:29], v[62:63]
v_pk_mul_f32 v[30:31], v[30:31], v[62:63]
v_pk_mul_f32 v[32:33], v[32:33], v[62:63]
v_pk_mul_f32 v[34:35], v[34:35], v[62:63]
v_cvt_pk_bf16_f32 v36, v20, v21
v_cvt_pk_bf16_f32 v37, v22, v23
v_cvt_pk_bf16_f32 v38, v24, v25
v_cvt_pk_bf16_f32 v39, v26, v27
v_cvt_pk_bf16_f32 v40, v28, v29
v_cvt_pk_bf16_f32 v41, v30, v31
v_cvt_pk_bf16_f32 v42, v32, v33
v_cvt_pk_bf16_f32 v43, v34, v35
ds_write_b64 v8, v[36:37] offset:51200
ds_write_b64 v9, v[38:39] offset:51200
ds_write_b64 v10, v[40:41] offset:51200
ds_write_b64 v11, v[42:43] offset:51200
v_accvgpr_read_b32 v20, a132
v_accvgpr_read_b32 v21, a133
v_accvgpr_read_b32 v22, a134
v_accvgpr_read_b32 v23, a135
v_accvgpr_read_b32 v24, a148
v_accvgpr_read_b32 v25, a149
v_accvgpr_read_b32 v26, a150
v_accvgpr_read_b32 v27, a151
s_waitcnt lgkmcnt(0)
ds_read_b128 v[44:47], v12 offset:51200
ds_read_b128 v[48:51], v12 offset:52224
v_accvgpr_read_b32 v28, a164
v_accvgpr_read_b32 v29, a165
v_accvgpr_read_b32 v30, a166
v_accvgpr_read_b32 v31, a167
v_accvgpr_read_b32 v32, a180
v_accvgpr_read_b32 v33, a181
v_accvgpr_read_b32 v34, a182
v_accvgpr_read_b32 v35, a183
s_nop 0
s_add_u32 s32, s29, 6144
buffer_store_dwordx4 v[0:3], v244, s[20:23], s32 offen sc0 sc1
buffer_store_dwordx4 v[4:7], v245, s[20:23], s32 offen sc0 sc1
v_pk_mul_f32 v[20:21], v[20:21], v[62:63]
v_pk_mul_f32 v[22:23], v[22:23], v[62:63]
v_pk_mul_f32 v[24:25], v[24:25], v[62:63]
v_pk_mul_f32 v[26:27], v[26:27], v[62:63]
v_pk_mul_f32 v[28:29], v[28:29], v[62:63]
v_pk_mul_f32 v[30:31], v[30:31], v[62:63]
v_pk_mul_f32 v[32:33], v[32:33], v[62:63]
v_pk_mul_f32 v[34:35], v[34:35], v[62:63]
v_cvt_pk_bf16_f32 v36, v20, v21
v_cvt_pk_bf16_f32 v37, v22, v23
v_cvt_pk_bf16_f32 v38, v24, v25
v_cvt_pk_bf16_f32 v39, v26, v27
v_cvt_pk_bf16_f32 v40, v28, v29
v_cvt_pk_bf16_f32 v41, v30, v31
v_cvt_pk_bf16_f32 v42, v32, v33
v_cvt_pk_bf16_f32 v43, v34, v35
ds_write_b64 v8, v[36:37] offset:53248
ds_write_b64 v9, v[38:39] offset:53248
ds_write_b64 v10, v[40:41] offset:53248
ds_write_b64 v11, v[42:43] offset:53248
s_waitcnt lgkmcnt(0)
ds_read_b128 v[52:55], v12 offset:53248
ds_read_b128 v[56:59], v12 offset:54272
s_nop 0
s_add_u32 s32, s29, 6144
buffer_store_dwordx4 v[44:47], v244, s[20:23], s32 offen offset:128 sc0 sc1
buffer_store_dwordx4 v[48:51], v245, s[20:23], s32 offen offset:128 sc0 sc1
s_waitcnt lgkmcnt(0)
s_add_u32 s32, s29, 6144
buffer_store_dwordx4 v[52:55], v244, s[20:23], s32 offen offset:256 sc0 sc1
buffer_store_dwordx4 v[56:59], v245, s[20:23], s32 offen offset:256 sc0 sc1
s_waitcnt lgkmcnt(0)
ds_read_b64_tr_b16 v[144:145], v236 offset:24576
ds_read_b64_tr_b16 v[146:147], v236 offset:30720
ds_read_b64_tr_b16 v[148:149], v236 offset:36864
ds_read_b64_tr_b16 v[150:151], v236 offset:43008
ds_read_b64_tr_b16 v[152:153], v237 offset:24576
ds_read_b64_tr_b16 v[154:155], v237 offset:30720
ds_read_b64_tr_b16 v[156:157], v237 offset:36864
ds_read_b64_tr_b16 v[158:159], v237 offset:43008
s_waitcnt lgkmcnt(0)
v_mfma_f32_16x16x32_bf16 a[8:11], v[144:147], v[104:107], a[8:11]
ds_read_b64_tr_b16 v[176:177], v238 offset:24576
ds_read_b64_tr_b16 v[178:179], v238 offset:30720
v_mfma_f32_16x16x32_bf16 a[8:11], v[148:151], v[120:123], a[8:11]
ds_read_b64_tr_b16 v[180:181], v238 offset:36864
ds_read_b64_tr_b16 v[182:183], v238 offset:43008
v_mfma_f32_16x16x32_bf16 a[12:15], v[148:151], v[124:127], a[12:15]
ds_read_b64_tr_b16 v[160:161], v239 offset:24576
ds_read_b64_tr_b16 v[162:163], v239 offset:30720
v_mfma_f32_16x16x32_bf16 a[12:15], v[144:147], v[108:111], a[12:15]
ds_read_b64_tr_b16 v[164:165], v239 offset:36864
ds_read_b64_tr_b16 v[166:167], v239 offset:43008
v_mfma_f32_16x16x32_bf16 a[24:27], v[152:155], v[104:107], a[24:27]
v_add_f32 v230, v230, v226
v_add_f32 v231, v231, v227
v_mfma_f32_16x16x32_bf16 a[24:27], v[156:159], v[120:123], a[24:27]
ds_read_b64_tr_b16 v[168:169], v236 offset:26624
ds_read_b64_tr_b16 v[170:171], v236 offset:32768
v_mfma_f32_16x16x32_bf16 a[28:31], v[156:159], v[124:127], a[28:31]
ds_read_b64_tr_b16 v[172:173], v236 offset:38912
ds_read_b64_tr_b16 v[174:175], v236 offset:45056
v_mfma_f32_16x16x32_bf16 a[28:31], v[152:155], v[108:111], a[28:31]
v_mov_b32 v250, v230
s_waitcnt lgkmcnt(8)
v_mfma_f32_16x16x32_bf16 a[40:43], v[176:179], v[104:107], a[40:43]
v_mov_b32 v251, v231
v_mfma_f32_16x16x32_bf16 a[40:43], v[180:183], v[120:123], a[40:43]
ds_read_b64_tr_b16 v[144:145], v237 offset:26624
ds_read_b64_tr_b16 v[146:147], v237 offset:32768
v_mfma_f32_16x16x32_bf16 a[44:47], v[180:183], v[124:127], a[44:47]
ds_read_b64_tr_b16 v[148:149], v237 offset:38912
ds_read_b64_tr_b16 v[150:151], v237 offset:45056
v_mfma_f32_16x16x32_bf16 a[44:47], v[176:179], v[108:111], a[44:47]
v_permlane16_swap_b32 v230, v250
s_waitcnt lgkmcnt(8)
v_mfma_f32_16x16x32_bf16 a[56:59], v[160:163], v[104:107], a[56:59]
v_permlane16_swap_b32 v231, v251
v_add_f32 v230, v230, v250
v_mfma_f32_16x16x32_bf16 a[56:59], v[164:167], v[120:123], a[56:59]
ds_read_b64_tr_b16 v[176:177], v238 offset:26624
ds_read_b64_tr_b16 v[178:179], v238 offset:32768
v_mfma_f32_16x16x32_bf16 a[60:63], v[164:167], v[124:127], a[60:63]
ds_read_b64_tr_b16 v[180:181], v238 offset:38912
ds_read_b64_tr_b16 v[182:183], v238 offset:45056
v_mfma_f32_16x16x32_bf16 a[60:63], v[160:163], v[108:111], a[60:63]
v_add_f32 v231, v231, v251
s_waitcnt lgkmcnt(8)
v_mfma_f32_16x16x32_bf16 a[72:75], v[168:171], v[104:107], a[72:75]
v_mov_b32 v250, v230
v_mov_b32 v251, v231
v_mfma_f32_16x16x32_bf16 a[72:75], v[172:175], v[120:123], a[72:75]
ds_read_b64_tr_b16 v[160:161], v239 offset:26624
ds_read_b64_tr_b16 v[162:163], v239 offset:32768
v_mfma_f32_16x16x32_bf16 a[76:79], v[172:175], v[124:127], a[76:79]
ds_read_b64_tr_b16 v[164:165], v239 offset:38912
ds_read_b64_tr_b16 v[166:167], v239 offset:45056
v_mfma_f32_16x16x32_bf16 a[76:79], v[168:171], v[108:111], a[76:79]
v_permlane32_swap_b32 v230, v250
s_waitcnt lgkmcnt(8)
v_mfma_f32_16x16x32_bf16 a[88:91], v[144:147], v[104:107], a[88:91]
v_permlane32_swap_b32 v231, v251
v_add_f32 v230, v230, v250
v_mfma_f32_16x16x32_bf16 a[88:91], v[148:151], v[120:123], a[88:91]
ds_read_b64_tr_b16 v[152:153], v236 offset:28672
ds_read_b64_tr_b16 v[154:155], v236 offset:34816
v_mfma_f32_16x16x32_bf16 a[92:95], v[148:151], v[124:127], a[92:95]
ds_read_b64_tr_b16 v[156:157], v236 offset:40960
ds_read_b64_tr_b16 v[158:159], v236 offset:47104
v_mfma_f32_16x16x32_bf16 a[92:95], v[144:147], v[108:111], a[92:95]
v_add_f32 v231, v231, v251
s_waitcnt lgkmcnt(8)
v_mfma_f32_16x16x32_bf16 a[104:107], v[176:179], v[104:107], a[104:107]
v_rcp_f32 v230, v230
v_mfma_f32_16x16x32_bf16 a[104:107], v[180:183], v[120:123], a[104:107]
ds_read_b64_tr_b16 v[144:145], v237 offset:28672
ds_read_b64_tr_b16 v[146:147], v237 offset:34816
v_mfma_f32_16x16x32_bf16 a[108:111], v[180:183], v[124:127], a[108:111]
ds_read_b64_tr_b16 v[148:149], v237 offset:40960
ds_read_b64_tr_b16 v[150:151], v237 offset:47104
v_mfma_f32_16x16x32_bf16 a[108:111], v[176:179], v[108:111], a[108:111]
s_waitcnt lgkmcnt(8)
v_mfma_f32_16x16x32_bf16 a[120:123], v[160:163], v[104:107], a[120:123]
v_rcp_f32 v231, v231
v_mfma_f32_16x16x32_bf16 a[120:123], v[164:167], v[120:123], a[120:123]
ds_read_b64_tr_b16 v[176:177], v238 offset:28672
ds_read_b64_tr_b16 v[178:179], v238 offset:34816
v_mfma_f32_16x16x32_bf16 a[124:127], v[164:167], v[124:127], a[124:127]
ds_read_b64_tr_b16 v[180:181], v238 offset:40960
ds_read_b64_tr_b16 v[182:183], v238 offset:47104
v_mfma_f32_16x16x32_bf16 a[124:127], v[160:163], v[108:111], a[124:127]
s_waitcnt lgkmcnt(8)
v_mfma_f32_16x16x32_bf16 a[136:139], v[152:155], v[104:107], a[136:139]
v_mfma_f32_16x16x32_bf16 a[136:139], v[156:159], v[120:123], a[136:139]
ds_read_b64_tr_b16 v[168:169], v239 offset:28672
ds_read_b64_tr_b16 v[170:171], v239 offset:34816
v_mfma_f32_16x16x32_bf16 a[140:143], v[156:159], v[124:127], a[140:143]
ds_read_b64_tr_b16 v[172:173], v239 offset:40960
ds_read_b64_tr_b16 v[174:175], v239 offset:47104
v_mfma_f32_16x16x32_bf16 a[140:143], v[152:155], v[108:111], a[140:143]
s_waitcnt lgkmcnt(8)
v_mfma_f32_16x16x32_bf16 a[152:155], v[144:147], v[104:107], a[152:155]
v_mfma_f32_16x16x32_bf16 a[152:155], v[148:151], v[120:123], a[152:155]
v_mfma_f32_16x16x32_bf16 a[156:159], v[148:151], v[124:127], a[156:159]
v_mfma_f32_16x16x32_bf16 a[156:159], v[144:147], v[108:111], a[156:159]
s_waitcnt lgkmcnt(4)
v_mfma_f32_16x16x32_bf16 a[168:171], v[176:179], v[104:107], a[168:171]
v_mfma_f32_16x16x32_bf16 a[168:171], v[180:183], v[120:123], a[168:171]
v_mfma_f32_16x16x32_bf16 a[172:175], v[180:183], v[124:127], a[172:175]
v_mfma_f32_16x16x32_bf16 a[172:175], v[176:179], v[108:111], a[172:175]
s_waitcnt lgkmcnt(0)
v_mfma_f32_16x16x32_bf16 a[184:187], v[168:171], v[104:107], a[184:187]
v_mfma_f32_16x16x32_bf16 a[184:187], v[172:175], v[120:123], a[184:187]
v_mfma_f32_16x16x32_bf16 a[188:191], v[172:175], v[124:127], a[188:191]
v_mfma_f32_16x16x32_bf16 a[188:191], v[168:171], v[108:111], a[188:191]
s_mul_i32 s29, s28, 18432
v_mov_b32 v60, v230
v_mov_b32 v61, v230
v_accvgpr_read_b32 v20, a8
v_accvgpr_read_b32 v21, a9
v_accvgpr_read_b32 v22, a10
v_accvgpr_read_b32 v23, a11
v_accvgpr_read_b32 v24, a24
v_accvgpr_read_b32 v25, a25
v_accvgpr_read_b32 v26, a26
v_accvgpr_read_b32 v27, a27
v_accvgpr_read_b32 v28, a40
v_accvgpr_read_b32 v29, a41
v_accvgpr_read_b32 v30, a42
v_accvgpr_read_b32 v31, a43
v_accvgpr_read_b32 v32, a56
v_accvgpr_read_b32 v33, a57
v_accvgpr_read_b32 v34, a58
v_accvgpr_read_b32 v35, a59
v_pk_mul_f32 v[20:21], v[20:21], v[60:61]
v_pk_mul_f32 v[22:23], v[22:23], v[60:61]
v_pk_mul_f32 v[24:25], v[24:25], v[60:61]
v_pk_mul_f32 v[26:27], v[26:27], v[60:61]
v_pk_mul_f32 v[28:29], v[28:29], v[60:61]
v_pk_mul_f32 v[30:31], v[30:31], v[60:61]
v_pk_mul_f32 v[32:33], v[32:33], v[60:61]
v_pk_mul_f32 v[34:35], v[34:35], v[60:61]
v_cvt_pk_bf16_f32 v36, v20, v21
v_cvt_pk_bf16_f32 v37, v22, v23
v_cvt_pk_bf16_f32 v38, v24, v25
v_cvt_pk_bf16_f32 v39, v26, v27
v_cvt_pk_bf16_f32 v40, v28, v29
v_cvt_pk_bf16_f32 v41, v30, v31
v_cvt_pk_bf16_f32 v42, v32, v33
v_cvt_pk_bf16_f32 v43, v34, v35
ds_write_b64 v8, v[36:37] offset:49152
ds_write_b64 v9, v[38:39] offset:49152
ds_write_b64 v10, v[40:41] offset:49152
ds_write_b64 v11, v[42:43] offset:49152
v_accvgpr_read_b32 v20, a72
v_accvgpr_read_b32 v21, a73
v_accvgpr_read_b32 v22, a74
v_accvgpr_read_b32 v23, a75
v_accvgpr_read_b32 v24, a88
v_accvgpr_read_b32 v25, a89
v_accvgpr_read_b32 v26, a90
v_accvgpr_read_b32 v27, a91
s_waitcnt lgkmcnt(0)
ds_read_b128 v[0:3], v12 offset:49152
ds_read_b128 v[4:7], v12 offset:50176
v_accvgpr_read_b32 v28, a104
v_accvgpr_read_b32 v29, a105
v_accvgpr_read_b32 v30, a106
v_accvgpr_read_b32 v31, a107
v_accvgpr_read_b32 v32, a120
v_accvgpr_read_b32 v33, a121
v_accvgpr_read_b32 v34, a122
v_accvgpr_read_b32 v35, a123
v_pk_mul_f32 v[20:21], v[20:21], v[60:61]
v_pk_mul_f32 v[22:23], v[22:23], v[60:61]
v_pk_mul_f32 v[24:25], v[24:25], v[60:61]
v_pk_mul_f32 v[26:27], v[26:27], v[60:61]
v_pk_mul_f32 v[28:29], v[28:29], v[60:61]
v_pk_mul_f32 v[30:31], v[30:31], v[60:61]
v_pk_mul_f32 v[32:33], v[32:33], v[60:61]
v_pk_mul_f32 v[34:35], v[34:35], v[60:61]
v_cvt_pk_bf16_f32 v36, v20, v21
v_cvt_pk_bf16_f32 v37, v22, v23
v_cvt_pk_bf16_f32 v38, v24, v25
v_cvt_pk_bf16_f32 v39, v26, v27
v_cvt_pk_bf16_f32 v40, v28, v29
v_cvt_pk_bf16_f32 v41, v30, v31
v_cvt_pk_bf16_f32 v42, v32, v33
v_cvt_pk_bf16_f32 v43, v34, v35
ds_write_b64 v8, v[36:37] offset:51200
ds_write_b64 v9, v[38:39] offset:51200
ds_write_b64 v10, v[40:41] offset:51200
ds_write_b64 v11, v[42:43] offset:51200
v_accvgpr_read_b32 v20, a136
v_accvgpr_read_b32 v21, a137
v_accvgpr_read_b32 v22, a138
v_accvgpr_read_b32 v23, a139
v_accvgpr_read_b32 v24, a152
v_accvgpr_read_b32 v25, a153
v_accvgpr_read_b32 v26, a154
v_accvgpr_read_b32 v27, a155
s_waitcnt lgkmcnt(0)
ds_read_b128 v[44:47], v12 offset:51200
ds_read_b128 v[48:51], v12 offset:52224
v_accvgpr_read_b32 v28, a168
v_accvgpr_read_b32 v29, a169
v_accvgpr_read_b32 v30, a170
v_accvgpr_read_b32 v31, a171
v_accvgpr_read_b32 v32, a184
v_accvgpr_read_b32 v33, a185
v_accvgpr_read_b32 v34, a186
v_accvgpr_read_b32 v35, a187
s_nop 0
s_add_u32 s32, s29, 12288
buffer_store_dwordx4 v[0:3], v244, s[20:23], s32 offen sc0 sc1
buffer_store_dwordx4 v[4:7], v245, s[20:23], s32 offen sc0 sc1
v_pk_mul_f32 v[20:21], v[20:21], v[60:61]
v_pk_mul_f32 v[22:23], v[22:23], v[60:61]
v_pk_mul_f32 v[24:25], v[24:25], v[60:61]
v_pk_mul_f32 v[26:27], v[26:27], v[60:61]
v_pk_mul_f32 v[28:29], v[28:29], v[60:61]
v_pk_mul_f32 v[30:31], v[30:31], v[60:61]
v_pk_mul_f32 v[32:33], v[32:33], v[60:61]
v_pk_mul_f32 v[34:35], v[34:35], v[60:61]
v_cvt_pk_bf16_f32 v36, v20, v21
v_cvt_pk_bf16_f32 v37, v22, v23
v_cvt_pk_bf16_f32 v38, v24, v25
v_cvt_pk_bf16_f32 v39, v26, v27
v_cvt_pk_bf16_f32 v40, v28, v29
v_cvt_pk_bf16_f32 v41, v30, v31
v_cvt_pk_bf16_f32 v42, v32, v33
v_cvt_pk_bf16_f32 v43, v34, v35
ds_write_b64 v8, v[36:37] offset:53248
ds_write_b64 v9, v[38:39] offset:53248
ds_write_b64 v10, v[40:41] offset:53248
ds_write_b64 v11, v[42:43] offset:53248
v_mov_b32 v62, v231
v_mov_b32 v63, v231
v_accvgpr_read_b32 v20, a12
v_accvgpr_read_b32 v21, a13
v_accvgpr_read_b32 v22, a14
v_accvgpr_read_b32 v23, a15
v_accvgpr_read_b32 v24, a28
v_accvgpr_read_b32 v25, a29
v_accvgpr_read_b32 v26, a30
v_accvgpr_read_b32 v27, a31
s_waitcnt lgkmcnt(0)
ds_read_b128 v[52:55], v12 offset:53248
ds_read_b128 v[56:59], v12 offset:54272
v_accvgpr_read_b32 v28, a44
v_accvgpr_read_b32 v29, a45
v_accvgpr_read_b32 v30, a46
v_accvgpr_read_b32 v31, a47
v_accvgpr_read_b32 v32, a60
v_accvgpr_read_b32 v33, a61
v_accvgpr_read_b32 v34, a62
v_accvgpr_read_b32 v35, a63
s_nop 0
s_add_u32 s32, s29, 12288
buffer_store_dwordx4 v[44:47], v244, s[20:23], s32 offen offset:128 sc0 sc1
buffer_store_dwordx4 v[48:51], v245, s[20:23], s32 offen offset:128 sc0 sc1
v_pk_mul_f32 v[20:21], v[20:21], v[62:63]
v_pk_mul_f32 v[22:23], v[22:23], v[62:63]
v_pk_mul_f32 v[24:25], v[24:25], v[62:63]
v_pk_mul_f32 v[26:27], v[26:27], v[62:63]
v_pk_mul_f32 v[28:29], v[28:29], v[62:63]
v_pk_mul_f32 v[30:31], v[30:31], v[62:63]
v_pk_mul_f32 v[32:33], v[32:33], v[62:63]
v_pk_mul_f32 v[34:35], v[34:35], v[62:63]
v_cvt_pk_bf16_f32 v36, v20, v21
v_cvt_pk_bf16_f32 v37, v22, v23
v_cvt_pk_bf16_f32 v38, v24, v25
v_cvt_pk_bf16_f32 v39, v26, v27
v_cvt_pk_bf16_f32 v40, v28, v29
v_cvt_pk_bf16_f32 v41, v30, v31
v_cvt_pk_bf16_f32 v42, v32, v33
v_cvt_pk_bf16_f32 v43, v34, v35
ds_write_b64 v8, v[36:37] offset:49152
ds_write_b64 v9, v[38:39] offset:49152
ds_write_b64 v10, v[40:41] offset:49152
ds_write_b64 v11, v[42:43] offset:49152
v_accvgpr_read_b32 v20, a76
v_accvgpr_read_b32 v21, a77
v_accvgpr_read_b32 v22, a78
v_accvgpr_read_b32 v23, a79
v_accvgpr_read_b32 v24, a92
v_accvgpr_read_b32 v25, a93
v_accvgpr_read_b32 v26, a94
v_accvgpr_read_b32 v27, a95
s_waitcnt lgkmcnt(0)
ds_read_b128 v[0:3], v12 offset:49152
ds_read_b128 v[4:7], v12 offset:50176
v_accvgpr_read_b32 v28, a108
v_accvgpr_read_b32 v29, a109
v_accvgpr_read_b32 v30, a110
v_accvgpr_read_b32 v31, a111
v_accvgpr_read_b32 v32, a124
v_accvgpr_read_b32 v33, a125
v_accvgpr_read_b32 v34, a126
v_accvgpr_read_b32 v35, a127
s_nop 0
s_add_u32 s32, s29, 12288
buffer_store_dwordx4 v[52:55], v244, s[20:23], s32 offen offset:256 sc0 sc1
buffer_store_dwordx4 v[56:59], v245, s[20:23], s32 offen offset:256 sc0 sc1
v_pk_mul_f32 v[20:21], v[20:21], v[62:63]
v_pk_mul_f32 v[22:23], v[22:23], v[62:63]
v_pk_mul_f32 v[24:25], v[24:25], v[62:63]
v_pk_mul_f32 v[26:27], v[26:27], v[62:63]
v_pk_mul_f32 v[28:29], v[28:29], v[62:63]
v_pk_mul_f32 v[30:31], v[30:31], v[62:63]
v_pk_mul_f32 v[32:33], v[32:33], v[62:63]
v_pk_mul_f32 v[34:35], v[34:35], v[62:63]
v_cvt_pk_bf16_f32 v36, v20, v21
v_cvt_pk_bf16_f32 v37, v22, v23
v_cvt_pk_bf16_f32 v38, v24, v25
v_cvt_pk_bf16_f32 v39, v26, v27
v_cvt_pk_bf16_f32 v40, v28, v29
v_cvt_pk_bf16_f32 v41, v30, v31
v_cvt_pk_bf16_f32 v42, v32, v33
v_cvt_pk_bf16_f32 v43, v34, v35
ds_write_b64 v8, v[36:37] offset:51200
ds_write_b64 v9, v[38:39] offset:51200
ds_write_b64 v10, v[40:41] offset:51200
ds_write_b64 v11, v[42:43] offset:51200
v_accvgpr_read_b32 v20, a140
v_accvgpr_read_b32 v21, a141
v_accvgpr_read_b32 v22, a142
v_accvgpr_read_b32 v23, a143
v_accvgpr_read_b32 v24, a156
v_accvgpr_read_b32 v25, a157
v_accvgpr_read_b32 v26, a158
v_accvgpr_read_b32 v27, a159
s_waitcnt lgkmcnt(0)
ds_read_b128 v[44:47], v12 offset:51200
ds_read_b128 v[48:51], v12 offset:52224
v_accvgpr_read_b32 v28, a172
v_accvgpr_read_b32 v29, a173
v_accvgpr_read_b32 v30, a174
v_accvgpr_read_b32 v31, a175
v_accvgpr_read_b32 v32, a188
v_accvgpr_read_b32 v33, a189
v_accvgpr_read_b32 v34, a190
v_accvgpr_read_b32 v35, a191
s_nop 0
s_add_u32 s32, s29, 18432
buffer_store_dwordx4 v[0:3], v244, s[20:23], s32 offen sc0 sc1
buffer_store_dwordx4 v[4:7], v245, s[20:23], s32 offen sc0 sc1
v_pk_mul_f32 v[20:21], v[20:21], v[62:63]
v_pk_mul_f32 v[22:23], v[22:23], v[62:63]
v_pk_mul_f32 v[24:25], v[24:25], v[62:63]
v_pk_mul_f32 v[26:27], v[26:27], v[62:63]
v_pk_mul_f32 v[28:29], v[28:29], v[62:63]
v_pk_mul_f32 v[30:31], v[30:31], v[62:63]
v_pk_mul_f32 v[32:33], v[32:33], v[62:63]
v_pk_mul_f32 v[34:35], v[34:35], v[62:63]
v_cvt_pk_bf16_f32 v36, v20, v21
v_cvt_pk_bf16_f32 v37, v22, v23
v_cvt_pk_bf16_f32 v38, v24, v25
v_cvt_pk_bf16_f32 v39, v26, v27
v_cvt_pk_bf16_f32 v40, v28, v29
v_cvt_pk_bf16_f32 v41, v30, v31
v_cvt_pk_bf16_f32 v42, v32, v33
v_cvt_pk_bf16_f32 v43, v34, v35
ds_write_b64 v8, v[36:37] offset:53248
ds_write_b64 v9, v[38:39] offset:53248
ds_write_b64 v10, v[40:41] offset:53248
ds_write_b64 v11, v[42:43] offset:53248
s_waitcnt lgkmcnt(0)
ds_read_b128 v[52:55], v12 offset:53248
ds_read_b128 v[56:59], v12 offset:54272
s_nop 0
s_add_u32 s32, s29, 18432
buffer_store_dwordx4 v[44:47], v244, s[20:23], s32 offen offset:128 sc0 sc1
buffer_store_dwordx4 v[48:51], v245, s[20:23], s32 offen offset:128 sc0 sc1
s_waitcnt lgkmcnt(0)
s_add_u32 s32, s29, 18432
buffer_store_dwordx4 v[52:55], v244, s[20:23], s32 offen offset:256 sc0 sc1
buffer_store_dwordx4 v[56:59], v245, s[20:23], s32 offen offset:256 sc0 sc1
L_end:
s_endpgm
L_stub_0:
s_call_b64 s[30:31], L_slow_1_0123
s_branch L_back_0
L_stub_1:
s_call_b64 s[30:31], L_slow_0_0123
s_branch L_back_1
L_stub_2:
s_call_b64 s[30:31], L_slow_1_0123
s_branch L_back_2
L_stub_3:
s_call_b64 s[30:31], L_slow_0_0123
s_branch L_back_3
L_stub_4:
s_call_b64 s[30:31], L_slow_1_0123
s_branch L_back_4
L_stub_5:
s_call_b64 s[30:31], L_slow_0_0123
s_cmp_lg_u32 s26, 0
s_branch L_back_5
L_stub_H:
s_call_b64 s[30:31], L_slow_1_0123
s_branch L_back_H
L_slow_1_0123:
s_nop 7
s_nop 7
v_max3_f32 v64, v0, v1, v2
v_max3_f32 v64, v64, v3, v16
v_max3_f32 v64, v64, v17, v18
v_max3_f32 v64, v64, v19, v32
v_max3_f32 v64, v64, v33, v34
v_max3_f32 v64, v64, v35, v48
v_max3_f32 v64, v64, v49, v50
v_max_f32 v64, v64, v51
v_mov_b32 v216, v64
s_nop 1
v_permlane16_swap_b32 v64, v216
v_max_f32 v64, v64, v216
v_mov_b32 v216, v64
s_nop 1
v_permlane32_swap_b32 v64, v216
v_max_f32 v64, v64, v216
v_ceil_f32 v64, v64
v_max_f32 v64, 0, v64
v_exp_f32_e64 v65, -v64
v_max3_f32 v68, v4, v5, v6
v_max3_f32 v68, v68, v7, v20
v_max3_f32 v68, v68, v21, v22
v_max3_f32 v68, v68, v23, v36
v_max3_f32 v68, v68, v37, v38
v_max3_f32 v68, v68, v39, v52
v_max3_f32 v68, v68, v53, v54
v_max_f32 v68, v68, v55
v_mov_b32 v216, v68
s_nop 1
v_permlane16_swap_b32 v68, v216
v_max_f32 v68, v68, v216
v_mov_b32 v216, v68
s_nop 1
v_permlane32_swap_b32 v68, v216
v_max_f32 v68, v68, v216
v_ceil_f32 v68, v68
v_max_f32 v68, 0, v68
v_exp_f32_e64 v69, -v68
v_max3_f32 v72, v8, v9, v10
v_max3_f32 v72, v72, v11, v24
v_max3_f32 v72, v72, v25, v26
v_max3_f32 v72, v72, v27, v40
v_max3_f32 v72, v72, v41, v42
v_max3_f32 v72, v72, v43, v56
v_max3_f32 v72, v72, v57, v58
v_max_f32 v72, v72, v59
v_mov_b32 v216, v72
s_nop 1
v_permlane16_swap_b32 v72, v216
v_max_f32 v72, v72, v216
v_mov_b32 v216, v72
s_nop 1
v_permlane32_swap_b32 v72, v216
v_max_f32 v72, v72, v216
v_ceil_f32 v72, v72
v_max_f32 v72, 0, v72
v_exp_f32_e64 v73, -v72
v_max3_f32 v76, v12, v13, v14
v_max3_f32 v76, v76, v15, v28
v_max3_f32 v76, v76, v29, v30
v_max3_f32 v76, v76, v31, v44
v_max3_f32 v76, v76, v45, v46
v_max3_f32 v76, v76, v47, v60
v_max3_f32 v76, v76, v61, v62
v_max_f32 v76, v76, v63
v_mov_b32 v216, v76
s_nop 1
v_permlane16_swap_b32 v76, v216
v_max_f32 v76, v76, v216
v_mov_b32 v216, v76
s_nop 1
v_permlane32_swap_b32 v76, v216
v_max_f32 v76, v76, v216
v_ceil_f32 v76, v76
v_max_f32 v76, 0, v76
v_exp_f32_e64 v77, -v76
s_nop 0
v_mul_f32 v228, v228, v65
v_sub_f32 v128, v128, v64
v_sub_f32 v129, v129, v64
v_sub_f32 v130, v130, v64
v_sub_f32 v131, v131, v64
v_sub_f32 v0, v0, v64
v_sub_f32 v1, v1, v64
v_sub_f32 v2, v2, v64
v_sub_f32 v3, v3, v64
v_sub_f32 v16, v16, v64
v_sub_f32 v17, v17, v64
v_sub_f32 v18, v18, v64
v_sub_f32 v19, v19, v64
v_sub_f32 v32, v32, v64
v_sub_f32 v33, v33, v64
v_sub_f32 v34, v34, v64
v_sub_f32 v35, v35, v64
v_sub_f32 v48, v48, v64
v_sub_f32 v49, v49, v64
v_sub_f32 v50, v50, v64
v_sub_f32 v51, v51, v64
v_mul_f32 v229, v229, v69
v_sub_f32 v132, v132, v68
v_sub_f32 v133, v133, v68
v_sub_f32 v134, v134, v68
v_sub_f32 v135, v135, v68
v_sub_f32 v4, v4, v68
v_sub_f32 v5, v5, v68
v_sub_f32 v6, v6, v68
v_sub_f32 v7, v7, v68
v_sub_f32 v20, v20, v68
v_sub_f32 v21, v21, v68
v_sub_f32 v22, v22, v68
v_sub_f32 v23, v23, v68
v_sub_f32 v36, v36, v68
v_sub_f32 v37, v37, v68
v_sub_f32 v38, v38, v68
v_sub_f32 v39, v39, v68
v_sub_f32 v52, v52, v68
v_sub_f32 v53, v53, v68
v_sub_f32 v54, v54, v68
v_sub_f32 v55, v55, v68
v_mul_f32 v230, v230, v73
v_sub_f32 v136, v136, v72
v_sub_f32 v137, v137, v72
v_sub_f32 v138, v138, v72
v_sub_f32 v139, v139, v72
v_sub_f32 v8, v8, v72
v_sub_f32 v9, v9, v72
v_sub_f32 v10, v10, v72
v_sub_f32 v11, v11, v72
v_sub_f32 v24, v24, v72
v_sub_f32 v25, v25, v72
v_sub_f32 v26, v26, v72
v_sub_f32 v27, v27, v72
v_sub_f32 v40, v40, v72
v_sub_f32 v41, v41, v72
v_sub_f32 v42, v42, v72
v_sub_f32 v43, v43, v72
v_sub_f32 v56, v56, v72
v_sub_f32 v57, v57, v72
v_sub_f32 v58, v58, v72
v_sub_f32 v59, v59, v72
v_mul_f32 v231, v231, v77
v_sub_f32 v140, v140, v76
v_sub_f32 v141, v141, v76
v_sub_f32 v142, v142, v76
v_sub_f32 v143, v143, v76
v_sub_f32 v12, v12, v76
v_sub_f32 v13, v13, v76
v_sub_f32 v14, v14, v76
v_sub_f32 v15, v15, v76
v_sub_f32 v28, v28, v76
v_sub_f32 v29, v29, v76
v_sub_f32 v30, v30, v76
v_sub_f32 v31, v31, v76
v_sub_f32 v44, v44, v76
v_sub_f32 v45, v45, v76
v_sub_f32 v46, v46, v76
v_sub_f32 v47, v47, v76
v_sub_f32 v60, v60, v76
v_sub_f32 v61, v61, v76
v_sub_f32 v62, v62, v76
v_sub_f32 v63, v63, v76
v_accvgpr_read_b32 v216, a0
v_accvgpr_read_b32 v217, a1
v_accvgpr_read_b32 v218, a2
v_accvgpr_read_b32 v219, a3
v_mul_f32 v216, v216, v65
v_mul_f32 v217, v217, v65
v_mul_f32 v218, v218, v65
v_mul_f32 v219, v219, v65
v_accvgpr_write_b32 a0, v216
v_accvgpr_write_b32 a1, v217
v_accvgpr_write_b32 a2, v218
v_accvgpr_write_b32 a3, v219
v_accvgpr_read_b32 v220, a4
v_accvgpr_read_b32 v221, a5
v_accvgpr_read_b32 v222, a6
v_accvgpr_read_b32 v223, a7
v_mul_f32 v220, v220, v69
v_mul_f32 v221, v221, v69
v_mul_f32 v222, v222, v69
v_mul_f32 v223, v223, v69
v_accvgpr_write_b32 a4, v220
v_accvgpr_write_b32 a5, v221
v_accvgpr_write_b32 a6, v222
v_accvgpr_write_b32 a7, v223
v_accvgpr_read_b32 v216, a8
v_accvgpr_read_b32 v217, a9
v_accvgpr_read_b32 v218, a10
v_accvgpr_read_b32 v219, a11
v_mul_f32 v216, v216, v73
v_mul_f32 v217, v217, v73
v_mul_f32 v218, v218, v73
v_mul_f32 v219, v219, v73
v_accvgpr_write_b32 a8, v216
v_accvgpr_write_b32 a9, v217
v_accvgpr_write_b32 a10, v218
v_accvgpr_write_b32 a11, v219
v_accvgpr_read_b32 v220, a12
v_accvgpr_read_b32 v221, a13
v_accvgpr_read_b32 v222, a14
v_accvgpr_read_b32 v223, a15
v_mul_f32 v220, v220, v77
v_mul_f32 v221, v221, v77
v_mul_f32 v222, v222, v77
v_mul_f32 v223, v223, v77
v_accvgpr_write_b32 a12, v220
v_accvgpr_write_b32 a13, v221
v_accvgpr_write_b32 a14, v222
v_accvgpr_write_b32 a15, v223
v_accvgpr_read_b32 v216, a16
v_accvgpr_read_b32 v217, a17
v_accvgpr_read_b32 v218, a18
v_accvgpr_read_b32 v219, a19
v_mul_f32 v216, v216, v65
v_mul_f32 v217, v217, v65
v_mul_f32 v218, v218, v65
v_mul_f32 v219, v219, v65
v_accvgpr_write_b32 a16, v216
v_accvgpr_write_b32 a17, v217
v_accvgpr_write_b32 a18, v218
v_accvgpr_write_b32 a19, v219
v_accvgpr_read_b32 v220, a20
v_accvgpr_read_b32 v221, a21
v_accvgpr_read_b32 v222, a22
v_accvgpr_read_b32 v223, a23
v_mul_f32 v220, v220, v69
v_mul_f32 v221, v221, v69
v_mul_f32 v222, v222, v69
v_mul_f32 v223, v223, v69
v_accvgpr_write_b32 a20, v220
v_accvgpr_write_b32 a21, v221
v_accvgpr_write_b32 a22, v222
v_accvgpr_write_b32 a23, v223
v_accvgpr_read_b32 v216, a24
v_accvgpr_read_b32 v217, a25
v_accvgpr_read_b32 v218, a26
v_accvgpr_read_b32 v219, a27
v_mul_f32 v216, v216, v73
v_mul_f32 v217, v217, v73
v_mul_f32 v218, v218, v73
v_mul_f32 v219, v219, v73
v_accvgpr_write_b32 a24, v216
v_accvgpr_write_b32 a25, v217
v_accvgpr_write_b32 a26, v218
v_accvgpr_write_b32 a27, v219
v_accvgpr_read_b32 v220, a28
v_accvgpr_read_b32 v221, a29
v_accvgpr_read_b32 v222, a30
v_accvgpr_read_b32 v223, a31
v_mul_f32 v220, v220, v77
v_mul_f32 v221, v221, v77
v_mul_f32 v222, v222, v77
v_mul_f32 v223, v223, v77
v_accvgpr_write_b32 a28, v220
v_accvgpr_write_b32 a29, v221
v_accvgpr_write_b32 a30, v222
v_accvgpr_write_b32 a31, v223
v_accvgpr_read_b32 v216, a32
v_accvgpr_read_b32 v217, a33
v_accvgpr_read_b32 v218, a34
v_accvgpr_read_b32 v219, a35
v_mul_f32 v216, v216, v65
v_mul_f32 v217, v217, v65
v_mul_f32 v218, v218, v65
v_mul_f32 v219, v219, v65
v_accvgpr_write_b32 a32, v216
v_accvgpr_write_b32 a33, v217
v_accvgpr_write_b32 a34, v218
v_accvgpr_write_b32 a35, v219
v_accvgpr_read_b32 v220, a36
v_accvgpr_read_b32 v221, a37
v_accvgpr_read_b32 v222, a38
v_accvgpr_read_b32 v223, a39
v_mul_f32 v220, v220, v69
v_mul_f32 v221, v221, v69
v_mul_f32 v222, v222, v69
v_mul_f32 v223, v223, v69
v_accvgpr_write_b32 a36, v220
v_accvgpr_write_b32 a37, v221
v_accvgpr_write_b32 a38, v222
v_accvgpr_write_b32 a39, v223
v_accvgpr_read_b32 v216, a40
v_accvgpr_read_b32 v217, a41
v_accvgpr_read_b32 v218, a42
v_accvgpr_read_b32 v219, a43
v_mul_f32 v216, v216, v73
v_mul_f32 v217, v217, v73
v_mul_f32 v218, v218, v73
v_mul_f32 v219, v219, v73
v_accvgpr_write_b32 a40, v216
v_accvgpr_write_b32 a41, v217
v_accvgpr_write_b32 a42, v218
v_accvgpr_write_b32 a43, v219
v_accvgpr_read_b32 v220, a44
v_accvgpr_read_b32 v221, a45
v_accvgpr_read_b32 v222, a46
v_accvgpr_read_b32 v223, a47
v_mul_f32 v220, v220, v77
v_mul_f32 v221, v221, v77
v_mul_f32 v222, v222, v77
v_mul_f32 v223, v223, v77
v_accvgpr_write_b32 a44, v220
v_accvgpr_write_b32 a45, v221
v_accvgpr_write_b32 a46, v222
v_accvgpr_write_b32 a47, v223
v_accvgpr_read_b32 v216, a48
v_accvgpr_read_b32 v217, a49
v_accvgpr_read_b32 v218, a50
v_accvgpr_read_b32 v219, a51
v_mul_f32 v216, v216, v65
v_mul_f32 v217, v217, v65
v_mul_f32 v218, v218, v65
v_mul_f32 v219, v219, v65
v_accvgpr_write_b32 a48, v216
v_accvgpr_write_b32 a49, v217
v_accvgpr_write_b32 a50, v218
v_accvgpr_write_b32 a51, v219
v_accvgpr_read_b32 v220, a52
v_accvgpr_read_b32 v221, a53
v_accvgpr_read_b32 v222, a54
v_accvgpr_read_b32 v223, a55
v_mul_f32 v220, v220, v69
v_mul_f32 v221, v221, v69
v_mul_f32 v222, v222, v69
v_mul_f32 v223, v223, v69
v_accvgpr_write_b32 a52, v220
v_accvgpr_write_b32 a53, v221
v_accvgpr_write_b32 a54, v222
v_accvgpr_write_b32 a55, v223
v_accvgpr_read_b32 v216, a56
v_accvgpr_read_b32 v217, a57
v_accvgpr_read_b32 v218, a58
v_accvgpr_read_b32 v219, a59
v_mul_f32 v216, v216, v73
v_mul_f32 v217, v217, v73
v_mul_f32 v218, v218, v73
v_mul_f32 v219, v219, v73
v_accvgpr_write_b32 a56, v216
v_accvgpr_write_b32 a57, v217
v_accvgpr_write_b32 a58, v218
v_accvgpr_write_b32 a59, v219
v_accvgpr_read_b32 v220, a60
v_accvgpr_read_b32 v221, a61
v_accvgpr_read_b32 v222, a62
v_accvgpr_read_b32 v223, a63
v_mul_f32 v220, v220, v77
v_mul_f32 v221, v221, v77
v_mul_f32 v222, v222, v77
v_mul_f32 v223, v223, v77
v_accvgpr_write_b32 a60, v220
v_accvgpr_write_b32 a61, v221
v_accvgpr_write_b32 a62, v222
v_accvgpr_write_b32 a63, v223
v_accvgpr_read_b32 v216, a64
v_accvgpr_read_b32 v217, a65
v_accvgpr_read_b32 v218, a66
v_accvgpr_read_b32 v219, a67
v_mul_f32 v216, v216, v65
v_mul_f32 v217, v217, v65
v_mul_f32 v218, v218, v65
v_mul_f32 v219, v219, v65
v_accvgpr_write_b32 a64, v216
v_accvgpr_write_b32 a65, v217
v_accvgpr_write_b32 a66, v218
v_accvgpr_write_b32 a67, v219
v_accvgpr_read_b32 v220, a68
v_accvgpr_read_b32 v221, a69
v_accvgpr_read_b32 v222, a70
v_accvgpr_read_b32 v223, a71
v_mul_f32 v220, v220, v69
v_mul_f32 v221, v221, v69
v_mul_f32 v222, v222, v69
v_mul_f32 v223, v223, v69
v_accvgpr_write_b32 a68, v220
v_accvgpr_write_b32 a69, v221
v_accvgpr_write_b32 a70, v222
v_accvgpr_write_b32 a71, v223
v_accvgpr_read_b32 v216, a72
v_accvgpr_read_b32 v217, a73
v_accvgpr_read_b32 v218, a74
v_accvgpr_read_b32 v219, a75
v_mul_f32 v216, v216, v73
v_mul_f32 v217, v217, v73
v_mul_f32 v218, v218, v73
v_mul_f32 v219, v219, v73
v_accvgpr_write_b32 a72, v216
v_accvgpr_write_b32 a73, v217
v_accvgpr_write_b32 a74, v218
v_accvgpr_write_b32 a75, v219
v_accvgpr_read_b32 v220, a76
v_accvgpr_read_b32 v221, a77
v_accvgpr_read_b32 v222, a78
v_accvgpr_read_b32 v223, a79
v_mul_f32 v220, v220, v77
v_mul_f32 v221, v221, v77
v_mul_f32 v222, v222, v77
v_mul_f32 v223, v223, v77
v_accvgpr_write_b32 a76, v220
v_accvgpr_write_b32 a77, v221
v_accvgpr_write_b32 a78, v222
v_accvgpr_write_b32 a79, v223
v_accvgpr_read_b32 v216, a80
v_accvgpr_read_b32 v217, a81
v_accvgpr_read_b32 v218, a82
v_accvgpr_read_b32 v219, a83
v_mul_f32 v216, v216, v65
v_mul_f32 v217, v217, v65
v_mul_f32 v218, v218, v65
v_mul_f32 v219, v219, v65
v_accvgpr_write_b32 a80, v216
v_accvgpr_write_b32 a81, v217
v_accvgpr_write_b32 a82, v218
v_accvgpr_write_b32 a83, v219
v_accvgpr_read_b32 v220, a84
v_accvgpr_read_b32 v221, a85
v_accvgpr_read_b32 v222, a86
v_accvgpr_read_b32 v223, a87
v_mul_f32 v220, v220, v69
v_mul_f32 v221, v221, v69
v_mul_f32 v222, v222, v69
v_mul_f32 v223, v223, v69
v_accvgpr_write_b32 a84, v220
v_accvgpr_write_b32 a85, v221
v_accvgpr_write_b32 a86, v222
v_accvgpr_write_b32 a87, v223
v_accvgpr_read_b32 v216, a88
v_accvgpr_read_b32 v217, a89
v_accvgpr_read_b32 v218, a90
v_accvgpr_read_b32 v219, a91
v_mul_f32 v216, v216, v73
v_mul_f32 v217, v217, v73
v_mul_f32 v218, v218, v73
v_mul_f32 v219, v219, v73
v_accvgpr_write_b32 a88, v216
v_accvgpr_write_b32 a89, v217
v_accvgpr_write_b32 a90, v218
v_accvgpr_write_b32 a91, v219
v_accvgpr_read_b32 v220, a92
v_accvgpr_read_b32 v221, a93
v_accvgpr_read_b32 v222, a94
v_accvgpr_read_b32 v223, a95
v_mul_f32 v220, v220, v77
v_mul_f32 v221, v221, v77
v_mul_f32 v222, v222, v77
v_mul_f32 v223, v223, v77
v_accvgpr_write_b32 a92, v220
v_accvgpr_write_b32 a93, v221
v_accvgpr_write_b32 a94, v222
v_accvgpr_write_b32 a95, v223
v_accvgpr_read_b32 v216, a96
v_accvgpr_read_b32 v217, a97
v_accvgpr_read_b32 v218, a98
v_accvgpr_read_b32 v219, a99
v_mul_f32 v216, v216, v65
v_mul_f32 v217, v217, v65
v_mul_f32 v218, v218, v65
v_mul_f32 v219, v219, v65
v_accvgpr_write_b32 a96, v216
v_accvgpr_write_b32 a97, v217
v_accvgpr_write_b32 a98, v218
v_accvgpr_write_b32 a99, v219
v_accvgpr_read_b32 v220, a100
v_accvgpr_read_b32 v221, a101
v_accvgpr_read_b32 v222, a102
v_accvgpr_read_b32 v223, a103
v_mul_f32 v220, v220, v69
v_mul_f32 v221, v221, v69
v_mul_f32 v222, v222, v69
v_mul_f32 v223, v223, v69
v_accvgpr_write_b32 a100, v220
v_accvgpr_write_b32 a101, v221
v_accvgpr_write_b32 a102, v222
v_accvgpr_write_b32 a103, v223
v_accvgpr_read_b32 v216, a104
v_accvgpr_read_b32 v217, a105
v_accvgpr_read_b32 v218, a106
v_accvgpr_read_b32 v219, a107
v_mul_f32 v216, v216, v73
v_mul_f32 v217, v217, v73
v_mul_f32 v218, v218, v73
v_mul_f32 v219, v219, v73
v_accvgpr_write_b32 a104, v216
v_accvgpr_write_b32 a105, v217
v_accvgpr_write_b32 a106, v218
v_accvgpr_write_b32 a107, v219
v_accvgpr_read_b32 v220, a108
v_accvgpr_read_b32 v221, a109
v_accvgpr_read_b32 v222, a110
v_accvgpr_read_b32 v223, a111
v_mul_f32 v220, v220, v77
v_mul_f32 v221, v221, v77
v_mul_f32 v222, v222, v77
v_mul_f32 v223, v223, v77
v_accvgpr_write_b32 a108, v220
v_accvgpr_write_b32 a109, v221
v_accvgpr_write_b32 a110, v222
v_accvgpr_write_b32 a111, v223
v_accvgpr_read_b32 v216, a112
v_accvgpr_read_b32 v217, a113
v_accvgpr_read_b32 v218, a114
v_accvgpr_read_b32 v219, a115
v_mul_f32 v216, v216, v65
v_mul_f32 v217, v217, v65
v_mul_f32 v218, v218, v65
v_mul_f32 v219, v219, v65
v_accvgpr_write_b32 a112, v216
v_accvgpr_write_b32 a113, v217
v_accvgpr_write_b32 a114, v218
v_accvgpr_write_b32 a115, v219
v_accvgpr_read_b32 v220, a116
v_accvgpr_read_b32 v221, a117
v_accvgpr_read_b32 v222, a118
v_accvgpr_read_b32 v223, a119
v_mul_f32 v220, v220, v69
v_mul_f32 v221, v221, v69
v_mul_f32 v222, v222, v69
v_mul_f32 v223, v223, v69
v_accvgpr_write_b32 a116, v220
v_accvgpr_write_b32 a117, v221
v_accvgpr_write_b32 a118, v222
v_accvgpr_write_b32 a119, v223
v_accvgpr_read_b32 v216, a120
v_accvgpr_read_b32 v217, a121
v_accvgpr_read_b32 v218, a122
v_accvgpr_read_b32 v219, a123
v_mul_f32 v216, v216, v73
v_mul_f32 v217, v217, v73
v_mul_f32 v218, v218, v73
v_mul_f32 v219, v219, v73
v_accvgpr_write_b32 a120, v216
v_accvgpr_write_b32 a121, v217
v_accvgpr_write_b32 a122, v218
v_accvgpr_write_b32 a123, v219
v_accvgpr_read_b32 v220, a124
v_accvgpr_read_b32 v221, a125
v_accvgpr_read_b32 v222, a126
v_accvgpr_read_b32 v223, a127
v_mul_f32 v220, v220, v77
v_mul_f32 v221, v221, v77
v_mul_f32 v222, v222, v77
v_mul_f32 v223, v223, v77
v_accvgpr_write_b32 a124, v220
v_accvgpr_write_b32 a125, v221
v_accvgpr_write_b32 a126, v222
v_accvgpr_write_b32 a127, v223
v_accvgpr_read_b32 v216, a128
v_accvgpr_read_b32 v217, a129
v_accvgpr_read_b32 v218, a130
v_accvgpr_read_b32 v219, a131
v_mul_f32 v216, v216, v65
v_mul_f32 v217, v217, v65
v_mul_f32 v218, v218, v65
v_mul_f32 v219, v219, v65
v_accvgpr_write_b32 a128, v216
v_accvgpr_write_b32 a129, v217
v_accvgpr_write_b32 a130, v218
v_accvgpr_write_b32 a131, v219
v_accvgpr_read_b32 v220, a132
v_accvgpr_read_b32 v221, a133
v_accvgpr_read_b32 v222, a134
v_accvgpr_read_b32 v223, a135
v_mul_f32 v220, v220, v69
v_mul_f32 v221, v221, v69
v_mul_f32 v222, v222, v69
v_mul_f32 v223, v223, v69
v_accvgpr_write_b32 a132, v220
v_accvgpr_write_b32 a133, v221
v_accvgpr_write_b32 a134, v222
v_accvgpr_write_b32 a135, v223
v_accvgpr_read_b32 v216, a136
v_accvgpr_read_b32 v217, a137
v_accvgpr_read_b32 v218, a138
v_accvgpr_read_b32 v219, a139
v_mul_f32 v216, v216, v73
v_mul_f32 v217, v217, v73
v_mul_f32 v218, v218, v73
v_mul_f32 v219, v219, v73
v_accvgpr_write_b32 a136, v216
v_accvgpr_write_b32 a137, v217
v_accvgpr_write_b32 a138, v218
v_accvgpr_write_b32 a139, v219
v_accvgpr_read_b32 v220, a140
v_accvgpr_read_b32 v221, a141
v_accvgpr_read_b32 v222, a142
v_accvgpr_read_b32 v223, a143
v_mul_f32 v220, v220, v77
v_mul_f32 v221, v221, v77
v_mul_f32 v222, v222, v77
v_mul_f32 v223, v223, v77
v_accvgpr_write_b32 a140, v220
v_accvgpr_write_b32 a141, v221
v_accvgpr_write_b32 a142, v222
v_accvgpr_write_b32 a143, v223
v_accvgpr_read_b32 v216, a144
v_accvgpr_read_b32 v217, a145
v_accvgpr_read_b32 v218, a146
v_accvgpr_read_b32 v219, a147
v_mul_f32 v216, v216, v65
v_mul_f32 v217, v217, v65
v_mul_f32 v218, v218, v65
v_mul_f32 v219, v219, v65
v_accvgpr_write_b32 a144, v216
v_accvgpr_write_b32 a145, v217
v_accvgpr_write_b32 a146, v218
v_accvgpr_write_b32 a147, v219
v_accvgpr_read_b32 v220, a148
v_accvgpr_read_b32 v221, a149
v_accvgpr_read_b32 v222, a150
v_accvgpr_read_b32 v223, a151
v_mul_f32 v220, v220, v69
v_mul_f32 v221, v221, v69
v_mul_f32 v222, v222, v69
v_mul_f32 v223, v223, v69
v_accvgpr_write_b32 a148, v220
v_accvgpr_write_b32 a149, v221
v_accvgpr_write_b32 a150, v222
v_accvgpr_write_b32 a151, v223
v_accvgpr_read_b32 v216, a152
v_accvgpr_read_b32 v217, a153
v_accvgpr_read_b32 v218, a154
v_accvgpr_read_b32 v219, a155
v_mul_f32 v216, v216, v73
v_mul_f32 v217, v217, v73
v_mul_f32 v218, v218, v73
v_mul_f32 v219, v219, v73
v_accvgpr_write_b32 a152, v216
v_accvgpr_write_b32 a153, v217
v_accvgpr_write_b32 a154, v218
v_accvgpr_write_b32 a155, v219
v_accvgpr_read_b32 v220, a156
v_accvgpr_read_b32 v221, a157
v_accvgpr_read_b32 v222, a158
v_accvgpr_read_b32 v223, a159
v_mul_f32 v220, v220, v77
v_mul_f32 v221, v221, v77
v_mul_f32 v222, v222, v77
v_mul_f32 v223, v223, v77
v_accvgpr_write_b32 a156, v220
v_accvgpr_write_b32 a157, v221
v_accvgpr_write_b32 a158, v222
v_accvgpr_write_b32 a159, v223
v_accvgpr_read_b32 v216, a160
v_accvgpr_read_b32 v217, a161
v_accvgpr_read_b32 v218, a162
v_accvgpr_read_b32 v219, a163
v_mul_f32 v216, v216, v65
v_mul_f32 v217, v217, v65
v_mul_f32 v218, v218, v65
v_mul_f32 v219, v219, v65
v_accvgpr_write_b32 a160, v216
v_accvgpr_write_b32 a161, v217
v_accvgpr_write_b32 a162, v218
v_accvgpr_write_b32 a163, v219
v_accvgpr_read_b32 v220, a164
v_accvgpr_read_b32 v221, a165
v_accvgpr_read_b32 v222, a166
v_accvgpr_read_b32 v223, a167
v_mul_f32 v220, v220, v69
v_mul_f32 v221, v221, v69
v_mul_f32 v222, v222, v69
v_mul_f32 v223, v223, v69
v_accvgpr_write_b32 a164, v220
v_accvgpr_write_b32 a165, v221
v_accvgpr_write_b32 a166, v222
v_accvgpr_write_b32 a167, v223
v_accvgpr_read_b32 v216, a168
v_accvgpr_read_b32 v217, a169
v_accvgpr_read_b32 v218, a170
v_accvgpr_read_b32 v219, a171
v_mul_f32 v216, v216, v73
v_mul_f32 v217, v217, v73
v_mul_f32 v218, v218, v73
v_mul_f32 v219, v219, v73
v_accvgpr_write_b32 a168, v216
v_accvgpr_write_b32 a169, v217
v_accvgpr_write_b32 a170, v218
v_accvgpr_write_b32 a171, v219
v_accvgpr_read_b32 v220, a172
v_accvgpr_read_b32 v221, a173
v_accvgpr_read_b32 v222, a174
v_accvgpr_read_b32 v223, a175
v_mul_f32 v220, v220, v77
v_mul_f32 v221, v221, v77
v_mul_f32 v222, v222, v77
v_mul_f32 v223, v223, v77
v_accvgpr_write_b32 a172, v220
v_accvgpr_write_b32 a173, v221
v_accvgpr_write_b32 a174, v222
v_accvgpr_write_b32 a175, v223
v_accvgpr_read_b32 v216, a176
v_accvgpr_read_b32 v217, a177
v_accvgpr_read_b32 v218, a178
v_accvgpr_read_b32 v219, a179
v_mul_f32 v216, v216, v65
v_mul_f32 v217, v217, v65
v_mul_f32 v218, v218, v65
v_mul_f32 v219, v219, v65
v_accvgpr_write_b32 a176, v216
v_accvgpr_write_b32 a177, v217
v_accvgpr_write_b32 a178, v218
v_accvgpr_write_b32 a179, v219
v_accvgpr_read_b32 v220, a180
v_accvgpr_read_b32 v221, a181
v_accvgpr_read_b32 v222, a182
v_accvgpr_read_b32 v223, a183
v_mul_f32 v220, v220, v69
v_mul_f32 v221, v221, v69
v_mul_f32 v222, v222, v69
v_mul_f32 v223, v223, v69
v_accvgpr_write_b32 a180, v220
v_accvgpr_write_b32 a181, v221
v_accvgpr_write_b32 a182, v222
v_accvgpr_write_b32 a183, v223
v_accvgpr_read_b32 v216, a184
v_accvgpr_read_b32 v217, a185
v_accvgpr_read_b32 v218, a186
v_accvgpr_read_b32 v219, a187
v_mul_f32 v216, v216, v73
v_mul_f32 v217, v217, v73
v_mul_f32 v218, v218, v73
v_mul_f32 v219, v219, v73
v_accvgpr_write_b32 a184, v216
v_accvgpr_write_b32 a185, v217
v_accvgpr_write_b32 a186, v218
v_accvgpr_write_b32 a187, v219
v_accvgpr_read_b32 v220, a188
v_accvgpr_read_b32 v221, a189
v_accvgpr_read_b32 v222, a190
v_accvgpr_read_b32 v223, a191
v_mul_f32 v220, v220, v77
v_mul_f32 v221, v221, v77
v_mul_f32 v222, v222, v77
v_mul_f32 v223, v223, v77
v_accvgpr_write_b32 a188, v220
v_accvgpr_write_b32 a189, v221
v_accvgpr_write_b32 a190, v222
v_accvgpr_write_b32 a191, v223
v_exp_f32 v216, v0
v_exp_f32 v217, v1
v_exp_f32 v218, v2
v_exp_f32 v219, v3
v_cvt_pk_bf16_f32 v96, v216, v217
v_cvt_pk_bf16_f32 v97, v218, v219
v_add_f32 v216, v216, v217
v_add_f32 v218, v218, v219
v_add_f32 v224, v216, v218
v_exp_f32 v220, v4
v_exp_f32 v221, v5
v_exp_f32 v222, v6
v_exp_f32 v223, v7
v_cvt_pk_bf16_f32 v100, v220, v221
v_cvt_pk_bf16_f32 v101, v222, v223
v_add_f32 v220, v220, v221
v_add_f32 v222, v222, v223
v_add_f32 v225, v220, v222
v_exp_f32 v216, v8
v_exp_f32 v217, v9
v_exp_f32 v218, v10
v_exp_f32 v219, v11
v_cvt_pk_bf16_f32 v104, v216, v217
v_cvt_pk_bf16_f32 v105, v218, v219
v_add_f32 v216, v216, v217
v_add_f32 v218, v218, v219
v_add_f32 v226, v216, v218
v_exp_f32 v220, v12
v_exp_f32 v221, v13
v_exp_f32 v222, v14
v_exp_f32 v223, v15
v_cvt_pk_bf16_f32 v108, v220, v221
v_cvt_pk_bf16_f32 v109, v222, v223
v_add_f32 v220, v220, v221
v_add_f32 v222, v222, v223
v_add_f32 v227, v220, v222
v_exp_f32 v216, v16
v_exp_f32 v217, v17
v_exp_f32 v218, v18
v_exp_f32 v219, v19
v_cvt_pk_bf16_f32 v98, v216, v217
v_cvt_pk_bf16_f32 v99, v218, v219
v_add_f32 v216, v216, v217
v_add_f32 v218, v218, v219
v_add_f32 v224, v224, v216
v_add_f32 v224, v224, v218
v_exp_f32 v220, v20
v_exp_f32 v221, v21
v_exp_f32 v222, v22
v_exp_f32 v223, v23
v_cvt_pk_bf16_f32 v102, v220, v221
v_cvt_pk_bf16_f32 v103, v222, v223
v_add_f32 v220, v220, v221
v_add_f32 v222, v222, v223
v_add_f32 v225, v225, v220
v_add_f32 v225, v225, v222
v_exp_f32 v216, v24
v_exp_f32 v217, v25
v_exp_f32 v218, v26
v_exp_f32 v219, v27
v_cvt_pk_bf16_f32 v106, v216, v217
v_cvt_pk_bf16_f32 v107, v218, v219
v_add_f32 v216, v216, v217
v_add_f32 v218, v218, v219
v_add_f32 v226, v226, v216
v_add_f32 v226, v226, v218
v_exp_f32 v220, v28
v_exp_f32 v221, v29
v_exp_f32 v222, v30
v_exp_f32 v223, v31
v_cvt_pk_bf16_f32 v110, v220, v221
v_cvt_pk_bf16_f32 v111, v222, v223
v_add_f32 v220, v220, v221
v_add_f32 v222, v222, v223
v_add_f32 v227, v227, v220
v_add_f32 v227, v227, v222
v_exp_f32 v216, v32
v_exp_f32 v217, v33
v_exp_f32 v218, v34
v_exp_f32 v219, v35
v_cvt_pk_bf16_f32 v112, v216, v217
v_cvt_pk_bf16_f32 v113, v218, v219
v_add_f32 v216, v216, v217
v_add_f32 v218, v218, v219
v_add_f32 v224, v224, v216
v_add_f32 v224, v224, v218
v_exp_f32 v220, v36
v_exp_f32 v221, v37
v_exp_f32 v222, v38
v_exp_f32 v223, v39
v_cvt_pk_bf16_f32 v116, v220, v221
v_cvt_pk_bf16_f32 v117, v222, v223
v_add_f32 v220, v220, v221
v_add_f32 v222, v222, v223
v_add_f32 v225, v225, v220
v_add_f32 v225, v225, v222
v_exp_f32 v216, v40
v_exp_f32 v217, v41
v_exp_f32 v218, v42
v_exp_f32 v219, v43
v_cvt_pk_bf16_f32 v120, v216, v217
v_cvt_pk_bf16_f32 v121, v218, v219
v_add_f32 v216, v216, v217
v_add_f32 v218, v218, v219
v_add_f32 v226, v226, v216
v_add_f32 v226, v226, v218
v_exp_f32 v220, v44
v_exp_f32 v221, v45
v_exp_f32 v222, v46
v_exp_f32 v223, v47
v_cvt_pk_bf16_f32 v124, v220, v221
v_cvt_pk_bf16_f32 v125, v222, v223
v_add_f32 v220, v220, v221
v_add_f32 v222, v222, v223
v_add_f32 v227, v227, v220
v_add_f32 v227, v227, v222
v_exp_f32 v216, v48
v_exp_f32 v217, v49
v_exp_f32 v218, v50
v_exp_f32 v219, v51
v_cvt_pk_bf16_f32 v114, v216, v217
v_cvt_pk_bf16_f32 v115, v218, v219
v_add_f32 v216, v216, v217
v_add_f32 v218, v218, v219
v_add_f32 v224, v224, v216
v_add_f32 v224, v224, v218
v_exp_f32 v220, v52
v_exp_f32 v221, v53
v_exp_f32 v222, v54
v_exp_f32 v223, v55
v_cvt_pk_bf16_f32 v118, v220, v221
v_cvt_pk_bf16_f32 v119, v222, v223
v_add_f32 v220, v220, v221
v_add_f32 v222, v222, v223
v_add_f32 v225, v225, v220
v_add_f32 v225, v225, v222
v_exp_f32 v216, v56
v_exp_f32 v217, v57
v_exp_f32 v218, v58
v_exp_f32 v219, v59
v_cvt_pk_bf16_f32 v122, v216, v217
v_cvt_pk_bf16_f32 v123, v218, v219
v_add_f32 v216, v216, v217
v_add_f32 v218, v218, v219
v_add_f32 v226, v226, v216
v_add_f32 v226, v226, v218
v_exp_f32 v220, v60
v_exp_f32 v221, v61
v_exp_f32 v222, v62
v_exp_f32 v223, v63
v_cvt_pk_bf16_f32 v126, v220, v221
v_cvt_pk_bf16_f32 v127, v222, v223
v_add_f32 v220, v220, v221
v_add_f32 v222, v222, v223
v_add_f32 v227, v227, v220
v_add_f32 v227, v227, v222
s_nop 1
s_setpc_b64 s[30:31]
L_slow_0_0123:
s_nop 7
s_nop 7
v_max3_f32 v96, v0, v1, v2
v_max3_f32 v96, v96, v3, v16
v_max3_f32 v96, v96, v17, v18
v_max3_f32 v96, v96, v19, v32
v_max3_f32 v96, v96, v33, v34
v_max3_f32 v96, v96, v35, v48
v_max3_f32 v96, v96, v49, v50
v_max_f32 v96, v96, v51
v_mov_b32 v216, v96
s_nop 1
v_permlane16_swap_b32 v96, v216
v_max_f32 v96, v96, v216
v_mov_b32 v216, v96
s_nop 1
v_permlane32_swap_b32 v96, v216
v_max_f32 v96, v96, v216
v_ceil_f32 v96, v96
v_max_f32 v96, 0, v96
v_exp_f32_e64 v97, -v96
v_max3_f32 v100, v4, v5, v6
v_max3_f32 v100, v100, v7, v20
v_max3_f32 v100, v100, v21, v22
v_max3_f32 v100, v100, v23, v36
v_max3_f32 v100, v100, v37, v38
v_max3_f32 v100, v100, v39, v52
v_max3_f32 v100, v100, v53, v54
v_max_f32 v100, v100, v55
v_mov_b32 v216, v100
s_nop 1
v_permlane16_swap_b32 v100, v216
v_max_f32 v100, v100, v216
v_mov_b32 v216, v100
s_nop 1
v_permlane32_swap_b32 v100, v216
v_max_f32 v100, v100, v216
v_ceil_f32 v100, v100
v_max_f32 v100, 0, v100
v_exp_f32_e64 v101, -v100
v_max3_f32 v104, v8, v9, v10
v_max3_f32 v104, v104, v11, v24
v_max3_f32 v104, v104, v25, v26
v_max3_f32 v104, v104, v27, v40
v_max3_f32 v104, v104, v41, v42
v_max3_f32 v104, v104, v43, v56
v_max3_f32 v104, v104, v57, v58
v_max_f32 v104, v104, v59
v_mov_b32 v216, v104
s_nop 1
v_permlane16_swap_b32 v104, v216
v_max_f32 v104, v104, v216
v_mov_b32 v216, v104
s_nop 1
v_permlane32_swap_b32 v104, v216
v_max_f32 v104, v104, v216
v_ceil_f32 v104, v104
v_max_f32 v104, 0, v104
v_exp_f32_e64 v105, -v104
v_max3_f32 v108, v12, v13, v14
v_max3_f32 v108, v108, v15, v28
v_max3_f32 v108, v108, v29, v30
v_max3_f32 v108, v108, v31, v44
v_max3_f32 v108, v108, v45, v46
v_max3_f32 v108, v108, v47, v60
v_max3_f32 v108, v108, v61, v62
v_max_f32 v108, v108, v63
v_mov_b32 v216, v108
s_nop 1
v_permlane16_swap_b32 v108, v216
v_max_f32 v108, v108, v216
v_mov_b32 v216, v108
s_nop 1
v_permlane32_swap_b32 v108, v216
v_max_f32 v108, v108, v216
v_ceil_f32 v108, v108
v_max_f32 v108, 0, v108
v_exp_f32_e64 v109, -v108
s_nop 0
v_mul_f32 v228, v228, v97
v_sub_f32 v128, v128, v96
v_sub_f32 v129, v129, v96
v_sub_f32 v130, v130, v96
v_sub_f32 v131, v131, v96
v_sub_f32 v0, v0, v96
v_sub_f32 v1, v1, v96
v_sub_f32 v2, v2, v96
v_sub_f32 v3, v3, v96
v_sub_f32 v16, v16, v96
v_sub_f32 v17, v17, v96
v_sub_f32 v18, v18, v96
v_sub_f32 v19, v19, v96
v_sub_f32 v32, v32, v96
v_sub_f32 v33, v33, v96
v_sub_f32 v34, v34, v96
v_sub_f32 v35, v35, v96
v_sub_f32 v48, v48, v96
v_sub_f32 v49, v49, v96
v_sub_f32 v50, v50, v96
v_sub_f32 v51, v51, v96
v_mul_f32 v229, v229, v101
v_sub_f32 v132, v132, v100
v_sub_f32 v133, v133, v100
v_sub_f32 v134, v134, v100
v_sub_f32 v135, v135, v100
v_sub_f32 v4, v4, v100
v_sub_f32 v5, v5, v100
v_sub_f32 v6, v6, v100
v_sub_f32 v7, v7, v100
v_sub_f32 v20, v20, v100
v_sub_f32 v21, v21, v100
v_sub_f32 v22, v22, v100
v_sub_f32 v23, v23, v100
v_sub_f32 v36, v36, v100
v_sub_f32 v37, v37, v100
v_sub_f32 v38, v38, v100
v_sub_f32 v39, v39, v100
v_sub_f32 v52, v52, v100
v_sub_f32 v53, v53, v100
v_sub_f32 v54, v54, v100
v_sub_f32 v55, v55, v100
v_mul_f32 v230, v230, v105
v_sub_f32 v136, v136, v104
v_sub_f32 v137, v137, v104
v_sub_f32 v138, v138, v104
v_sub_f32 v139, v139, v104
v_sub_f32 v8, v8, v104
v_sub_f32 v9, v9, v104
v_sub_f32 v10, v10, v104
v_sub_f32 v11, v11, v104
v_sub_f32 v24, v24, v104
v_sub_f32 v25, v25, v104
v_sub_f32 v26, v26, v104
v_sub_f32 v27, v27, v104
v_sub_f32 v40, v40, v104
v_sub_f32 v41, v41, v104
v_sub_f32 v42, v42, v104
v_sub_f32 v43, v43, v104
v_sub_f32 v56, v56, v104
v_sub_f32 v57, v57, v104
v_sub_f32 v58, v58, v104
v_sub_f32 v59, v59, v104
v_mul_f32 v231, v231, v109
v_sub_f32 v140, v140, v108
v_sub_f32 v141, v141, v108
v_sub_f32 v142, v142, v108
v_sub_f32 v143, v143, v108
v_sub_f32 v12, v12, v108
v_sub_f32 v13, v13, v108
v_sub_f32 v14, v14, v108
v_sub_f32 v15, v15, v108
v_sub_f32 v28, v28, v108
v_sub_f32 v29, v29, v108
v_sub_f32 v30, v30, v108
v_sub_f32 v31, v31, v108
v_sub_f32 v44, v44, v108
v_sub_f32 v45, v45, v108
v_sub_f32 v46, v46, v108
v_sub_f32 v47, v47, v108
v_sub_f32 v60, v60, v108
v_sub_f32 v61, v61, v108
v_sub_f32 v62, v62, v108
v_sub_f32 v63, v63, v108
v_accvgpr_read_b32 v216, a0
v_accvgpr_read_b32 v217, a1
v_accvgpr_read_b32 v218, a2
v_accvgpr_read_b32 v219, a3
v_mul_f32 v216, v216, v97
v_mul_f32 v217, v217, v97
v_mul_f32 v218, v218, v97
v_mul_f32 v219, v219, v97
v_accvgpr_write_b32 a0, v216
v_accvgpr_write_b32 a1, v217
v_accvgpr_write_b32 a2, v218
v_accvgpr_write_b32 a3, v219
v_accvgpr_read_b32 v220, a4
v_accvgpr_read_b32 v221, a5
v_accvgpr_read_b32 v222, a6
v_accvgpr_read_b32 v223, a7
v_mul_f32 v220, v220, v101
v_mul_f32 v221, v221, v101
v_mul_f32 v222, v222, v101
v_mul_f32 v223, v223, v101
v_accvgpr_write_b32 a4, v220
v_accvgpr_write_b32 a5, v221
v_accvgpr_write_b32 a6, v222
v_accvgpr_write_b32 a7, v223
v_accvgpr_read_b32 v216, a8
v_accvgpr_read_b32 v217, a9
v_accvgpr_read_b32 v218, a10
v_accvgpr_read_b32 v219, a11
v_mul_f32 v216, v216, v105
v_mul_f32 v217, v217, v105
v_mul_f32 v218, v218, v105
v_mul_f32 v219, v219, v105
v_accvgpr_write_b32 a8, v216
v_accvgpr_write_b32 a9, v217
v_accvgpr_write_b32 a10, v218
v_accvgpr_write_b32 a11, v219
v_accvgpr_read_b32 v220, a12
v_accvgpr_read_b32 v221, a13
v_accvgpr_read_b32 v222, a14
v_accvgpr_read_b32 v223, a15
v_mul_f32 v220, v220, v109
v_mul_f32 v221, v221, v109
v_mul_f32 v222, v222, v109
v_mul_f32 v223, v223, v109
v_accvgpr_write_b32 a12, v220
v_accvgpr_write_b32 a13, v221
v_accvgpr_write_b32 a14, v222
v_accvgpr_write_b32 a15, v223
v_accvgpr_read_b32 v216, a16
v_accvgpr_read_b32 v217, a17
v_accvgpr_read_b32 v218, a18
v_accvgpr_read_b32 v219, a19
v_mul_f32 v216, v216, v97
v_mul_f32 v217, v217, v97
v_mul_f32 v218, v218, v97
v_mul_f32 v219, v219, v97
v_accvgpr_write_b32 a16, v216
v_accvgpr_write_b32 a17, v217
v_accvgpr_write_b32 a18, v218
v_accvgpr_write_b32 a19, v219
v_accvgpr_read_b32 v220, a20
v_accvgpr_read_b32 v221, a21
v_accvgpr_read_b32 v222, a22
v_accvgpr_read_b32 v223, a23
v_mul_f32 v220, v220, v101
v_mul_f32 v221, v221, v101
v_mul_f32 v222, v222, v101
v_mul_f32 v223, v223, v101
v_accvgpr_write_b32 a20, v220
v_accvgpr_write_b32 a21, v221
v_accvgpr_write_b32 a22, v222
v_accvgpr_write_b32 a23, v223
v_accvgpr_read_b32 v216, a24
v_accvgpr_read_b32 v217, a25
v_accvgpr_read_b32 v218, a26
v_accvgpr_read_b32 v219, a27
v_mul_f32 v216, v216, v105
v_mul_f32 v217, v217, v105
v_mul_f32 v218, v218, v105
v_mul_f32 v219, v219, v105
v_accvgpr_write_b32 a24, v216
v_accvgpr_write_b32 a25, v217
v_accvgpr_write_b32 a26, v218
v_accvgpr_write_b32 a27, v219
v_accvgpr_read_b32 v220, a28
v_accvgpr_read_b32 v221, a29
v_accvgpr_read_b32 v222, a30
v_accvgpr_read_b32 v223, a31
v_mul_f32 v220, v220, v109
v_mul_f32 v221, v221, v109
v_mul_f32 v222, v222, v109
v_mul_f32 v223, v223, v109
v_accvgpr_write_b32 a28, v220
v_accvgpr_write_b32 a29, v221
v_accvgpr_write_b32 a30, v222
v_accvgpr_write_b32 a31, v223
v_accvgpr_read_b32 v216, a32
v_accvgpr_read_b32 v217, a33
v_accvgpr_read_b32 v218, a34
v_accvgpr_read_b32 v219, a35
v_mul_f32 v216, v216, v97
v_mul_f32 v217, v217, v97
v_mul_f32 v218, v218, v97
v_mul_f32 v219, v219, v97
v_accvgpr_write_b32 a32, v216
v_accvgpr_write_b32 a33, v217
v_accvgpr_write_b32 a34, v218
v_accvgpr_write_b32 a35, v219
v_accvgpr_read_b32 v220, a36
v_accvgpr_read_b32 v221, a37
v_accvgpr_read_b32 v222, a38
v_accvgpr_read_b32 v223, a39
v_mul_f32 v220, v220, v101
v_mul_f32 v221, v221, v101
v_mul_f32 v222, v222, v101
v_mul_f32 v223, v223, v101
v_accvgpr_write_b32 a36, v220
v_accvgpr_write_b32 a37, v221
v_accvgpr_write_b32 a38, v222
v_accvgpr_write_b32 a39, v223
v_accvgpr_read_b32 v216, a40
v_accvgpr_read_b32 v217, a41
v_accvgpr_read_b32 v218, a42
v_accvgpr_read_b32 v219, a43
v_mul_f32 v216, v216, v105
v_mul_f32 v217, v217, v105
v_mul_f32 v218, v218, v105
v_mul_f32 v219, v219, v105
v_accvgpr_write_b32 a40, v216
v_accvgpr_write_b32 a41, v217
v_accvgpr_write_b32 a42, v218
v_accvgpr_write_b32 a43, v219
v_accvgpr_read_b32 v220, a44
v_accvgpr_read_b32 v221, a45
v_accvgpr_read_b32 v222, a46
v_accvgpr_read_b32 v223, a47
v_mul_f32 v220, v220, v109
v_mul_f32 v221, v221, v109
v_mul_f32 v222, v222, v109
v_mul_f32 v223, v223, v109
v_accvgpr_write_b32 a44, v220
v_accvgpr_write_b32 a45, v221
v_accvgpr_write_b32 a46, v222
v_accvgpr_write_b32 a47, v223
v_accvgpr_read_b32 v216, a48
v_accvgpr_read_b32 v217, a49
v_accvgpr_read_b32 v218, a50
v_accvgpr_read_b32 v219, a51
v_mul_f32 v216, v216, v97
v_mul_f32 v217, v217, v97
v_mul_f32 v218, v218, v97
v_mul_f32 v219, v219, v97
v_accvgpr_write_b32 a48, v216
v_accvgpr_write_b32 a49, v217
v_accvgpr_write_b32 a50, v218
v_accvgpr_write_b32 a51, v219
v_accvgpr_read_b32 v220, a52
v_accvgpr_read_b32 v221, a53
v_accvgpr_read_b32 v222, a54
v_accvgpr_read_b32 v223, a55
v_mul_f32 v220, v220, v101
v_mul_f32 v221, v221, v101
v_mul_f32 v222, v222, v101
v_mul_f32 v223, v223, v101
v_accvgpr_write_b32 a52, v220
v_accvgpr_write_b32 a53, v221
v_accvgpr_write_b32 a54, v222
v_accvgpr_write_b32 a55, v223
v_accvgpr_read_b32 v216, a56
v_accvgpr_read_b32 v217, a57
v_accvgpr_read_b32 v218, a58
v_accvgpr_read_b32 v219, a59
v_mul_f32 v216, v216, v105
v_mul_f32 v217, v217, v105
v_mul_f32 v218, v218, v105
v_mul_f32 v219, v219, v105
v_accvgpr_write_b32 a56, v216
v_accvgpr_write_b32 a57, v217
v_accvgpr_write_b32 a58, v218
v_accvgpr_write_b32 a59, v219
v_accvgpr_read_b32 v220, a60
v_accvgpr_read_b32 v221, a61
v_accvgpr_read_b32 v222, a62
v_accvgpr_read_b32 v223, a63
v_mul_f32 v220, v220, v109
v_mul_f32 v221, v221, v109
v_mul_f32 v222, v222, v109
v_mul_f32 v223, v223, v109
v_accvgpr_write_b32 a60, v220
v_accvgpr_write_b32 a61, v221
v_accvgpr_write_b32 a62, v222
v_accvgpr_write_b32 a63, v223
v_accvgpr_read_b32 v216, a64
v_accvgpr_read_b32 v217, a65
v_accvgpr_read_b32 v218, a66
v_accvgpr_read_b32 v219, a67
v_mul_f32 v216, v216, v97
v_mul_f32 v217, v217, v97
v_mul_f32 v218, v218, v97
v_mul_f32 v219, v219, v97
v_accvgpr_write_b32 a64, v216
v_accvgpr_write_b32 a65, v217
v_accvgpr_write_b32 a66, v218
v_accvgpr_write_b32 a67, v219
v_accvgpr_read_b32 v220, a68
v_accvgpr_read_b32 v221, a69
v_accvgpr_read_b32 v222, a70
v_accvgpr_read_b32 v223, a71
v_mul_f32 v220, v220, v101
v_mul_f32 v221, v221, v101
v_mul_f32 v222, v222, v101
v_mul_f32 v223, v223, v101
v_accvgpr_write_b32 a68, v220
v_accvgpr_write_b32 a69, v221
v_accvgpr_write_b32 a70, v222
v_accvgpr_write_b32 a71, v223
v_accvgpr_read_b32 v216, a72
v_accvgpr_read_b32 v217, a73
v_accvgpr_read_b32 v218, a74
v_accvgpr_read_b32 v219, a75
v_mul_f32 v216, v216, v105
v_mul_f32 v217, v217, v105
v_mul_f32 v218, v218, v105
v_mul_f32 v219, v219, v105
v_accvgpr_write_b32 a72, v216
v_accvgpr_write_b32 a73, v217
v_accvgpr_write_b32 a74, v218
v_accvgpr_write_b32 a75, v219
v_accvgpr_read_b32 v220, a76
v_accvgpr_read_b32 v221, a77
v_accvgpr_read_b32 v222, a78
v_accvgpr_read_b32 v223, a79
v_mul_f32 v220, v220, v109
v_mul_f32 v221, v221, v109
v_mul_f32 v222, v222, v109
v_mul_f32 v223, v223, v109
v_accvgpr_write_b32 a76, v220
v_accvgpr_write_b32 a77, v221
v_accvgpr_write_b32 a78, v222
v_accvgpr_write_b32 a79, v223
v_accvgpr_read_b32 v216, a80
v_accvgpr_read_b32 v217, a81
v_accvgpr_read_b32 v218, a82
v_accvgpr_read_b32 v219, a83
v_mul_f32 v216, v216, v97
v_mul_f32 v217, v217, v97
v_mul_f32 v218, v218, v97
v_mul_f32 v219, v219, v97
v_accvgpr_write_b32 a80, v216
v_accvgpr_write_b32 a81, v217
v_accvgpr_write_b32 a82, v218
v_accvgpr_write_b32 a83, v219
v_accvgpr_read_b32 v220, a84
v_accvgpr_read_b32 v221, a85
v_accvgpr_read_b32 v222, a86
v_accvgpr_read_b32 v223, a87
v_mul_f32 v220, v220, v101
v_mul_f32 v221, v221, v101
v_mul_f32 v222, v222, v101
v_mul_f32 v223, v223, v101
v_accvgpr_write_b32 a84, v220
v_accvgpr_write_b32 a85, v221
v_accvgpr_write_b32 a86, v222
v_accvgpr_write_b32 a87, v223
v_accvgpr_read_b32 v216, a88
v_accvgpr_read_b32 v217, a89
v_accvgpr_read_b32 v218, a90
v_accvgpr_read_b32 v219, a91
v_mul_f32 v216, v216, v105
v_mul_f32 v217, v217, v105
v_mul_f32 v218, v218, v105
v_mul_f32 v219, v219, v105
v_accvgpr_write_b32 a88, v216
v_accvgpr_write_b32 a89, v217
v_accvgpr_write_b32 a90, v218
v_accvgpr_write_b32 a91, v219
v_accvgpr_read_b32 v220, a92
v_accvgpr_read_b32 v221, a93
v_accvgpr_read_b32 v222, a94
v_accvgpr_read_b32 v223, a95
v_mul_f32 v220, v220, v109
v_mul_f32 v221, v221, v109
v_mul_f32 v222, v222, v109
v_mul_f32 v223, v223, v109
v_accvgpr_write_b32 a92, v220
v_accvgpr_write_b32 a93, v221
v_accvgpr_write_b32 a94, v222
v_accvgpr_write_b32 a95, v223
v_accvgpr_read_b32 v216, a96
v_accvgpr_read_b32 v217, a97
v_accvgpr_read_b32 v218, a98
v_accvgpr_read_b32 v219, a99
v_mul_f32 v216, v216, v97
v_mul_f32 v217, v217, v97
v_mul_f32 v218, v218, v97
v_mul_f32 v219, v219, v97
v_accvgpr_write_b32 a96, v216
v_accvgpr_write_b32 a97, v217
v_accvgpr_write_b32 a98, v218
v_accvgpr_write_b32 a99, v219
v_accvgpr_read_b32 v220, a100
v_accvgpr_read_b32 v221, a101
v_accvgpr_read_b32 v222, a102
v_accvgpr_read_b32 v223, a103
v_mul_f32 v220, v220, v101
v_mul_f32 v221, v221, v101
v_mul_f32 v222, v222, v101
v_mul_f32 v223, v223, v101
v_accvgpr_write_b32 a100, v220
v_accvgpr_write_b32 a101, v221
v_accvgpr_write_b32 a102, v222
v_accvgpr_write_b32 a103, v223
v_accvgpr_read_b32 v216, a104
v_accvgpr_read_b32 v217, a105
v_accvgpr_read_b32 v218, a106
v_accvgpr_read_b32 v219, a107
v_mul_f32 v216, v216, v105
v_mul_f32 v217, v217, v105
v_mul_f32 v218, v218, v105
v_mul_f32 v219, v219, v105
v_accvgpr_write_b32 a104, v216
v_accvgpr_write_b32 a105, v217
v_accvgpr_write_b32 a106, v218
v_accvgpr_write_b32 a107, v219
v_accvgpr_read_b32 v220, a108
v_accvgpr_read_b32 v221, a109
v_accvgpr_read_b32 v222, a110
v_accvgpr_read_b32 v223, a111
v_mul_f32 v220, v220, v109
v_mul_f32 v221, v221, v109
v_mul_f32 v222, v222, v109
v_mul_f32 v223, v223, v109
v_accvgpr_write_b32 a108, v220
v_accvgpr_write_b32 a109, v221
v_accvgpr_write_b32 a110, v222
v_accvgpr_write_b32 a111, v223
v_accvgpr_read_b32 v216, a112
v_accvgpr_read_b32 v217, a113
v_accvgpr_read_b32 v218, a114
v_accvgpr_read_b32 v219, a115
v_mul_f32 v216, v216, v97
v_mul_f32 v217, v217, v97
v_mul_f32 v218, v218, v97
v_mul_f32 v219, v219, v97
v_accvgpr_write_b32 a112, v216
v_accvgpr_write_b32 a113, v217
v_accvgpr_write_b32 a114, v218
v_accvgpr_write_b32 a115, v219
v_accvgpr_read_b32 v220, a116
v_accvgpr_read_b32 v221, a117
v_accvgpr_read_b32 v222, a118
v_accvgpr_read_b32 v223, a119
v_mul_f32 v220, v220, v101
v_mul_f32 v221, v221, v101
v_mul_f32 v222, v222, v101
v_mul_f32 v223, v223, v101
v_accvgpr_write_b32 a116, v220
v_accvgpr_write_b32 a117, v221
v_accvgpr_write_b32 a118, v222
v_accvgpr_write_b32 a119, v223
v_accvgpr_read_b32 v216, a120
v_accvgpr_read_b32 v217, a121
v_accvgpr_read_b32 v218, a122
v_accvgpr_read_b32 v219, a123
v_mul_f32 v216, v216, v105
v_mul_f32 v217, v217, v105
v_mul_f32 v218, v218, v105
v_mul_f32 v219, v219, v105
v_accvgpr_write_b32 a120, v216
v_accvgpr_write_b32 a121, v217
v_accvgpr_write_b32 a122, v218
v_accvgpr_write_b32 a123, v219
v_accvgpr_read_b32 v220, a124
v_accvgpr_read_b32 v221, a125
v_accvgpr_read_b32 v222, a126
v_accvgpr_read_b32 v223, a127
v_mul_f32 v220, v220, v109
v_mul_f32 v221, v221, v109
v_mul_f32 v222, v222, v109
v_mul_f32 v223, v223, v109
v_accvgpr_write_b32 a124, v220
v_accvgpr_write_b32 a125, v221
v_accvgpr_write_b32 a126, v222
v_accvgpr_write_b32 a127, v223
v_accvgpr_read_b32 v216, a128
v_accvgpr_read_b32 v217, a129
v_accvgpr_read_b32 v218, a130
v_accvgpr_read_b32 v219, a131
v_mul_f32 v216, v216, v97
v_mul_f32 v217, v217, v97
v_mul_f32 v218, v218, v97
v_mul_f32 v219, v219, v97
v_accvgpr_write_b32 a128, v216
v_accvgpr_write_b32 a129, v217
v_accvgpr_write_b32 a130, v218
v_accvgpr_write_b32 a131, v219
v_accvgpr_read_b32 v220, a132
v_accvgpr_read_b32 v221, a133
v_accvgpr_read_b32 v222, a134
v_accvgpr_read_b32 v223, a135
v_mul_f32 v220, v220, v101
v_mul_f32 v221, v221, v101
v_mul_f32 v222, v222, v101
v_mul_f32 v223, v223, v101
v_accvgpr_write_b32 a132, v220
v_accvgpr_write_b32 a133, v221
v_accvgpr_write_b32 a134, v222
v_accvgpr_write_b32 a135, v223
v_accvgpr_read_b32 v216, a136
v_accvgpr_read_b32 v217, a137
v_accvgpr_read_b32 v218, a138
v_accvgpr_read_b32 v219, a139
v_mul_f32 v216, v216, v105
v_mul_f32 v217, v217, v105
v_mul_f32 v218, v218, v105
v_mul_f32 v219, v219, v105
v_accvgpr_write_b32 a136, v216
v_accvgpr_write_b32 a137, v217
v_accvgpr_write_b32 a138, v218
v_accvgpr_write_b32 a139, v219
v_accvgpr_read_b32 v220, a140
v_accvgpr_read_b32 v221, a141
v_accvgpr_read_b32 v222, a142
v_accvgpr_read_b32 v223, a143
v_mul_f32 v220, v220, v109
v_mul_f32 v221, v221, v109
v_mul_f32 v222, v222, v109
v_mul_f32 v223, v223, v109
v_accvgpr_write_b32 a140, v220
v_accvgpr_write_b32 a141, v221
v_accvgpr_write_b32 a142, v222
v_accvgpr_write_b32 a143, v223
v_accvgpr_read_b32 v216, a144
v_accvgpr_read_b32 v217, a145
v_accvgpr_read_b32 v218, a146
v_accvgpr_read_b32 v219, a147
v_mul_f32 v216, v216, v97
v_mul_f32 v217, v217, v97
v_mul_f32 v218, v218, v97
v_mul_f32 v219, v219, v97
v_accvgpr_write_b32 a144, v216
v_accvgpr_write_b32 a145, v217
v_accvgpr_write_b32 a146, v218
v_accvgpr_write_b32 a147, v219
v_accvgpr_read_b32 v220, a148
v_accvgpr_read_b32 v221, a149
v_accvgpr_read_b32 v222, a150
v_accvgpr_read_b32 v223, a151
v_mul_f32 v220, v220, v101
v_mul_f32 v221, v221, v101
v_mul_f32 v222, v222, v101
v_mul_f32 v223, v223, v101
v_accvgpr_write_b32 a148, v220
v_accvgpr_write_b32 a149, v221
v_accvgpr_write_b32 a150, v222
v_accvgpr_write_b32 a151, v223
v_accvgpr_read_b32 v216, a152
v_accvgpr_read_b32 v217, a153
v_accvgpr_read_b32 v218, a154
v_accvgpr_read_b32 v219, a155
v_mul_f32 v216, v216, v105
v_mul_f32 v217, v217, v105
v_mul_f32 v218, v218, v105
v_mul_f32 v219, v219, v105
v_accvgpr_write_b32 a152, v216
v_accvgpr_write_b32 a153, v217
v_accvgpr_write_b32 a154, v218
v_accvgpr_write_b32 a155, v219
v_accvgpr_read_b32 v220, a156
v_accvgpr_read_b32 v221, a157
v_accvgpr_read_b32 v222, a158
v_accvgpr_read_b32 v223, a159
v_mul_f32 v220, v220, v109
v_mul_f32 v221, v221, v109
v_mul_f32 v222, v222, v109
v_mul_f32 v223, v223, v109
v_accvgpr_write_b32 a156, v220
v_accvgpr_write_b32 a157, v221
v_accvgpr_write_b32 a158, v222
v_accvgpr_write_b32 a159, v223
v_accvgpr_read_b32 v216, a160
v_accvgpr_read_b32 v217, a161
v_accvgpr_read_b32 v218, a162
v_accvgpr_read_b32 v219, a163
v_mul_f32 v216, v216, v97
v_mul_f32 v217, v217, v97
v_mul_f32 v218, v218, v97
v_mul_f32 v219, v219, v97
v_accvgpr_write_b32 a160, v216
v_accvgpr_write_b32 a161, v217
v_accvgpr_write_b32 a162, v218
v_accvgpr_write_b32 a163, v219
v_accvgpr_read_b32 v220, a164
v_accvgpr_read_b32 v221, a165
v_accvgpr_read_b32 v222, a166
v_accvgpr_read_b32 v223, a167
v_mul_f32 v220, v220, v101
v_mul_f32 v221, v221, v101
v_mul_f32 v222, v222, v101
v_mul_f32 v223, v223, v101
v_accvgpr_write_b32 a164, v220
v_accvgpr_write_b32 a165, v221
v_accvgpr_write_b32 a166, v222
v_accvgpr_write_b32 a167, v223
v_accvgpr_read_b32 v216, a168
v_accvgpr_read_b32 v217, a169
v_accvgpr_read_b32 v218, a170
v_accvgpr_read_b32 v219, a171
v_mul_f32 v216, v216, v105
v_mul_f32 v217, v217, v105
v_mul_f32 v218, v218, v105
v_mul_f32 v219, v219, v105
v_accvgpr_write_b32 a168, v216
v_accvgpr_write_b32 a169, v217
v_accvgpr_write_b32 a170, v218
v_accvgpr_write_b32 a171, v219
v_accvgpr_read_b32 v220, a172
v_accvgpr_read_b32 v221, a173
v_accvgpr_read_b32 v222, a174
v_accvgpr_read_b32 v223, a175
v_mul_f32 v220, v220, v109
v_mul_f32 v221, v221, v109
v_mul_f32 v222, v222, v109
v_mul_f32 v223, v223, v109
v_accvgpr_write_b32 a172, v220
v_accvgpr_write_b32 a173, v221
v_accvgpr_write_b32 a174, v222
v_accvgpr_write_b32 a175, v223
v_accvgpr_read_b32 v216, a176
v_accvgpr_read_b32 v217, a177
v_accvgpr_read_b32 v218, a178
v_accvgpr_read_b32 v219, a179
v_mul_f32 v216, v216, v97
v_mul_f32 v217, v217, v97
v_mul_f32 v218, v218, v97
v_mul_f32 v219, v219, v97
v_accvgpr_write_b32 a176, v216
v_accvgpr_write_b32 a177, v217
v_accvgpr_write_b32 a178, v218
v_accvgpr_write_b32 a179, v219
v_accvgpr_read_b32 v220, a180
v_accvgpr_read_b32 v221, a181
v_accvgpr_read_b32 v222, a182
v_accvgpr_read_b32 v223, a183
v_mul_f32 v220, v220, v101
v_mul_f32 v221, v221, v101
v_mul_f32 v222, v222, v101
v_mul_f32 v223, v223, v101
v_accvgpr_write_b32 a180, v220
v_accvgpr_write_b32 a181, v221
v_accvgpr_write_b32 a182, v222
v_accvgpr_write_b32 a183, v223
v_accvgpr_read_b32 v216, a184
v_accvgpr_read_b32 v217, a185
v_accvgpr_read_b32 v218, a186
v_accvgpr_read_b32 v219, a187
v_mul_f32 v216, v216, v105
v_mul_f32 v217, v217, v105
v_mul_f32 v218, v218, v105
v_mul_f32 v219, v219, v105
v_accvgpr_write_b32 a184, v216
v_accvgpr_write_b32 a185, v217
v_accvgpr_write_b32 a186, v218
v_accvgpr_write_b32 a187, v219
v_accvgpr_read_b32 v220, a188
v_accvgpr_read_b32 v221, a189
v_accvgpr_read_b32 v222, a190
v_accvgpr_read_b32 v223, a191
v_mul_f32 v220, v220, v109
v_mul_f32 v221, v221, v109
v_mul_f32 v222, v222, v109
v_mul_f32 v223, v223, v109
v_accvgpr_write_b32 a188, v220
v_accvgpr_write_b32 a189, v221
v_accvgpr_write_b32 a190, v222
v_accvgpr_write_b32 a191, v223
v_exp_f32 v216, v0
v_exp_f32 v217, v1
v_exp_f32 v218, v2
v_exp_f32 v219, v3
v_cvt_pk_bf16_f32 v64, v216, v217
v_cvt_pk_bf16_f32 v65, v218, v219
v_add_f32 v216, v216, v217
v_add_f32 v218, v218, v219
v_add_f32 v224, v216, v218
v_exp_f32 v220, v4
v_exp_f32 v221, v5
v_exp_f32 v222, v6
v_exp_f32 v223, v7
v_cvt_pk_bf16_f32 v68, v220, v221
v_cvt_pk_bf16_f32 v69, v222, v223
v_add_f32 v220, v220, v221
v_add_f32 v222, v222, v223
v_add_f32 v225, v220, v222
v_exp_f32 v216, v8
v_exp_f32 v217, v9
v_exp_f32 v218, v10
v_exp_f32 v219, v11
v_cvt_pk_bf16_f32 v72, v216, v217
v_cvt_pk_bf16_f32 v73, v218, v219
v_add_f32 v216, v216, v217
v_add_f32 v218, v218, v219
v_add_f32 v226, v216, v218
v_exp_f32 v220, v12
v_exp_f32 v221, v13
v_exp_f32 v222, v14
v_exp_f32 v223, v15
v_cvt_pk_bf16_f32 v76, v220, v221
v_cvt_pk_bf16_f32 v77, v222, v223
v_add_f32 v220, v220, v221
v_add_f32 v222, v222, v223
v_add_f32 v227, v220, v222
v_exp_f32 v216, v16
v_exp_f32 v217, v17
v_exp_f32 v218, v18
v_exp_f32 v219, v19
v_cvt_pk_bf16_f32 v66, v216, v217
v_cvt_pk_bf16_f32 v67, v218, v219
v_add_f32 v216, v216, v217
v_add_f32 v218, v218, v219
v_add_f32 v224, v224, v216
v_add_f32 v224, v224, v218
v_exp_f32 v220, v20
v_exp_f32 v221, v21
v_exp_f32 v222, v22
v_exp_f32 v223, v23
v_cvt_pk_bf16_f32 v70, v220, v221
v_cvt_pk_bf16_f32 v71, v222, v223
v_add_f32 v220, v220, v221
v_add_f32 v222, v222, v223
v_add_f32 v225, v225, v220
v_add_f32 v225, v225, v222
v_exp_f32 v216, v24
v_exp_f32 v217, v25
v_exp_f32 v218, v26
v_exp_f32 v219, v27
v_cvt_pk_bf16_f32 v74, v216, v217
v_cvt_pk_bf16_f32 v75, v218, v219
v_add_f32 v216, v216, v217
v_add_f32 v218, v218, v219
v_add_f32 v226, v226, v216
v_add_f32 v226, v226, v218
v_exp_f32 v220, v28
v_exp_f32 v221, v29
v_exp_f32 v222, v30
v_exp_f32 v223, v31
v_cvt_pk_bf16_f32 v78, v220, v221
v_cvt_pk_bf16_f32 v79, v222, v223
v_add_f32 v220, v220, v221
v_add_f32 v222, v222, v223
v_add_f32 v227, v227, v220
v_add_f32 v227, v227, v222
v_exp_f32 v216, v32
v_exp_f32 v217, v33
v_exp_f32 v218, v34
v_exp_f32 v219, v35
v_cvt_pk_bf16_f32 v80, v216, v217
v_cvt_pk_bf16_f32 v81, v218, v219
v_add_f32 v216, v216, v217
v_add_f32 v218, v218, v219
v_add_f32 v224, v224, v216
v_add_f32 v224, v224, v218
v_exp_f32 v220, v36
v_exp_f32 v221, v37
v_exp_f32 v222, v38
v_exp_f32 v223, v39
v_cvt_pk_bf16_f32 v84, v220, v221
v_cvt_pk_bf16_f32 v85, v222, v223
v_add_f32 v220, v220, v221
v_add_f32 v222, v222, v223
v_add_f32 v225, v225, v220
v_add_f32 v225, v225, v222
v_exp_f32 v216, v40
v_exp_f32 v217, v41
v_exp_f32 v218, v42
v_exp_f32 v219, v43
v_cvt_pk_bf16_f32 v88, v216, v217
v_cvt_pk_bf16_f32 v89, v218, v219
v_add_f32 v216, v216, v217
v_add_f32 v218, v218, v219
v_add_f32 v226, v226, v216
v_add_f32 v226, v226, v218
v_exp_f32 v220, v44
v_exp_f32 v221, v45
v_exp_f32 v222, v46
v_exp_f32 v223, v47
v_cvt_pk_bf16_f32 v92, v220, v221
v_cvt_pk_bf16_f32 v93, v222, v223
v_add_f32 v220, v220, v221
v_add_f32 v222, v222, v223
v_add_f32 v227, v227, v220
v_add_f32 v227, v227, v222
v_exp_f32 v216, v48
v_exp_f32 v217, v49
v_exp_f32 v218, v50
v_exp_f32 v219, v51
v_cvt_pk_bf16_f32 v82, v216, v217
v_cvt_pk_bf16_f32 v83, v218, v219
v_add_f32 v216, v216, v217
v_add_f32 v218, v218, v219
v_add_f32 v224, v224, v216
v_add_f32 v224, v224, v218
v_exp_f32 v220, v52
v_exp_f32 v221, v53
v_exp_f32 v222, v54
v_exp_f32 v223, v55
v_cvt_pk_bf16_f32 v86, v220, v221
v_cvt_pk_bf16_f32 v87, v222, v223
v_add_f32 v220, v220, v221
v_add_f32 v222, v222, v223
v_add_f32 v225, v225, v220
v_add_f32 v225, v225, v222
v_exp_f32 v216, v56
v_exp_f32 v217, v57
v_exp_f32 v218, v58
v_exp_f32 v219, v59
v_cvt_pk_bf16_f32 v90, v216, v217
v_cvt_pk_bf16_f32 v91, v218, v219
v_add_f32 v216, v216, v217
v_add_f32 v218, v218, v219
v_add_f32 v226, v226, v216
v_add_f32 v226, v226, v218
v_exp_f32 v220, v60
v_exp_f32 v221, v61
v_exp_f32 v222, v62
v_exp_f32 v223, v63
v_cvt_pk_bf16_f32 v94, v220, v221
v_cvt_pk_bf16_f32 v95, v222, v223
v_add_f32 v220, v220, v221
v_add_f32 v222, v222, v223
v_add_f32 v227, v227, v220
v_add_f32 v227, v227, v222
s_nop 1
s_setpc_b64 s[30:31]
L_text_end:
s_endpgm
.section .rodata,"a"
.p2align 6
.amdhsa_kernel standalone__gqa_softmax__prompt_kernel
  .amdhsa_next_free_vgpr 512
  .amdhsa_next_free_sgpr 102
  .amdhsa_accum_offset 256
  .amdhsa_group_segment_fixed_size 0
  .amdhsa_kernarg_size 48
  .amdhsa_user_sgpr_count 2
  .amdhsa_user_sgpr_kernarg_segment_ptr 1
  .amdhsa_system_sgpr_workgroup_id_x 1
.end_amdhsa_kernel
```
